```python
import torch

def _softmax(x, axis=-1):
    return torch.softmax(x, dim=axis)
def _gelu(x):
    return torch.nn.functional.gelu(x, approximate="tanh")
def _silu(x):
    return torch.nn.functional.silu(x)
def _sigmoid(x):
    return torch.sigmoid(x)
def _layernorm(x, axis=-1, eps=1e-5):
    m = x.mean(dim=axis, keepdim=True)
    v = x.var(dim=axis, keepdim=True, unbiased=False)
    return (x - m) / torch.sqrt(v + eps)
def _scatter_add(tgt, idx, src, axis=0):
    return tgt.clone().index_add_(axis, idx, src)
def _segment_sum(src, seg, n):
    out = torch.zeros((n,) + src.shape[1:], dtype=src.dtype)
    return out.index_add_(0, seg, src)
def _pad(x, pw):
    flat = tuple(v for pair in reversed(pw) for v in pair)
    return torch.nn.functional.pad(x, flat)

kernel_name = 'standalone__modern_conv_block_slak__vision'

def setup_inputs():

    _w = (lambda a: (lambda t: t.to(torch.bfloat16) if t.is_floating_point() else t)(torch.as_tensor(a)))
    H = W = 224
    C = 192
    K = 3
    return {
        "x": _w((lambda *s: torch.randn(*s, dtype=torch.bfloat16) * 0.05)(1, H, W, C)),
        "dw": _w((lambda *s: torch.randn(*s, dtype=torch.bfloat16) * 0.05)(K, K, C)),
        "w1": _w((lambda *s: torch.randn(*s, dtype=torch.bfloat16) * 0.05)(C, 4 * C)),
        "w2": _w((lambda *s: torch.randn(*s, dtype=torch.bfloat16) * 0.05)(4 * C, C)),
        "grn_g": _w((lambda *s: torch.randn(*s, dtype=torch.bfloat16) * 0.05)(4 * C)),
        "grn_b": _w((lambda *s: torch.randn(*s, dtype=torch.bfloat16) * 0.05)(4 * C)),
    }

def reference(x, dw, w1, w2, grn_g, grn_b):
    B, H, W, C = x.shape
    K = dw.shape[0]
    pad = K // 2
    xp = _pad(x, ((0,0),(pad,pad),(pad,pad),(0,0)))
    out = torch.zeros_like(x)
    for i in range(K):
        for j in range(K):
            out = out + xp[:, i:i+H, j:j+W, :] * dw[i, j][None, None, None, :]
    h = _layernorm(out, axis=-1)
    h = _gelu(h @ w1)
    gx = torch.sqrt((h * h).sum(axis=(1, 2), keepdims=True) + 1e-6)
    nx = gx / (gx.mean(axis=-1, keepdims=True) + 1e-6)
    h = grn_g[None, None, None, :] * (h * nx) + grn_b[None, None, None, :] + h
    return x + h @ w2
```

```asm
; @launch grid=(256,1,1) block=(256,1,1) lds=163840
.amdgcn_target "amdgcn-amd-amdhsa--gfx950"
.text
.globl standalone__modern_conv_block_slak__vision_kernel
.p2align 8
.type standalone__modern_conv_block_slak__vision_kernel,@function
standalone__modern_conv_block_slak__vision_kernel:
 s_cmp_ge_u32 s2, 256
 s_cbranch_scc1 L_end
 s_load_dwordx16 s[64:79], s[0:1], 0
 s_load_dwordx2 s[80:81], s[0:1], 64
 s_getpc_b64 s[82:83]
L_pc1:
 s_getreg_b32 s6, hwreg(HW_REG_HW_ID, 8, 3)
 s_lshl_b32 s7, s6, 11
 v_lshl_add_u32 v254, v0, 3, s7
 global_load_dword v255, v254, s[82:83]
 s_lshl_b32 s7, s6, 13
 v_lshl_add_u32 v254, v0, 5, s7
 v_min_u32 v254, L_end-L_pc1-4, v254
 global_load_dword v243, v254, s[82:83]
 s_sub_u32 s82, s82, L_pc1-standalone__modern_conv_block_slak__vision_kernel
 s_subb_u32 s83, s83, 0
 v_lshrrev_b32 v7, 6, v0
 v_and_b32 v1, 63, v0
 v_readfirstlane_b32 s3, v7
 s_and_b32 s4, s2, 7
 s_add_u32 s6, s4, 3
 s_and_b32 s6, s6, 7
 s_cmp_lt_u32 s6, 2
 s_cselect_b32 s6, 3, 0
 s_xor_b32 s4, s4, s6
 s_lshr_b32 s5, s2, 3
 s_lshr_b32 s6, s4, 1
 s_lshl_b32 s6, s6, 2
 s_lshr_b32 s7, s5, 3
 s_add_u32 s46, s6, s7
 s_and_b32 s6, s4, 1
 s_lshl_b32 s6, s6, 3
 s_and_b32 s7, s5, 7
 s_add_u32 s47, s6, s7
 s_mul_i32 s44, s46, 14
 s_mul_i32 s45, s47, 14
 s_mov_b32 s50, 0x409d30fc
 s_mov_b32 s51, 0x409d30fc
 s_and_b32 s62, s3, 1
 s_lshr_b32 s63, s3, 1
 s_lshl_b32 s7, s62, 3
 s_cmp_eq_u32 s47, 0
 s_cselect_b32 s54, 0, 99
 s_cmp_eq_u32 s47, 15
 s_cselect_b32 s55, 15, 99
 v_add_u32 v96, 0, v1
 v_mul_u32_u24 v97, 171, v96
 v_lshrrev_b32 v97, 12, v97
 v_mul_u32_u24 v98, 24, v97
 v_sub_u32 v98, v96, v98
 v_add_u32 v97, s7, v97
 v_lshrrev_b32 v99, 1, v97
 v_xor_b32 v99, v99, v98
 v_and_b32 v99, 7, v99
 v_and_b32 v98, 24, v98
 v_or_b32 v98, v98, v99
 v_lshlrev_b32 v98, 4, v98
 v_mul_u32_u24 v99, 384, v97
 v_add_u32 v98, v98, v99
 v_mov_b32 v99, 0x40000000
 v_cmp_eq_u32 vcc, s54, v97
 s_nop 1
 v_cndmask_b32 v98, v98, v99, vcc
 v_cmp_eq_u32 vcc, s55, v97
 s_nop 1
 v_cndmask_b32 v30, v98, v99, vcc
 v_add_u32_e64 v96, 64, v1
 v_mul_u32_u24 v97, 171, v96
 v_lshrrev_b32 v97, 12, v97
 v_mul_u32_u24 v98, 24, v97
 v_sub_u32 v98, v96, v98
 v_add_u32 v97, s7, v97
 v_lshrrev_b32 v99, 1, v97
 v_xor_b32 v99, v99, v98
 v_and_b32 v99, 7, v99
 v_and_b32 v98, 24, v98
 v_or_b32 v98, v98, v99
 v_lshlrev_b32 v98, 4, v98
 v_mul_u32_u24 v99, 384, v97
 v_add_u32 v98, v98, v99
 v_mov_b32 v99, 0x40000000
 v_cmp_eq_u32 vcc, s54, v97
 s_nop 1
 v_cndmask_b32 v98, v98, v99, vcc
 v_cmp_eq_u32 vcc, s55, v97
 s_nop 1
 v_cndmask_b32 v31, v98, v99, vcc
 v_add_u32 v96, 128, v1
 v_mul_u32_u24 v97, 171, v96
 v_lshrrev_b32 v97, 12, v97
 v_mul_u32_u24 v98, 24, v97
 v_sub_u32 v98, v96, v98
 v_add_u32 v97, s7, v97
 v_lshrrev_b32 v99, 1, v97
 v_xor_b32 v99, v99, v98
 v_and_b32 v99, 7, v99
 v_and_b32 v98, 24, v98
 v_or_b32 v98, v98, v99
 v_lshlrev_b32 v98, 4, v98
 v_mul_u32_u24 v99, 384, v97
 v_add_u32 v98, v98, v99
 v_mov_b32 v99, 0x40000000
 v_cmp_eq_u32 vcc, s54, v97
 s_nop 1
 v_cndmask_b32 v98, v98, v99, vcc
 v_cmp_eq_u32 vcc, s55, v97
 s_nop 1
 v_cndmask_b32 v32, v98, v99, vcc
 v_mul_u32_u24 v96, 43, v1
 v_lshrrev_b32 v96, 8, v96
 v_mul_u32_u24 v97, 6, v96
 v_sub_u32 v97, v1, v97
 v_mul_u32_u24 v96, 384, v96
 v_lshl_add_u32 v96, v97, 4, v96
 s_mul_i32 s6, s3, 96
 v_add_u32 v96, s6, v96
 v_mov_b32 v34, 0x40000000
 v_cmp_gt_u32 vcc, 54, v1
 s_nop 1
 v_cndmask_b32_e64 v35, v34, v96, vcc
 s_mul_i32 s6, s44, 224
 s_add_u32 s6, s6, s45
 s_sub_u32 s6, s6, 225
 s_mul_i32 s7, s63, 224
 s_add_u32 s6, s6, s7
 s_mul_i32 s48, s6, 384
 s_mul_i32 s49, s3, 3072
 s_lshl_b32 s87, s3, 11
 s_add_u32 s87, s87, 98304
 s_waitcnt lgkmcnt(0)
 s_mov_b32 s8, s64
 s_mov_b32 s9, s65
 s_mov_b32 s10, 0x1260000
 s_mov_b32 s11, 0x20000
 s_mov_b32 s28, s66
 s_mov_b32 s29, s67
 s_mov_b32 s30, 0xd80
 s_mov_b32 s31, 0x20000
 s_mov_b32 s12, s68
 s_mov_b32 s13, s69
 s_mov_b32 s14, 0x48000
 s_mov_b32 s15, 0x20000
 s_mov_b32 s16, s70
 s_mov_b32 s17, s71
 s_mov_b32 s18, 0x48000
 s_mov_b32 s19, 0x20000
 s_mov_b32 s32, s72
 s_mov_b32 s33, s73
 s_mov_b32 s34, 0x600
 s_mov_b32 s35, 0x20000
 s_mov_b32 s36, s74
 s_mov_b32 s37, s75
 s_mov_b32 s38, 0x600
 s_mov_b32 s39, 0x20000
 s_mov_b32 s20, s76
 s_mov_b32 s21, s77
 s_mov_b32 s22, 0x1260000
 s_mov_b32 s23, 0x20000
 s_mov_b32 s40, s78
 s_mov_b32 s41, s79
 s_mov_b32 s42, 0x100
 s_mov_b32 s43, 0x20000
 s_mov_b32 s24, s80
 s_mov_b32 s25, s81
 s_mov_b32 s26, 0x10000000
 s_mov_b32 s27, 0x20000
 s_lshr_b32 s6, s2, 3
 s_lshl_b32 s6, s6, 1
 s_bfe_u32 s7, s2, 0x10001
 s_add_u32 s81, s6, s7
 s_and_b32 s7, s2, 5
 s_cmp_eq_u32 s7, 0
 s_cselect_b32 s81, s81, 99
 s_add_u32 s85, s48, 0
 s_cmp_eq_u32 s46, 0
 s_cselect_b32 s86, s63, 1
 s_cmp_eq_u32 s86, 0
 s_cselect_b32 s85, 0x40000000, s85
 s_add_u32 m0, s49, 0
 v_add_u32 v76, s85, v30
 buffer_load_dwordx4 v76, s[8:11], 0 offen lds
 s_add_u32 m0, s49, 1024
 v_add_u32_e64 v95, s85, v31
 buffer_load_dwordx4 v95, s[8:11], 0 offen lds
 s_add_u32 m0, s49, 2048
 v_add_u32 v76, s85, v32
 buffer_load_dwordx4 v76, s[8:11], 0 offen lds
 s_mov_b32 m0, s87
 s_nop 0
 buffer_load_dwordx4 v35, s[28:31], 0 offen lds
 s_add_u32 m0, s87, 1024
 s_nop 0
 buffer_load_dwordx4 v34, s[28:31], 0 offen lds
 s_add_u32 s85, s48, 172032
 s_add_u32 m0, s49, 12288
 v_add_u32_e64 v76, s85, v30
 buffer_load_dwordx4 v76, s[8:11], 0 offen lds
 s_add_u32 m0, s49, 13312
 v_add_u32_e64 v95, s85, v31
 buffer_load_dwordx4 v95, s[8:11], 0 offen lds
 s_add_u32 m0, s49, 14336
 v_add_u32_e64 v76, s85, v32
 buffer_load_dwordx4 v76, s[8:11], 0 offen lds
 s_add_u32 s85, s48, 344064
 s_add_u32 m0, s49, 24576
 v_add_u32_e64 v76, s85, v30
 buffer_load_dwordx4 v76, s[8:11], 0 offen lds
 s_add_u32 m0, s49, 25600
 v_add_u32_e64 v95, s85, v31
 buffer_load_dwordx4 v95, s[8:11], 0 offen lds
 s_add_u32 m0, s49, 26624
 v_add_u32_e64 v76, s85, v32
 buffer_load_dwordx4 v76, s[8:11], 0 offen lds
 s_add_u32 s6, s4, 1
 s_cmp_ge_u32 s6, 12
 s_cselect_b32 s7, 12, 0
 s_sub_u32 s6, s6, s7
 s_cmp_ge_u32 s6, 6
 s_cselect_b32 s7, 6, 0
 s_sub_u32 s56, s6, s7
 s_add_u32 s6, s4, 2
 s_cmp_ge_u32 s6, 12
 s_cselect_b32 s7, 12, 0
 s_sub_u32 s6, s6, s7
 s_cmp_ge_u32 s6, 6
 s_cselect_b32 s7, 6, 0
 s_sub_u32 s57, s6, s7
 s_add_u32 s6, s4, 3
 s_cmp_ge_u32 s6, 12
 s_cselect_b32 s7, 12, 0
 s_sub_u32 s6, s6, s7
 s_cmp_ge_u32 s6, 6
 s_cselect_b32 s7, 6, 0
 s_sub_u32 s58, s6, s7
 s_add_u32 s6, s4, 4
 s_cmp_ge_u32 s6, 12
 s_cselect_b32 s7, 12, 0
 s_sub_u32 s6, s6, s7
 s_cmp_ge_u32 s6, 6
 s_cselect_b32 s7, 6, 0
 s_sub_u32 s59, s6, s7
 s_add_u32 s6, s4, 5
 s_cmp_ge_u32 s6, 12
 s_cselect_b32 s7, 12, 0
 s_sub_u32 s6, s6, s7
 s_cmp_ge_u32 s6, 6
 s_cselect_b32 s7, 6, 0
 s_sub_u32 s60, s6, s7
 s_add_u32 s6, s4, 6
 s_cmp_ge_u32 s6, 12
 s_cselect_b32 s7, 12, 0
 s_sub_u32 s6, s6, s7
 s_cmp_ge_u32 s6, 6
 s_cselect_b32 s7, 6, 0
 s_sub_u32 s61, s6, s7
 v_lshrrev_b32_e64 v96, 4, v1
 v_bfe_u32 v97, v1, 2, 1
 v_bfe_u32 v98, v1, 3, 1
 v_and_b32_e64 v99, 3, v1
 v_lshl_add_u32 v99, v98, 2, v99
 v_sub_u32_e64 v96, v96, v97
 v_mul_u32_u24 v100, 288, v96
 v_lshl_add_u32 v100, v99, 1, v100
 v_mov_b32 v97, 1024
 v_cmp_gt_u32 vcc, 3, v96
 v_and_b32 v98, 1, v99
 s_nop 0
 v_cndmask_b32 v100, v97, v100, vcc
 v_add_u32 v35, s87, v100
 v_lshlrev_b32 v98, 4, v98
 v_mov_b32 v97, 1
 v_lshlrev_b32 v98, v98, v97
 v_lshrrev_b32 v99, 1, v99
 v_cmp_eq_u32 vcc, 0, v99
 s_nop 1
 v_cndmask_b32 v26, 0, v98, vcc
 v_cmp_eq_u32 vcc, 1, v99
 s_nop 1
 v_cndmask_b32 v27, 0, v98, vcc
 v_cmp_eq_u32 vcc, 2, v99
 s_nop 1
 v_cndmask_b32 v28, 0, v98, vcc
 v_cmp_eq_u32 vcc, 3, v99
 s_nop 1
 v_cndmask_b32 v29, 0, v98, vcc
 v_lshrrev_b32 v96, 4, v1
 v_and_b32 v97, 15, v1
 v_lshrrev_b32 v98, 1, v96
 v_mul_u32_u24 v98, 12288, v98
 v_and_b32_e64 v99, 1, v96
 v_mul_u32_u24 v99, 6144, v99
 v_add_u32 v98, v98, v99
 v_add_u32 v99, 0, v97
 v_and_b32 v99, 15, v99
 v_lshrrev_b32 v100, 1, v99
 v_lshlrev_b32_e64 v92, 4, v100
 v_mul_u32_u24 v99, 384, v99
 v_add_u32 v89, v99, v98
 v_add_u32 v99, 1, v97
 v_and_b32 v99, 15, v99
 v_lshrrev_b32 v100, 1, v99
 v_lshlrev_b32_e64 v93, 4, v100
 v_mul_u32_u24 v99, 384, v99
 v_add_u32 v90, v99, v98
 v_add_u32 v99, 2, v97
 v_and_b32 v99, 15, v99
 v_lshrrev_b32 v100, 1, v99
 v_lshlrev_b32_e64 v94, 4, v100
 v_mul_u32_u24 v99, 384, v99
 v_add_u32 v91, v99, v98
 s_mul_i32 s6, s3, 6
 s_add_u32 s6, s6, 0
 s_and_b32 s7, s6, 7
 s_lshl_b32 s7, s7, 4
 s_and_b32 s6, s6, 24
 s_lshl_b32 s6, s6, 4
 v_xor_b32 v99, s7, v92
 v_add3_u32 v224, v99, v89, s6
 v_xor_b32_e64 v99, s7, v93
 v_add3_u32 v225, v99, v90, s6
 v_xor_b32_e64 v99, s7, v94
 v_add3_u32 v226, v99, v91, s6
 s_mul_i32 s6, s3, 6
 s_add_u32 s6, s6, 1
 s_and_b32 s7, s6, 7
 s_lshl_b32 s7, s7, 4
 s_and_b32 s6, s6, 24
 s_lshl_b32 s6, s6, 4
 v_xor_b32_e64 v99, s7, v92
 v_add3_u32 v227, v99, v89, s6
 v_xor_b32_e64 v99, s7, v93
 v_add3_u32 v228, v99, v90, s6
 v_xor_b32_e64 v99, s7, v94
 v_add3_u32 v229, v99, v91, s6
 s_mul_i32 s6, s3, 6
 s_add_u32 s6, s6, 2
 s_and_b32 s7, s6, 7
 s_lshl_b32 s7, s7, 4
 s_and_b32 s6, s6, 24
 s_lshl_b32 s6, s6, 4
 v_xor_b32_e64 v99, s7, v92
 v_add3_u32 v230, v99, v89, s6
 v_xor_b32_e64 v99, s7, v93
 v_add3_u32 v231, v99, v90, s6
 v_xor_b32_e64 v99, s7, v94
 v_add3_u32 v232, v99, v91, s6
 s_mul_i32 s6, s3, 6
 s_add_u32 s6, s6, 3
 s_and_b32 s7, s6, 7
 s_lshl_b32 s7, s7, 4
 s_and_b32 s6, s6, 24
 s_lshl_b32 s6, s6, 4
 v_xor_b32_e64 v99, s7, v92
 v_add3_u32 v233, v99, v89, s6
 v_xor_b32_e64 v99, s7, v93
 v_add3_u32 v234, v99, v90, s6
 v_xor_b32_e64 v99, s7, v94
 v_add3_u32 v235, v99, v91, s6
 s_mul_i32 s6, s3, 6
 s_add_u32 s6, s6, 4
 s_and_b32 s7, s6, 7
 s_lshl_b32 s7, s7, 4
 s_and_b32 s6, s6, 24
 s_lshl_b32 s6, s6, 4
 v_xor_b32_e64 v99, s7, v92
 v_add3_u32 v236, v99, v89, s6
 v_xor_b32_e64 v99, s7, v93
 v_add3_u32 v237, v99, v90, s6
 v_xor_b32_e64 v99, s7, v94
 v_add3_u32 v238, v99, v91, s6
 s_mul_i32 s6, s3, 6
 s_add_u32 s6, s6, 5
 s_and_b32 s7, s6, 7
 s_lshl_b32 s7, s7, 4
 s_and_b32 s6, s6, 24
 s_lshl_b32 s6, s6, 4
 v_xor_b32_e64 v99, s7, v92
 v_add3_u32 v239, v99, v89, s6
 v_xor_b32_e64 v99, s7, v93
 v_add3_u32 v240, v99, v90, s6
 v_xor_b32_e64 v99, s7, v94
 v_add3_u32 v241, v99, v91, s6
 v_bfe_u32 v99, v1, 4, 1
 v_mul_u32_u24 v99, 14, v99
 v_add_u32 v72, v99, v97
 v_lshrrev_b32 v100, 5, v1
 v_lshlrev_b32 v100, 9, v100
 v_lshl_add_u32 v100, v72, 4, v100
 v_add_u32 v73, s49, v100
 s_lshl_b32 s6, s3, 2
 s_add_u32 s6, s6, 159744
 v_lshlrev_b32 v100, 4, v1
 v_add_u32 v74, s6, v100
 v_and_b32 v100, 31, v1
 v_lshlrev_b32 v100, 4, v100
 v_add_u32 v75, 159744, v100
 s_add_u32 s85, s48, 516096
 s_add_u32 m0, s49, 36864
 v_add_u32_e64 v76, s85, v30
 buffer_load_dwordx4 v76, s[8:11], 0 offen lds
 s_add_u32 m0, s49, 37888
 v_add_u32_e64 v95, s85, v31
 buffer_load_dwordx4 v95, s[8:11], 0 offen lds
 s_add_u32 m0, s49, 38912
 v_add_u32 v76, s85, v32
 buffer_load_dwordx4 v76, s[8:11], 0 offen lds
 s_waitcnt vmcnt(9)
 ds_read_u16 v8, v35 offset:0
 ds_read_u16 v9, v35 offset:96
 ds_read_u16 v10, v35 offset:192
 ds_read_u16 v11, v35 offset:16
 ds_read_u16 v12, v35 offset:112
 ds_read_u16 v13, v35 offset:208
 ds_read_u16 v14, v35 offset:32
 ds_read_u16 v15, v35 offset:128
 ds_read_u16 v16, v35 offset:224
 ds_read_u16 v17, v35 offset:48
 ds_read_u16 v18, v35 offset:144
 ds_read_u16 v19, v35 offset:240
 ds_read_u16 v20, v35 offset:64
 ds_read_u16 v21, v35 offset:160
 ds_read_u16 v22, v35 offset:256
 ds_read_u16 v23, v35 offset:80
 ds_read_u16 v24, v35 offset:176
 ds_read_u16 v25, v35 offset:272
 v_lshlrev_b32_e64 v100, 4, v1
 v_add_u32 v3, 12288, v100
 v_add_u32 v2, 98304, v100
 v_bfe_u32 v96, v1, 2, 3
 v_mul_u32_u24 v96, 1536, v96
 v_lshrrev_b32_e64 v97, 5, v1
 v_lshl_add_u32 v96, v97, 6, v96
 v_and_b32_e64 v97, 3, v1
 v_lshl_add_u32 v96, v97, 4, v96
 s_mul_i32 s6, s62, 12288
 v_add_u32 v5, s6, v96
 v_lshrrev_b32 v96, 5, v1
 v_bfe_u32 v97, v1, 2, 2
 v_lshl_add_u32 v96, v96, 2, v97
 v_lshlrev_b32_e64 v96, 6, v96
 v_bfe_u32 v97, v1, 4, 1
 v_lshl_add_u32 v96, v97, 5, v96
 v_and_b32_e64 v97, 3, v1
 v_lshl_add_u32 v96, v97, 3, v96
 s_mul_i32 s6, s63, 24576
 s_lshl_b32 s7, s62, 9
 s_add_u32 s6, s6, s7
 s_add_u32 s6, s6, 0
 v_add_u32 v4, s6, v96
 s_waitcnt lgkmcnt(15)
 v_mul_u32_u24 v104, v8, v26
 v_mul_u32_u24 v105, v8, v27
 v_mul_u32_u24 v106, v8, v28
 v_mul_u32_u24 v107, v8, v29
 v_mul_u32_u24 v108, v9, v26
 v_mul_u32_u24 v109, v9, v27
 v_mul_u32_u24 v110, v9, v28
 v_mul_u32_u24 v111, v9, v29
 v_mul_u32_u24 v112, v10, v26
 v_mul_u32_u24 v113, v10, v27
 v_mul_u32_u24 v114, v10, v28
 v_mul_u32_u24 v115, v10, v29
 s_waitcnt lgkmcnt(14)
 v_mul_u32_u24 v116, v11, v26
 v_mul_u32_u24 v117, v11, v27
 v_mul_u32_u24 v118, v11, v28
 v_mul_u32_u24 v119, v11, v29
 s_waitcnt lgkmcnt(13)
 v_mul_u32_u24 v120, v12, v26
 v_mul_u32_u24 v121, v12, v27
 v_mul_u32_u24 v122, v12, v28
 v_mul_u32_u24 v123, v12, v29
 s_waitcnt lgkmcnt(12)
 v_mul_u32_u24 v124, v13, v26
 v_mul_u32_u24 v125, v13, v27
 v_mul_u32_u24 v126, v13, v28
 v_mul_u32_u24 v127, v13, v29
 s_waitcnt lgkmcnt(11)
 v_mul_u32_u24 v128, v14, v26
 v_mul_u32_u24 v129, v14, v27
 v_mul_u32_u24 v130, v14, v28
 v_mul_u32_u24 v131, v14, v29
 s_waitcnt lgkmcnt(10)
 v_mul_u32_u24 v132, v15, v26
 v_mul_u32_u24 v133, v15, v27
 v_mul_u32_u24 v134, v15, v28
 v_mul_u32_u24 v135, v15, v29
 s_waitcnt lgkmcnt(9)
 v_mul_u32_u24 v136, v16, v26
 v_mul_u32_u24 v137, v16, v27
 v_mul_u32_u24 v138, v16, v28
 v_mul_u32_u24 v139, v16, v29
 s_waitcnt lgkmcnt(8)
 v_mul_u32_u24 v140, v17, v26
 v_mul_u32_u24 v141, v17, v27
 v_mul_u32_u24 v142, v17, v28
 v_mul_u32_u24 v143, v17, v29
 s_waitcnt lgkmcnt(7)
 v_mul_u32_u24 v144, v18, v26
 v_mul_u32_u24 v145, v18, v27
 v_mul_u32_u24 v146, v18, v28
 v_mul_u32_u24 v147, v18, v29
 s_waitcnt lgkmcnt(6)
 v_mul_u32_u24 v148, v19, v26
 v_mul_u32_u24 v149, v19, v27
 v_mul_u32_u24 v150, v19, v28
 v_mul_u32_u24 v151, v19, v29
 s_waitcnt lgkmcnt(5)
 v_mul_u32_u24 v152, v20, v26
 v_mul_u32_u24 v153, v20, v27
 v_mul_u32_u24 v154, v20, v28
 v_mul_u32_u24 v155, v20, v29
 s_waitcnt lgkmcnt(4)
 v_mul_u32_u24 v156, v21, v26
 v_mul_u32_u24 v157, v21, v27
 v_mul_u32_u24 v158, v21, v28
 v_mul_u32_u24 v159, v21, v29
 s_waitcnt lgkmcnt(3)
 v_mul_u32_u24 v160, v22, v26
 v_mul_u32_u24 v161, v22, v27
 v_mul_u32_u24 v162, v22, v28
 v_mul_u32_u24 v163, v22, v29
 s_waitcnt lgkmcnt(2)
 v_mul_u32_u24 v164, v23, v26
 v_mul_u32_u24 v165, v23, v27
 v_mul_u32_u24 v166, v23, v28
 v_mul_u32_u24 v167, v23, v29
 s_waitcnt lgkmcnt(1)
 v_mul_u32_u24 v168, v24, v26
 v_mul_u32_u24 v169, v24, v27
 v_mul_u32_u24 v170, v24, v28
 v_mul_u32_u24 v171, v24, v29
 s_waitcnt lgkmcnt(0)
 v_mul_u32_u24 v172, v25, v26
 v_mul_u32_u24 v173, v25, v27
 v_mul_u32_u24 v174, v25, v28
 v_mul_u32_u24 v175, v25, v29
 s_mov_b32 s88, 0x3fff3fff
 s_mov_b32 s89, 0x3fff3fff
 v_lshrrev_b32 v101, 3, v0
 v_lshlrev_b32 v101, 15, v101
 v_and_b32_e64 v96, 7, v0
 v_lshl_add_u32 v101, v96, 4, v101
 s_lshl_b32 s6, s2, 7
 s_add_u32 s6, s6, 0x0
 v_add_u32 v101, s6, v101
 v_mov_b32 v96, 0x40000000
 v_cmp_gt_u32 vcc, 240, v0
 s_nop 1
 v_cndmask_b32 v101, v96, v101, vcc
 v_lshrrev_b32 v96, 3, v0
 v_lshlrev_b32 v96, 10, v96
 v_bfe_u32 v97, v0, 2, 1
 v_lshl_add_u32 v96, v97, 9, v96
 v_and_b32_e64 v97, 3, v0
 v_lshl_add_u32 v96, v97, 4, v96
 s_mul_i32 s6, s5, 12288
 s_lshl_b32 s7, s4, 6
 s_add_u32 s6, s6, s7
 s_add_u32 s6, s6, 0x101000
 v_add_u32 v96, s6, v96
 s_lshl_b32 s6, s81, 7
 s_add_u32 s6, s6, 0xffa00
 s_cmp_lt_u32 s81, 30
 s_cselect_b32 s6, s6, 0x40000000
 v_lshlrev_b32 v97, 4, v0
 v_add_u32 v97, s6, v97
 v_mov_b32_e64 v98, 0x40000000
 v_cmp_gt_u32 vcc, 104, v0
 s_nop 1
 v_cndmask_b32 v97, v98, v97, vcc
 v_cmp_gt_u32 vcc, 96, v0
 s_nop 1
 v_cndmask_b32 v102, v97, v96, vcc
 v_mov_b32 v36, -1
 v_mov_b32 v37, -1
 v_mov_b32 v38, -1
 v_mov_b32 v39, -1
 v_lshrrev_b32 v96, 5, v1
 v_lshlrev_b32 v96, 5, v96
 v_and_b32 v97, 15, v1
 v_add_u32 v96, v96, v97
 v_lshlrev_b32 v96, 4, v96
 s_mul_i32 s6, s5, 12288
 s_mul_i32 s7, s3, 3072
 s_add_u32 s6, s6, s7
 s_lshl_b32 s7, s4, 6
 s_add_u32 s6, s6, s7
 s_add_u32 s6, s6, 0x100f60
 v_add_u32 v103, s6, v96
 s_and_b32 s6, s3, 1
 s_lshl_b32 s6, s6, 8
 s_add_u32 s54, s6, s2
 s_mul_i32 s6, s54, 5462
 s_lshr_b32 s6, s6, 16
 s_mul_i32 s7, s6, 12
 s_sub_u32 s7, s54, s7
 s_mul_i32 s7, s7, 24576
 s_lshl_b32 s6, s6, 6
 s_add_u32 s94, s6, s7
 s_mul_i32 s6, s54, 1366
 s_lshr_b32 s6, s6, 16
 s_mul_i32 s7, s6, 48
 s_sub_u32 s7, s54, s7
 s_mul_i32 s7, s7, 6144
 s_lshl_b32 s6, s6, 6
 s_add_u32 s95, s6, s7
 s_lshl_b32 s6, s54, 10
 s_add_u32 s96, s6, 0x400000
 s_add_u32 s97, s6, 0x380000
 s_cmp_lt_u32 s3, 2
 s_cselect_b32 s94, s94, s95
 s_cselect_b32 s96, s96, s97
 s_cselect_b32 s28, s12, s16
 s_cselect_b32 s29, s13, s17
 s_mov_b32 s30, 294912
 s_mov_b32 s31, 0x20000
 s_mov_b32 s6, 1536
 s_cselect_b32 s95, s6, 384
 s_mov_b32 s6, 512
 s_cselect_b32 s97, s6, 256
 s_cselect_b32 s7, 2, 3
 s_cmp_lt_u32 s54, 288
 s_cselect_b32 s94, s94, 0x40000000
 s_cselect_b32 s96, s96, 0x40000000
 s_mul_i32 s98, s3, 3072
 s_add_u32 s98, s98, 147456
 v_lshrrev_b32 v96, 2, v1
 v_and_b32 v97, 3, v1
 v_lshlrev_b32 v97, 4, v97
 v_mul_lo_u32 v40, s95, v96
 v_add_u32 v40, v40, v97
 v_lshrrev_b32 v96, 5, v1
 v_lshlrev_b32_e64 v96, s7, v96
 v_bfe_u32 v97, v1, 2, 2
 v_add_u32_e64 v96, v96, v97
 v_bfe_u32 v98, v1, 4, 1
 v_and_b32 v99, 3, v1
 v_lshlrev_b32 v99, 3, v99
 v_lshl_add_u32 v99, v98, 5, v99
 v_lshl_add_u32 v96, v96, 6, v99
 v_add_u32 v42, s98, v96
 v_add_u32 v43, s97, v42
 v_lshlrev_b32 v77, 4, v1
 v_lshlrev_b32 v78, 3, v0
 s_mul_i32 s6, s2, 1152
 v_add_u32 v78, s6, v78
 v_mov_b32 v79, 0x40000000
 v_cmp_gt_u32 vcc, 48, v0
 s_nop 1
 v_cndmask_b32 v78, v79, v78, vcc
 s_mul_i32 s6, s2, 6
 v_mov_b32_e64 v79, s6
 s_lshr_b32 s6, s3, 1
 s_mul_i32 s99, s6, 24576
 s_mul_i32 s6, s6, 6
 s_add_u32 s6, s6, s56
 s_lshl_b32 s55, s6, 7
 s_and_b32 s6, s3, 1
 s_lshl_b32 s6, s6, 10
 s_add_u32 s99, s99, s6
 s_add_u32 s99, s99, 0
 s_waitcnt vmcnt(6)
 s_barrier
 ds_read_b128 a[0:3], v224 offset:0
 ds_read_b128 a[4:7], v225 offset:0
 ds_read_b128 a[8:11], v226 offset:0
 ds_read_b128 a[12:15], v227 offset:0
 ds_read_b128 a[16:19], v228 offset:0
 ds_read_b128 a[20:23], v229 offset:0
 ds_read_b128 a[24:27], v230 offset:0
 ds_read_b128 a[28:31], v231 offset:0
 ds_read_b128 a[32:35], v232 offset:0
 ds_read_b128 a[36:39], v233 offset:0
 ds_read_b128 a[40:43], v234 offset:0
 ds_read_b128 a[44:47], v235 offset:0
 ds_read_b128 a[48:51], v236 offset:0
 ds_read_b128 a[52:55], v237 offset:0
 ds_read_b128 a[56:59], v238 offset:0
 ds_read_b128 a[60:63], v239 offset:0
 ds_read_b128 a[64:67], v240 offset:0
 ds_read_b128 a[68:71], v241 offset:0
 s_waitcnt lgkmcnt(12)
 v_mfma_f32_16x16x32_bf16 v[176:179], v[104:107], a[0:3], 0
 v_mfma_f32_16x16x32_bf16 v[176:179], v[108:111], a[4:7], v[176:179]
 s_add_u32 s85, s48, 688128
 s_add_u32 m0, s49, 49152
 v_add_u32 v76, s85, v30
 buffer_load_dwordx4 v76, s[8:11], 0 offen lds
 v_mfma_f32_16x16x32_bf16 v[176:179], v[112:115], a[8:11], v[176:179]
 v_mfma_f32_16x16x32_bf16 v[180:183], v[116:119], a[12:15], 0
 s_add_u32 m0, s49, 50176
 v_add_u32_e64 v95, s85, v31
 buffer_load_dwordx4 v95, s[8:11], 0 offen lds
 v_mfma_f32_16x16x32_bf16 v[180:183], v[120:123], a[16:19], v[180:183]
 v_mfma_f32_16x16x32_bf16 v[180:183], v[124:127], a[20:23], v[180:183]
 s_add_u32 m0, s49, 51200
 v_add_u32_e64 v76, s85, v32
 buffer_load_dwordx4 v76, s[8:11], 0 offen lds
 s_waitcnt lgkmcnt(6)
 v_mfma_f32_16x16x32_bf16 v[184:187], v[128:131], a[24:27], 0
 s_waitcnt vmcnt(6)
 s_waitcnt lgkmcnt(0)
 s_barrier
 ds_read_b128 a[72:75], v224 offset:12288
 ds_read_b128 a[76:79], v225 offset:12288
 v_mfma_f32_16x16x32_bf16 v[184:187], v[132:135], a[28:31], v[184:187]
 ds_read_b128 a[80:83], v226 offset:12288
 ds_read_b128 a[84:87], v227 offset:12288
 s_mov_b32 m0, s98
 s_nop 0
 buffer_load_dwordx4 v40, s[28:31], s94 offen lds
 v_mfma_f32_16x16x32_bf16 v[184:187], v[136:139], a[32:35], v[184:187]
 ds_read_b128 a[88:91], v228 offset:12288
 ds_read_b128 a[92:95], v229 offset:12288
 v_mfma_f32_16x16x32_bf16 v[188:191], v[140:143], a[36:39], 0
 ds_read_b128 a[96:99], v230 offset:12288
 ds_read_b128 a[100:103], v231 offset:12288
 buffer_store_dwordx4 v[36:39], v101, s[24:27], 0 offen sc1
 v_mfma_f32_16x16x32_bf16 v[188:191], v[144:147], a[40:43], v[188:191]
 ds_read_b128 a[104:107], v232 offset:12288
 ds_read_b128 a[108:111], v233 offset:12288
 v_mfma_f32_16x16x32_bf16 v[188:191], v[148:151], a[44:47], v[188:191]
 ds_read_b128 a[112:115], v234 offset:12288
 ds_read_b128 a[116:119], v235 offset:12288
 buffer_store_dwordx4 v[36:39], v102, s[24:27], 0 offen sc1
 v_mfma_f32_16x16x32_bf16 v[192:195], v[152:155], a[48:51], 0
 ds_read_b128 a[120:123], v236 offset:12288
 v_mfma_f32_16x16x32_bf16 v[192:195], v[156:159], a[52:55], v[192:195]
 ds_read_b128 a[124:127], v237 offset:12288
 v_mfma_f32_16x16x32_bf16 v[192:195], v[160:163], a[56:59], v[192:195]
 ds_read_b128 a[128:131], v238 offset:12288
 v_mfma_f32_16x16x32_bf16 v[196:199], v[164:167], a[60:63], 0
 ds_read_b128 a[132:135], v239 offset:12288
 v_mfma_f32_16x16x32_bf16 v[196:199], v[168:171], a[64:67], v[196:199]
 ds_read_b128 a[136:139], v240 offset:12288
 v_mfma_f32_16x16x32_bf16 v[196:199], v[172:175], a[68:71], v[196:199]
 ds_read_b128 a[140:143], v241 offset:12288
 v_pk_add_f32 v[54:55], v[176:177], v[178:179]
 v_pk_mul_f32 v[56:57], v[176:177], v[176:177]
 v_pk_add_f32 v[96:97], v[180:181], v[182:183]
 v_pk_mul_f32 v[98:99], v[178:179], v[178:179]
 v_pk_fma_f32 v[56:57], v[180:181], v[180:181], v[56:57]
 v_pk_fma_f32 v[98:99], v[182:183], v[182:183], v[98:99]
 v_pk_add_f32 v[54:55], v[54:55], v[184:185]
 v_pk_fma_f32 v[56:57], v[184:185], v[184:185], v[56:57]
 v_pk_add_f32 v[96:97], v[96:97], v[186:187]
 v_pk_fma_f32 v[98:99], v[186:187], v[186:187], v[98:99]
 v_pk_add_f32 v[54:55], v[54:55], v[188:189]
 v_pk_fma_f32 v[56:57], v[188:189], v[188:189], v[56:57]
 v_pk_add_f32 v[96:97], v[96:97], v[190:191]
 v_pk_fma_f32 v[98:99], v[190:191], v[190:191], v[98:99]
 v_pk_add_f32 v[54:55], v[54:55], v[192:193]
 v_pk_fma_f32 v[56:57], v[192:193], v[192:193], v[56:57]
 v_pk_add_f32 v[96:97], v[96:97], v[194:195]
 v_pk_fma_f32 v[98:99], v[194:195], v[194:195], v[98:99]
 v_pk_add_f32 v[54:55], v[54:55], v[196:197]
 v_pk_fma_f32 v[56:57], v[196:197], v[196:197], v[56:57]
 v_pk_add_f32 v[96:97], v[96:97], v[198:199]
 v_pk_fma_f32 v[98:99], v[198:199], v[198:199], v[98:99]
 v_pk_add_f32 v[54:55], v[54:55], v[96:97]
 v_pk_add_f32 v[56:57], v[56:57], v[98:99]
 v_add_f32 v54, v54, v55
 v_add_f32 v56, v56, v57
 s_nop 1
 v_permlane32_swap_b32 v54, v56
 v_add_f32 v54, v54, v56
 ds_write_b32 v74, v54 offset:0
 v_cmp_le_u32 vcc, 32, v72
 v_mov_b32 v58, 110080
 v_mov_b32 v59, 98304
 v_cndmask_b32_e64 v58, v59, v58, vcc
 v_add_u32 v58, v58, v73
 s_waitcnt lgkmcnt(13)
 v_mfma_f32_16x16x32_bf16 v[200:203], v[104:107], a[72:75], 0
 v_mfma_f32_16x16x32_bf16 v[200:203], v[108:111], a[76:79], v[200:203]
 s_add_u32 s85, s48, 860160
 s_add_u32 m0, s49, 61440
 v_add_u32_e64 v76, s85, v30
 buffer_load_dwordx4 v76, s[8:11], 0 offen lds
 v_mfma_f32_16x16x32_bf16 v[200:203], v[112:115], a[80:83], v[200:203]
 v_mfma_f32_16x16x32_bf16 v[204:207], v[116:119], a[84:87], 0
 s_add_u32 m0, s49, 62464
 v_add_u32_e64 v95, s85, v31
 buffer_load_dwordx4 v95, s[8:11], 0 offen lds
 v_mfma_f32_16x16x32_bf16 v[204:207], v[120:123], a[88:91], v[204:207]
 v_mfma_f32_16x16x32_bf16 v[204:207], v[124:127], a[92:95], v[204:207]
 s_add_u32 m0, s49, 63488
 v_add_u32_e64 v76, s85, v32
 buffer_load_dwordx4 v76, s[8:11], 0 offen lds
 s_waitcnt lgkmcnt(7)
 v_mfma_f32_16x16x32_bf16 v[208:211], v[128:131], a[96:99], 0
 s_waitcnt vmcnt(9)
 s_waitcnt lgkmcnt(0)
 s_barrier
 ds_read_b128 v[44:47], v75 offset:0
 ds_read_b128 v[48:51], v75 offset:512
 ds_read_b128 a[0:3], v224 offset:24576
 ds_read_b128 a[4:7], v225 offset:24576
 v_mfma_f32_16x16x32_bf16 v[208:211], v[132:135], a[100:103], v[208:211]
 ds_read_b128 a[8:11], v226 offset:24576
 ds_read_b128 a[12:15], v227 offset:24576
 v_mfma_f32_16x16x32_bf16 v[208:211], v[136:139], a[104:107], v[208:211]
 ds_read_b128 a[16:19], v228 offset:24576
 ds_read_b128 a[20:23], v229 offset:24576
 v_mfma_f32_16x16x32_bf16 v[212:215], v[140:143], a[108:111], 0
 ds_read_b128 a[24:27], v230 offset:24576
 ds_read_b128 a[28:31], v231 offset:24576
 v_mfma_f32_16x16x32_bf16 v[212:215], v[144:147], a[112:115], v[212:215]
 ds_read_b128 a[32:35], v232 offset:24576
 ds_read_b128 a[36:39], v233 offset:24576
 v_mfma_f32_16x16x32_bf16 v[212:215], v[148:151], a[116:119], v[212:215]
 ds_read_b128 a[40:43], v234 offset:24576
 ds_read_b128 a[44:47], v235 offset:24576
 v_mfma_f32_16x16x32_bf16 v[216:219], v[152:155], a[120:123], 0
 ds_read_b128 a[48:51], v236 offset:24576
 v_mfma_f32_16x16x32_bf16 v[216:219], v[156:159], a[124:127], v[216:219]
 ds_read_b128 a[52:55], v237 offset:24576
 v_mfma_f32_16x16x32_bf16 v[216:219], v[160:163], a[128:131], v[216:219]
 ds_read_b128 a[56:59], v238 offset:24576
 v_mfma_f32_16x16x32_bf16 v[220:223], v[164:167], a[132:135], 0
 ds_read_b128 a[60:63], v239 offset:24576
 v_mfma_f32_16x16x32_bf16 v[220:223], v[168:171], a[136:139], v[220:223]
 ds_read_b128 a[64:67], v240 offset:24576
 v_mfma_f32_16x16x32_bf16 v[220:223], v[172:175], a[140:143], v[220:223]
 ds_read_b128 a[68:71], v241 offset:24576
 s_waitcnt lgkmcnt(15)
 v_add_f32 v44, v44, v45
 v_add_f32 v48, v48, v49
 v_add_f32 v46, v46, v47
 v_add_f32 v50, v50, v51
 v_add_f32 v44, v44, v46
 v_add_f32_e64 v48, v48, v50
 v_mul_f32 v44, 0x3baaaaab, v44
 v_mul_f32 v48, 0x3baaaaab, v48
 v_pk_add_f32 v[54:55], v[200:201], v[202:203]
 v_pk_mul_f32 v[56:57], v[200:201], v[200:201]
 v_fma_f32 v48, -v44, v44, v48
 v_pk_add_f32 v[96:97], v[204:205], v[206:207]
 v_pk_mul_f32 v[98:99], v[202:203], v[202:203]
 v_max_f32_e64 v48, 0, v48
 v_pk_fma_f32 v[56:57], v[204:205], v[204:205], v[56:57]
 v_pk_fma_f32 v[98:99], v[206:207], v[206:207], v[98:99]
 v_add_f32 v48, 0x3727c5ac, v48
 v_pk_add_f32 v[54:55], v[54:55], v[208:209]
 v_pk_fma_f32 v[56:57], v[208:209], v[208:209], v[56:57]
 v_rsq_f32_e64 v48, v48
 v_pk_add_f32 v[96:97], v[96:97], v[210:211]
 v_pk_fma_f32 v[98:99], v[210:211], v[210:211], v[98:99]
 v_sub_f32_e64 v44, 0, v44
 v_pk_add_f32 v[54:55], v[54:55], v[212:213]
 v_pk_fma_f32 v[56:57], v[212:213], v[212:213], v[56:57]
 v_mul_f32 v52, 0xbeeff558, v48
 v_pk_add_f32 v[96:97], v[96:97], v[214:215]
 v_pk_fma_f32 v[98:99], v[214:215], v[214:215], v[98:99]
 v_mul_f32_e64 v53, v44, v52
 v_pk_add_f32 v[54:55], v[54:55], v[216:217]
 v_pk_fma_f32 v[56:57], v[216:217], v[216:217], v[56:57]
 v_pk_add_f32 v[96:97], v[96:97], v[218:219]
 v_pk_fma_f32 v[98:99], v[218:219], v[218:219], v[98:99]
 v_pk_add_f32 v[54:55], v[54:55], v[220:221]
 v_pk_fma_f32 v[56:57], v[220:221], v[220:221], v[56:57]
 v_pk_add_f32 v[96:97], v[96:97], v[222:223]
 v_pk_fma_f32 v[98:99], v[222:223], v[222:223], v[98:99]
 v_pk_add_f32 v[54:55], v[54:55], v[96:97]
 v_pk_add_f32 v[56:57], v[56:57], v[98:99]
 v_add_f32 v54, v54, v55
 v_add_f32 v56, v56, v57
 s_nop 1
 v_permlane32_swap_b32 v54, v56
 v_add_f32_e64 v54, v54, v56
 ds_write_b32 v74, v54 offset:1024
 s_waitcnt vmcnt(5)
 ds_read_b64_tr_b16 v[8:9], v42
 ds_read_b64_tr_b16 v[10:11], v43
 s_waitcnt lgkmcnt(0)
 buffer_store_dwordx4 v[8:11], v77, s[24:27], s96 offen sc1
 v_pk_fma_f32 v[176:177], v[176:177], v[52:53], v[52:53] op_sel:[0,0,1] op_sel_hi:[1,0,1]
 v_pk_fma_f32 v[178:179], v[178:179], v[52:53], v[52:53] op_sel:[0,0,1] op_sel_hi:[1,0,1]
 v_pk_fma_f32 v[180:181], v[180:181], v[52:53], v[52:53] op_sel:[0,0,1] op_sel_hi:[1,0,1]
 v_pk_fma_f32 v[182:183], v[182:183], v[52:53], v[52:53] op_sel:[0,0,1] op_sel_hi:[1,0,1]
 v_pk_fma_f32 v[184:185], v[184:185], v[52:53], v[52:53] op_sel:[0,0,1] op_sel_hi:[1,0,1]
 v_pk_fma_f32 v[186:187], v[186:187], v[52:53], v[52:53] op_sel:[0,0,1] op_sel_hi:[1,0,1]
 v_pk_fma_f32 v[188:189], v[188:189], v[52:53], v[52:53] op_sel:[0,0,1] op_sel_hi:[1,0,1]
 v_pk_fma_f32 v[190:191], v[190:191], v[52:53], v[52:53] op_sel:[0,0,1] op_sel_hi:[1,0,1]
 v_pk_fma_f32 v[192:193], v[192:193], v[52:53], v[52:53] op_sel:[0,0,1] op_sel_hi:[1,0,1]
 v_pk_fma_f32 v[194:195], v[194:195], v[52:53], v[52:53] op_sel:[0,0,1] op_sel_hi:[1,0,1]
 v_pk_fma_f32 v[196:197], v[196:197], v[52:53], v[52:53] op_sel:[0,0,1] op_sel_hi:[1,0,1]
 v_pk_fma_f32 v[198:199], v[198:199], v[52:53], v[52:53] op_sel:[0,0,1] op_sel_hi:[1,0,1]
 v_cvt_pk_bf16_f32 v60, v176, v177
 v_cvt_pk_bf16_f32 v61, v178, v179
 v_cvt_pk_bf16_f32 v62, v180, v181
 v_cvt_pk_bf16_f32 v63, v182, v183
 v_cvt_pk_bf16_f32 v64, v184, v185
 v_cvt_pk_bf16_f32 v65, v186, v187
 v_cvt_pk_bf16_f32 v66, v188, v189
 v_cvt_pk_bf16_f32 v67, v190, v191
 v_cvt_pk_bf16_f32 v68, v192, v193
 v_cvt_pk_bf16_f32 v69, v194, v195
 v_cvt_pk_bf16_f32 v70, v196, v197
 v_cvt_pk_bf16_f32 v71, v198, v199
 s_mov_b64 exec, s[88:89]
 ds_write_b128 v58, v[60:63] offset:0
 ds_write_b128 v58, v[64:67] offset:1024
 ds_write_b128 v58, v[68:71] offset:2048
 s_mov_b64 exec, -1
 v_cmp_le_u32 vcc, 4, v72
 v_mov_b32 v58, 110528
 v_mov_b32 v59, 98752
 v_cndmask_b32 v58, v59, v58, vcc
 v_add_u32_e64 v58, v58, v73
 v_mfma_f32_16x16x32_bf16 v[176:179], v[104:107], a[0:3], 0
 v_mfma_f32_16x16x32_bf16 v[176:179], v[108:111], a[4:7], v[176:179]
 s_add_u32 s85, s48, 1032192
 s_add_u32 m0, s49, 73728
 v_add_u32_e64 v76, s85, v30
 buffer_load_dwordx4 v76, s[8:11], 0 offen lds
 v_mfma_f32_16x16x32_bf16 v[176:179], v[112:115], a[8:11], v[176:179]
 v_mfma_f32_16x16x32_bf16 v[180:183], v[116:119], a[12:15], 0
 s_add_u32 m0, s49, 74752
 v_add_u32_e64 v95, s85, v31
 buffer_load_dwordx4 v95, s[8:11], 0 offen lds
 v_mfma_f32_16x16x32_bf16 v[180:183], v[120:123], a[16:19], v[180:183]
 v_mfma_f32_16x16x32_bf16 v[180:183], v[124:127], a[20:23], v[180:183]
 s_add_u32 m0, s49, 75776
 v_add_u32_e64 v76, s85, v32
 buffer_load_dwordx4 v76, s[8:11], 0 offen lds
 v_mfma_f32_16x16x32_bf16 v[184:187], v[128:131], a[24:27], 0
 s_waitcnt lgkmcnt(0)
 s_barrier
 ds_read_b128 v[44:47], v75 offset:1024
 ds_read_b128 v[48:51], v75 offset:1536
 ds_read_b128 a[72:75], v224 offset:36864
 ds_read_b128 a[76:79], v225 offset:36864
 v_mfma_f32_16x16x32_bf16 v[184:187], v[132:135], a[28:31], v[184:187]
 ds_read_b128 a[80:83], v226 offset:36864
 ds_read_b128 a[84:87], v227 offset:36864
 v_mfma_f32_16x16x32_bf16 v[184:187], v[136:139], a[32:35], v[184:187]
 ds_read_b128 a[88:91], v228 offset:36864
 ds_read_b128 a[92:95], v229 offset:36864
 v_mfma_f32_16x16x32_bf16 v[188:191], v[140:143], a[36:39], 0
 ds_read_b128 a[96:99], v230 offset:36864
 ds_read_b128 a[100:103], v231 offset:36864
 v_mfma_f32_16x16x32_bf16 v[188:191], v[144:147], a[40:43], v[188:191]
 ds_read_b128 a[104:107], v232 offset:36864
 ds_read_b128 a[108:111], v233 offset:36864
 v_mfma_f32_16x16x32_bf16 v[188:191], v[148:151], a[44:47], v[188:191]
 ds_read_b128 a[112:115], v234 offset:36864
 ds_read_b128 a[116:119], v235 offset:36864
 v_mfma_f32_16x16x32_bf16 v[192:195], v[152:155], a[48:51], 0
 ds_read_b128 a[120:123], v236 offset:36864
 v_mfma_f32_16x16x32_bf16 v[192:195], v[156:159], a[52:55], v[192:195]
 ds_read_b128 a[124:127], v237 offset:36864
 v_mfma_f32_16x16x32_bf16 v[192:195], v[160:163], a[56:59], v[192:195]
 ds_read_b128 a[128:131], v238 offset:36864
 v_mfma_f32_16x16x32_bf16 v[196:199], v[164:167], a[60:63], 0
 ds_read_b128 a[132:135], v239 offset:36864
 v_mfma_f32_16x16x32_bf16 v[196:199], v[168:171], a[64:67], v[196:199]
 ds_read_b128 a[136:139], v240 offset:36864
 v_mfma_f32_16x16x32_bf16 v[196:199], v[172:175], a[68:71], v[196:199]
 ds_read_b128 a[140:143], v241 offset:36864
 s_waitcnt lgkmcnt(15)
 v_add_f32 v44, v44, v45
 v_add_f32 v48, v48, v49
 v_add_f32 v46, v46, v47
 v_add_f32 v50, v50, v51
 v_add_f32 v44, v44, v46
 v_add_f32_e64 v48, v48, v50
 v_mul_f32 v44, 0x3baaaaab, v44
 v_mul_f32 v48, 0x3baaaaab, v48
 v_pk_add_f32 v[54:55], v[176:177], v[178:179]
 v_pk_mul_f32 v[56:57], v[176:177], v[176:177]
 v_fma_f32 v48, -v44, v44, v48
 v_pk_add_f32 v[96:97], v[180:181], v[182:183]
 v_pk_mul_f32 v[98:99], v[178:179], v[178:179]
 v_max_f32_e64 v48, 0, v48
 v_pk_fma_f32 v[56:57], v[180:181], v[180:181], v[56:57]
 v_pk_fma_f32 v[98:99], v[182:183], v[182:183], v[98:99]
 v_add_f32 v48, 0x3727c5ac, v48
 v_pk_add_f32 v[54:55], v[54:55], v[184:185]
 v_pk_fma_f32 v[56:57], v[184:185], v[184:185], v[56:57]
 v_rsq_f32_e64 v48, v48
 v_pk_add_f32 v[96:97], v[96:97], v[186:187]
 v_pk_fma_f32 v[98:99], v[186:187], v[186:187], v[98:99]
 v_sub_f32_e64 v44, 0, v44
 v_pk_add_f32 v[54:55], v[54:55], v[188:189]
 v_pk_fma_f32 v[56:57], v[188:189], v[188:189], v[56:57]
 v_mul_f32 v52, 0xbeeff558, v48
 v_pk_add_f32 v[96:97], v[96:97], v[190:191]
 v_pk_fma_f32 v[98:99], v[190:191], v[190:191], v[98:99]
 v_mul_f32_e64 v53, v44, v52
 v_pk_add_f32 v[54:55], v[54:55], v[192:193]
 v_pk_fma_f32 v[56:57], v[192:193], v[192:193], v[56:57]
 v_pk_add_f32 v[96:97], v[96:97], v[194:195]
 v_pk_fma_f32 v[98:99], v[194:195], v[194:195], v[98:99]
 v_pk_add_f32 v[54:55], v[54:55], v[196:197]
 v_pk_fma_f32 v[56:57], v[196:197], v[196:197], v[56:57]
 v_pk_add_f32 v[96:97], v[96:97], v[198:199]
 v_pk_fma_f32 v[98:99], v[198:199], v[198:199], v[98:99]
 v_pk_add_f32 v[54:55], v[54:55], v[96:97]
 v_pk_add_f32 v[56:57], v[56:57], v[98:99]
 v_add_f32 v54, v54, v55
 v_add_f32 v56, v56, v57
 s_nop 1
 v_permlane32_swap_b32 v54, v56
 v_add_f32_e64 v54, v54, v56
 ds_write_b32 v74, v54 offset:0
 v_pk_fma_f32 v[200:201], v[200:201], v[52:53], v[52:53] op_sel:[0,0,1] op_sel_hi:[1,0,1]
 v_pk_fma_f32 v[202:203], v[202:203], v[52:53], v[52:53] op_sel:[0,0,1] op_sel_hi:[1,0,1]
 v_pk_fma_f32 v[204:205], v[204:205], v[52:53], v[52:53] op_sel:[0,0,1] op_sel_hi:[1,0,1]
 v_pk_fma_f32 v[206:207], v[206:207], v[52:53], v[52:53] op_sel:[0,0,1] op_sel_hi:[1,0,1]
 v_pk_fma_f32 v[208:209], v[208:209], v[52:53], v[52:53] op_sel:[0,0,1] op_sel_hi:[1,0,1]
 v_pk_fma_f32 v[210:211], v[210:211], v[52:53], v[52:53] op_sel:[0,0,1] op_sel_hi:[1,0,1]
 v_pk_fma_f32 v[212:213], v[212:213], v[52:53], v[52:53] op_sel:[0,0,1] op_sel_hi:[1,0,1]
 v_pk_fma_f32 v[214:215], v[214:215], v[52:53], v[52:53] op_sel:[0,0,1] op_sel_hi:[1,0,1]
 v_pk_fma_f32 v[216:217], v[216:217], v[52:53], v[52:53] op_sel:[0,0,1] op_sel_hi:[1,0,1]
 v_pk_fma_f32 v[218:219], v[218:219], v[52:53], v[52:53] op_sel:[0,0,1] op_sel_hi:[1,0,1]
 v_pk_fma_f32 v[220:221], v[220:221], v[52:53], v[52:53] op_sel:[0,0,1] op_sel_hi:[1,0,1]
 v_pk_fma_f32 v[222:223], v[222:223], v[52:53], v[52:53] op_sel:[0,0,1] op_sel_hi:[1,0,1]
 v_cvt_pk_bf16_f32 v60, v200, v201
 v_cvt_pk_bf16_f32 v61, v202, v203
 v_cvt_pk_bf16_f32 v62, v204, v205
 v_cvt_pk_bf16_f32 v63, v206, v207
 v_cvt_pk_bf16_f32 v64, v208, v209
 v_cvt_pk_bf16_f32 v65, v210, v211
 v_cvt_pk_bf16_f32 v66, v212, v213
 v_cvt_pk_bf16_f32 v67, v214, v215
 v_cvt_pk_bf16_f32 v68, v216, v217
 v_cvt_pk_bf16_f32 v69, v218, v219
 v_cvt_pk_bf16_f32 v70, v220, v221
 v_cvt_pk_bf16_f32 v71, v222, v223
 s_mov_b64 exec, s[88:89]
 ds_write_b128 v58, v[60:63] offset:0
 ds_write_b128 v58, v[64:67] offset:1024
 ds_write_b128 v58, v[68:71] offset:2048
 s_mov_b64 exec, -1
 v_cmp_le_u32 vcc, 8, v72
 v_mov_b32 v58, 122752
 v_mov_b32 v59, 110976
 v_cndmask_b32 v58, v59, v58, vcc
 v_add_u32 v58, v58, v73
 s_waitcnt lgkmcnt(15)
 v_mfma_f32_16x16x32_bf16 v[200:203], v[104:107], a[72:75], 0
 v_mfma_f32_16x16x32_bf16 v[200:203], v[108:111], a[76:79], v[200:203]
 s_add_u32 s85, s48, 1204224
 s_cmp_eq_u32 s46, 15
 s_cselect_b32 s86, s63, 0
 s_cmp_eq_u32 s86, 1
 s_cselect_b32 s85, 0x40000000, s85
 s_add_u32 m0, s49, 86016
 v_add_u32_e64 v76, s85, v30
 buffer_load_dwordx4 v76, s[8:11], 0 offen lds
 v_mfma_f32_16x16x32_bf16 v[200:203], v[112:115], a[80:83], v[200:203]
 v_mfma_f32_16x16x32_bf16 v[204:207], v[116:119], a[84:87], 0
 s_add_u32 m0, s49, 87040
 v_add_u32_e64 v95, s85, v31
 buffer_load_dwordx4 v95, s[8:11], 0 offen lds
 v_mfma_f32_16x16x32_bf16 v[204:207], v[120:123], a[88:91], v[204:207]
 v_mfma_f32_16x16x32_bf16 v[204:207], v[124:127], a[92:95], v[204:207]
 s_add_u32 m0, s49, 88064
 v_add_u32_e64 v76, s85, v32
 buffer_load_dwordx4 v76, s[8:11], 0 offen lds
 s_waitcnt lgkmcnt(10)
 v_mfma_f32_16x16x32_bf16 v[208:211], v[128:131], a[96:99], 0
 s_waitcnt vmcnt(7)
 s_waitcnt lgkmcnt(0)
 s_barrier
 ds_read_b128 v[44:47], v75 offset:0
 ds_read_b128 v[48:51], v75 offset:512
 ds_read_b128 a[0:3], v224 offset:49152
 ds_read_b128 a[4:7], v225 offset:49152
 v_mfma_f32_16x16x32_bf16 v[208:211], v[132:135], a[100:103], v[208:211]
 ds_read_b128 a[8:11], v226 offset:49152
 ds_read_b128 a[12:15], v227 offset:49152
 v_mfma_f32_16x16x32_bf16 v[208:211], v[136:139], a[104:107], v[208:211]
 ds_read_b128 a[16:19], v228 offset:49152
 ds_read_b128 a[20:23], v229 offset:49152
 v_mfma_f32_16x16x32_bf16 v[212:215], v[140:143], a[108:111], 0
 ds_read_b128 a[24:27], v230 offset:49152
 ds_read_b128 a[28:31], v231 offset:49152
 v_mfma_f32_16x16x32_bf16 v[212:215], v[144:147], a[112:115], v[212:215]
 ds_read_b128 a[32:35], v232 offset:49152
 ds_read_b128 a[36:39], v233 offset:49152
 v_mfma_f32_16x16x32_bf16 v[212:215], v[148:151], a[116:119], v[212:215]
 ds_read_b128 a[40:43], v234 offset:49152
 ds_read_b128 a[44:47], v235 offset:49152
 v_mfma_f32_16x16x32_bf16 v[216:219], v[152:155], a[120:123], 0
 ds_read_b128 a[48:51], v236 offset:49152
 v_mfma_f32_16x16x32_bf16 v[216:219], v[156:159], a[124:127], v[216:219]
 ds_read_b128 a[52:55], v237 offset:49152
 v_mfma_f32_16x16x32_bf16 v[216:219], v[160:163], a[128:131], v[216:219]
 ds_read_b128 a[56:59], v238 offset:49152
 v_mfma_f32_16x16x32_bf16 v[220:223], v[164:167], a[132:135], 0
 ds_read_b128 a[60:63], v239 offset:49152
 v_mfma_f32_16x16x32_bf16 v[220:223], v[168:171], a[136:139], v[220:223]
 ds_read_b128 a[64:67], v240 offset:49152
 v_mfma_f32_16x16x32_bf16 v[220:223], v[172:175], a[140:143], v[220:223]
 ds_read_b128 a[68:71], v241 offset:49152
 s_waitcnt lgkmcnt(15)
 v_add_f32 v44, v44, v45
 v_add_f32 v48, v48, v49
 v_add_f32 v46, v46, v47
 v_add_f32 v50, v50, v51
 v_add_f32 v44, v44, v46
 v_add_f32_e64 v48, v48, v50
 v_mul_f32 v44, 0x3baaaaab, v44
 v_mul_f32 v48, 0x3baaaaab, v48
 v_pk_add_f32 v[54:55], v[200:201], v[202:203]
 v_pk_mul_f32 v[56:57], v[200:201], v[200:201]
 v_fma_f32 v48, -v44, v44, v48
 v_pk_add_f32 v[96:97], v[204:205], v[206:207]
 v_pk_mul_f32 v[98:99], v[202:203], v[202:203]
 v_max_f32_e64 v48, 0, v48
 v_pk_fma_f32 v[56:57], v[204:205], v[204:205], v[56:57]
 v_pk_fma_f32 v[98:99], v[206:207], v[206:207], v[98:99]
 v_add_f32 v48, 0x3727c5ac, v48
 v_pk_add_f32 v[54:55], v[54:55], v[208:209]
 v_pk_fma_f32 v[56:57], v[208:209], v[208:209], v[56:57]
 v_rsq_f32_e64 v48, v48
 v_pk_add_f32 v[96:97], v[96:97], v[210:211]
 v_pk_fma_f32 v[98:99], v[210:211], v[210:211], v[98:99]
 v_sub_f32_e64 v44, 0, v44
 v_pk_add_f32 v[54:55], v[54:55], v[212:213]
 v_pk_fma_f32 v[56:57], v[212:213], v[212:213], v[56:57]
 v_mul_f32 v52, 0xbeeff558, v48
 v_pk_add_f32 v[96:97], v[96:97], v[214:215]
 v_pk_fma_f32 v[98:99], v[214:215], v[214:215], v[98:99]
 v_mul_f32_e64 v53, v44, v52
 v_pk_add_f32 v[54:55], v[54:55], v[216:217]
 v_pk_fma_f32 v[56:57], v[216:217], v[216:217], v[56:57]
 v_pk_add_f32 v[96:97], v[96:97], v[218:219]
 v_pk_fma_f32 v[98:99], v[218:219], v[218:219], v[98:99]
 v_pk_add_f32 v[54:55], v[54:55], v[220:221]
 v_pk_fma_f32 v[56:57], v[220:221], v[220:221], v[56:57]
 v_pk_add_f32 v[96:97], v[96:97], v[222:223]
 v_pk_fma_f32 v[98:99], v[222:223], v[222:223], v[98:99]
 v_pk_add_f32 v[54:55], v[54:55], v[96:97]
 v_pk_add_f32 v[56:57], v[56:57], v[98:99]
 v_add_f32 v54, v54, v55
 v_add_f32 v56, v56, v57
 s_nop 1
 v_permlane32_swap_b32 v54, v56
 v_add_f32_e64 v54, v54, v56
 ds_write_b32 v74, v54 offset:1024
 v_pk_fma_f32 v[176:177], v[176:177], v[52:53], v[52:53] op_sel:[0,0,1] op_sel_hi:[1,0,1]
 v_pk_fma_f32 v[178:179], v[178:179], v[52:53], v[52:53] op_sel:[0,0,1] op_sel_hi:[1,0,1]
 v_pk_fma_f32 v[180:181], v[180:181], v[52:53], v[52:53] op_sel:[0,0,1] op_sel_hi:[1,0,1]
 v_pk_fma_f32 v[182:183], v[182:183], v[52:53], v[52:53] op_sel:[0,0,1] op_sel_hi:[1,0,1]
 v_pk_fma_f32 v[184:185], v[184:185], v[52:53], v[52:53] op_sel:[0,0,1] op_sel_hi:[1,0,1]
 v_pk_fma_f32 v[186:187], v[186:187], v[52:53], v[52:53] op_sel:[0,0,1] op_sel_hi:[1,0,1]
 v_pk_fma_f32 v[188:189], v[188:189], v[52:53], v[52:53] op_sel:[0,0,1] op_sel_hi:[1,0,1]
 v_pk_fma_f32 v[190:191], v[190:191], v[52:53], v[52:53] op_sel:[0,0,1] op_sel_hi:[1,0,1]
 v_pk_fma_f32 v[192:193], v[192:193], v[52:53], v[52:53] op_sel:[0,0,1] op_sel_hi:[1,0,1]
 v_pk_fma_f32 v[194:195], v[194:195], v[52:53], v[52:53] op_sel:[0,0,1] op_sel_hi:[1,0,1]
 v_pk_fma_f32 v[196:197], v[196:197], v[52:53], v[52:53] op_sel:[0,0,1] op_sel_hi:[1,0,1]
 v_pk_fma_f32 v[198:199], v[198:199], v[52:53], v[52:53] op_sel:[0,0,1] op_sel_hi:[1,0,1]
 v_cvt_pk_bf16_f32 v60, v176, v177
 v_cvt_pk_bf16_f32 v61, v178, v179
 v_cvt_pk_bf16_f32 v62, v180, v181
 v_cvt_pk_bf16_f32 v63, v182, v183
 v_cvt_pk_bf16_f32 v64, v184, v185
 v_cvt_pk_bf16_f32 v65, v186, v187
 v_cvt_pk_bf16_f32 v66, v188, v189
 v_cvt_pk_bf16_f32 v67, v190, v191
 v_cvt_pk_bf16_f32 v68, v192, v193
 v_cvt_pk_bf16_f32 v69, v194, v195
 v_cvt_pk_bf16_f32 v70, v196, v197
 v_cvt_pk_bf16_f32 v71, v198, v199
 s_mov_b64 exec, s[88:89]
 ds_write_b128 v58, v[60:63] offset:0
 ds_write_b128 v58, v[64:67] offset:1024
 ds_write_b128 v58, v[68:71] offset:2048
 s_mov_b64 exec, -1
 v_cmp_le_u32 vcc, 12, v72
 v_mov_b32 v58, 134976
 v_mov_b32 v59, 123200
 v_cndmask_b32 v58, v59, v58, vcc
 v_add_u32 v58, v58, v73
 s_waitcnt lgkmcnt(15)
 v_mfma_f32_16x16x32_bf16 v[176:179], v[104:107], a[0:3], 0
 v_mfma_f32_16x16x32_bf16 v[176:179], v[108:111], a[4:7], v[176:179]
 buffer_load_dwordx2 v[80:81], v78, s[16:19], 0 offen offset:0
 v_mfma_f32_16x16x32_bf16 v[176:179], v[112:115], a[8:11], v[176:179]
 v_mfma_f32_16x16x32_bf16 v[180:183], v[116:119], a[12:15], 0
 buffer_load_dwordx2 v[82:83], v78, s[16:19], 0 offen offset:384
 v_mfma_f32_16x16x32_bf16 v[180:183], v[120:123], a[16:19], v[180:183]
 v_mfma_f32_16x16x32_bf16 v[180:183], v[124:127], a[20:23], v[180:183]
 buffer_load_dwordx2 v[84:85], v78, s[16:19], 0 offen offset:768
 s_waitcnt lgkmcnt(10)
 v_mfma_f32_16x16x32_bf16 v[184:187], v[128:131], a[24:27], 0
 s_waitcnt vmcnt(6)
 s_waitcnt lgkmcnt(0)
 s_barrier
 ds_read_b128 v[44:47], v75 offset:1024
 ds_read_b128 v[48:51], v75 offset:1536
 s_and_b32 s7, s2, 3
 s_lshl_b32 s7, s7, 6
 s_cmp_eq_u32 s3, 0
 s_cselect_b32 s6, s7, 0x40000000
 v_mov_b32 v36, s6
 v_mov_b32 v37, 1
 s_mov_b64 exec, 1
 buffer_atomic_add v37, v36, s[40:43], 0 offen
 s_mov_b64 exec, -1
 ds_read_b128 a[72:75], v224 offset:61440
 ds_read_b128 a[76:79], v225 offset:61440
 v_mfma_f32_16x16x32_bf16 v[184:187], v[132:135], a[28:31], v[184:187]
 ds_read_b128 a[80:83], v226 offset:61440
 ds_read_b128 a[84:87], v227 offset:61440
 s_add_u32 m0, s99, 0
 s_add_u32 s6, s55, 0
 buffer_load_dwordx4 v5, s[12:15], s6 offen lds
 v_mfma_f32_16x16x32_bf16 v[184:187], v[136:139], a[32:35], v[184:187]
 ds_read_b128 a[88:91], v228 offset:61440
 ds_read_b128 a[92:95], v229 offset:61440
 v_mfma_f32_16x16x32_bf16 v[188:191], v[140:143], a[36:39], 0
 ds_read_b128 a[96:99], v230 offset:61440
 ds_read_b128 a[100:103], v231 offset:61440
 s_add_u32 m0, s99, 2048
 s_add_u32 s6, s55, 24576
 buffer_load_dwordx4 v5, s[12:15], s6 offen lds
 v_mfma_f32_16x16x32_bf16 v[188:191], v[144:147], a[40:43], v[188:191]
 ds_read_b128 a[104:107], v232 offset:61440
 ds_read_b128 a[108:111], v233 offset:61440
 v_mfma_f32_16x16x32_bf16 v[188:191], v[148:151], a[44:47], v[188:191]
 ds_read_b128 a[112:115], v234 offset:61440
 ds_read_b128 a[116:119], v235 offset:61440
 s_add_u32 m0, s99, 4096
 s_add_u32 s6, s55, 49152
 buffer_load_dwordx4 v5, s[12:15], s6 offen lds
 v_mfma_f32_16x16x32_bf16 v[192:195], v[152:155], a[48:51], 0
 ds_read_b128 a[120:123], v236 offset:61440
 v_mfma_f32_16x16x32_bf16 v[192:195], v[156:159], a[52:55], v[192:195]
 ds_read_b128 a[124:127], v237 offset:61440
 s_add_u32 m0, s99, 6144
 s_add_u32 s6, s55, 73728
 buffer_load_dwordx4 v5, s[12:15], s6 offen lds
 v_mfma_f32_16x16x32_bf16 v[192:195], v[160:163], a[56:59], v[192:195]
 ds_read_b128 a[128:131], v238 offset:61440
 v_mfma_f32_16x16x32_bf16 v[196:199], v[164:167], a[60:63], 0
 ds_read_b128 a[132:135], v239 offset:61440
 s_add_u32 m0, s99, 8192
 s_add_u32 s6, s55, 98304
 buffer_load_dwordx4 v5, s[12:15], s6 offen lds
 v_mfma_f32_16x16x32_bf16 v[196:199], v[168:171], a[64:67], v[196:199]
 ds_read_b128 a[136:139], v240 offset:61440
 v_mfma_f32_16x16x32_bf16 v[196:199], v[172:175], a[68:71], v[196:199]
 ds_read_b128 a[140:143], v241 offset:61440
 s_add_u32 m0, s99, 10240
 s_add_u32 s6, s55, 122880
 buffer_load_dwordx4 v5, s[12:15], s6 offen lds
 s_waitcnt lgkmcnt(15)
 v_add_f32 v44, v44, v45
 v_add_f32 v48, v48, v49
 v_add_f32 v46, v46, v47
 v_add_f32 v50, v50, v51
 v_add_f32 v44, v44, v46
 v_add_f32_e64 v48, v48, v50
 v_mul_f32 v44, 0x3baaaaab, v44
 v_mul_f32 v48, 0x3baaaaab, v48
 v_pk_add_f32 v[54:55], v[176:177], v[178:179]
 v_pk_mul_f32 v[56:57], v[176:177], v[176:177]
 v_fma_f32 v48, -v44, v44, v48
 v_pk_add_f32 v[96:97], v[180:181], v[182:183]
 v_pk_mul_f32 v[98:99], v[178:179], v[178:179]
 v_max_f32_e64 v48, 0, v48
 v_pk_fma_f32 v[56:57], v[180:181], v[180:181], v[56:57]
 v_pk_fma_f32 v[98:99], v[182:183], v[182:183], v[98:99]
 v_add_f32 v48, 0x3727c5ac, v48
 v_pk_add_f32 v[54:55], v[54:55], v[184:185]
 v_pk_fma_f32 v[56:57], v[184:185], v[184:185], v[56:57]
 v_rsq_f32_e64 v48, v48
 v_pk_add_f32 v[96:97], v[96:97], v[186:187]
 v_pk_fma_f32 v[98:99], v[186:187], v[186:187], v[98:99]
 v_sub_f32_e64 v44, 0, v44
 v_pk_add_f32 v[54:55], v[54:55], v[188:189]
 v_pk_fma_f32 v[56:57], v[188:189], v[188:189], v[56:57]
 v_mul_f32 v52, 0xbeeff558, v48
 v_pk_add_f32 v[96:97], v[96:97], v[190:191]
 v_pk_fma_f32 v[98:99], v[190:191], v[190:191], v[98:99]
 v_mul_f32_e64 v53, v44, v52
 v_pk_add_f32 v[54:55], v[54:55], v[192:193]
 v_pk_fma_f32 v[56:57], v[192:193], v[192:193], v[56:57]
 v_pk_add_f32 v[96:97], v[96:97], v[194:195]
 v_pk_fma_f32 v[98:99], v[194:195], v[194:195], v[98:99]
 v_pk_add_f32 v[54:55], v[54:55], v[196:197]
 v_pk_fma_f32 v[56:57], v[196:197], v[196:197], v[56:57]
 v_pk_add_f32 v[96:97], v[96:97], v[198:199]
 v_pk_fma_f32 v[98:99], v[198:199], v[198:199], v[98:99]
 v_pk_add_f32 v[54:55], v[54:55], v[96:97]
 v_pk_add_f32 v[56:57], v[56:57], v[98:99]
 v_add_f32 v54, v54, v55
 v_add_f32 v56, v56, v57
 s_nop 1
 v_permlane32_swap_b32 v54, v56
 v_add_f32_e64 v54, v54, v56
 ds_write_b32 v74, v54 offset:0
 v_pk_fma_f32 v[200:201], v[200:201], v[52:53], v[52:53] op_sel:[0,0,1] op_sel_hi:[1,0,1]
 v_pk_fma_f32 v[202:203], v[202:203], v[52:53], v[52:53] op_sel:[0,0,1] op_sel_hi:[1,0,1]
 v_pk_fma_f32 v[204:205], v[204:205], v[52:53], v[52:53] op_sel:[0,0,1] op_sel_hi:[1,0,1]
 v_pk_fma_f32 v[206:207], v[206:207], v[52:53], v[52:53] op_sel:[0,0,1] op_sel_hi:[1,0,1]
 v_pk_fma_f32 v[208:209], v[208:209], v[52:53], v[52:53] op_sel:[0,0,1] op_sel_hi:[1,0,1]
 v_pk_fma_f32 v[210:211], v[210:211], v[52:53], v[52:53] op_sel:[0,0,1] op_sel_hi:[1,0,1]
 v_pk_fma_f32 v[212:213], v[212:213], v[52:53], v[52:53] op_sel:[0,0,1] op_sel_hi:[1,0,1]
 v_pk_fma_f32 v[214:215], v[214:215], v[52:53], v[52:53] op_sel:[0,0,1] op_sel_hi:[1,0,1]
 v_pk_fma_f32 v[216:217], v[216:217], v[52:53], v[52:53] op_sel:[0,0,1] op_sel_hi:[1,0,1]
 v_pk_fma_f32 v[218:219], v[218:219], v[52:53], v[52:53] op_sel:[0,0,1] op_sel_hi:[1,0,1]
 v_pk_fma_f32 v[220:221], v[220:221], v[52:53], v[52:53] op_sel:[0,0,1] op_sel_hi:[1,0,1]
 v_pk_fma_f32 v[222:223], v[222:223], v[52:53], v[52:53] op_sel:[0,0,1] op_sel_hi:[1,0,1]
 v_cvt_pk_bf16_f32 v60, v200, v201
 v_cvt_pk_bf16_f32 v61, v202, v203
 v_cvt_pk_bf16_f32 v62, v204, v205
 v_cvt_pk_bf16_f32 v63, v206, v207
 v_cvt_pk_bf16_f32 v64, v208, v209
 v_cvt_pk_bf16_f32 v65, v210, v211
 v_cvt_pk_bf16_f32 v66, v212, v213
 v_cvt_pk_bf16_f32 v67, v214, v215
 v_cvt_pk_bf16_f32 v68, v216, v217
 v_cvt_pk_bf16_f32 v69, v218, v219
 v_cvt_pk_bf16_f32 v70, v220, v221
 v_cvt_pk_bf16_f32 v71, v222, v223
 s_mov_b64 exec, s[88:89]
 ds_write_b128 v58, v[60:63] offset:0
 ds_write_b128 v58, v[64:67] offset:1024
 ds_write_b128 v58, v[68:71] offset:2048
 s_mov_b64 exec, -1
 v_cmp_le_u32 vcc, 16, v72
 v_mov_b32 v58, 147200
 v_mov_b32 v59, 135424
 v_cndmask_b32 v58, v59, v58, vcc
 v_add_u32 v58, v58, v73
 v_add_u32 v224, 12288, v224
 v_add_u32 v225, 12288, v225
 v_add_u32 v226, 12288, v226
 v_add_u32 v227, 12288, v227
 v_add_u32 v228, 12288, v228
 v_add_u32 v229, 12288, v229
 v_add_u32 v230, 12288, v230
 v_add_u32 v231, 12288, v231
 v_add_u32 v232, 12288, v232
 v_add_u32 v233, 12288, v233
 v_add_u32 v234, 12288, v234
 v_add_u32 v235, 12288, v235
 v_add_u32 v236, 12288, v236
 v_add_u32 v237, 12288, v237
 v_add_u32 v238, 12288, v238
 v_add_u32 v239, 12288, v239
 v_add_u32 v240, 12288, v240
 v_add_u32 v241, 12288, v241
 s_waitcnt lgkmcnt(15)
 v_mfma_f32_16x16x32_bf16 v[200:203], v[104:107], a[72:75], 0
 v_mfma_f32_16x16x32_bf16 v[200:203], v[108:111], a[76:79], v[200:203]
 buffer_load_ushort v86, v79, s[36:39], 0 offen offset:0
 v_mfma_f32_16x16x32_bf16 v[200:203], v[112:115], a[80:83], v[200:203]
 v_mfma_f32_16x16x32_bf16 v[204:207], v[116:119], a[84:87], 0
 buffer_load_ushort v87, v79, s[36:39], 0 offen offset:2
 v_mfma_f32_16x16x32_bf16 v[204:207], v[120:123], a[88:91], v[204:207]
 v_mfma_f32_16x16x32_bf16 v[204:207], v[124:127], a[92:95], v[204:207]
 buffer_load_ushort v88, v79, s[36:39], 0 offen offset:4
 s_waitcnt lgkmcnt(10)
 v_mfma_f32_16x16x32_bf16 v[208:211], v[128:131], a[96:99], 0
 s_waitcnt vmcnt(13)
 s_waitcnt lgkmcnt(0)
 s_barrier
 ds_read_b128 v[44:47], v75 offset:0
 ds_read_b128 v[48:51], v75 offset:512
 ds_read_b128 a[0:3], v224 offset:61440
 ds_read_b128 a[4:7], v225 offset:61440
 v_mfma_f32_16x16x32_bf16 v[208:211], v[132:135], a[100:103], v[208:211]
 ds_read_b128 a[8:11], v226 offset:61440
 ds_read_b128 a[12:15], v227 offset:61440
 s_add_u32 m0, s99, 12288
 s_add_u32 s6, s55, 147456
 buffer_load_dwordx4 v5, s[12:15], s6 offen lds
 v_mfma_f32_16x16x32_bf16 v[208:211], v[136:139], a[104:107], v[208:211]
 ds_read_b128 a[16:19], v228 offset:61440
 ds_read_b128 a[20:23], v229 offset:61440
 v_mfma_f32_16x16x32_bf16 v[212:215], v[140:143], a[108:111], 0
 ds_read_b128 a[24:27], v230 offset:61440
 ds_read_b128 a[28:31], v231 offset:61440
 s_add_u32 m0, s99, 14336
 s_add_u32 s6, s55, 172032
 buffer_load_dwordx4 v5, s[12:15], s6 offen lds
 v_mfma_f32_16x16x32_bf16 v[212:215], v[144:147], a[112:115], v[212:215]
 ds_read_b128 a[32:35], v232 offset:61440
 ds_read_b128 a[36:39], v233 offset:61440
 v_mfma_f32_16x16x32_bf16 v[212:215], v[148:151], a[116:119], v[212:215]
 ds_read_b128 a[40:43], v234 offset:61440
 ds_read_b128 a[44:47], v235 offset:61440
 s_add_u32 m0, s99, 16384
 s_add_u32 s6, s55, 196608
 buffer_load_dwordx4 v5, s[12:15], s6 offen lds
 v_mfma_f32_16x16x32_bf16 v[216:219], v[152:155], a[120:123], 0
 ds_read_b128 a[48:51], v236 offset:61440
 v_mfma_f32_16x16x32_bf16 v[216:219], v[156:159], a[124:127], v[216:219]
 ds_read_b128 a[52:55], v237 offset:61440
 s_add_u32 m0, s99, 18432
 s_add_u32 s6, s55, 221184
 buffer_load_dwordx4 v5, s[12:15], s6 offen lds
 v_mfma_f32_16x16x32_bf16 v[216:219], v[160:163], a[128:131], v[216:219]
 ds_read_b128 a[56:59], v238 offset:61440
 v_mfma_f32_16x16x32_bf16 v[220:223], v[164:167], a[132:135], 0
 ds_read_b128 a[60:63], v239 offset:61440
 s_add_u32 m0, s99, 20480
 s_add_u32 s6, s55, 245760
 buffer_load_dwordx4 v5, s[12:15], s6 offen lds
 v_mfma_f32_16x16x32_bf16 v[220:223], v[168:171], a[136:139], v[220:223]
 ds_read_b128 a[64:67], v240 offset:61440
 v_mfma_f32_16x16x32_bf16 v[220:223], v[172:175], a[140:143], v[220:223]
 ds_read_b128 a[68:71], v241 offset:61440
 s_add_u32 m0, s99, 22528
 s_add_u32 s6, s55, 270336
 buffer_load_dwordx4 v5, s[12:15], s6 offen lds
 s_waitcnt lgkmcnt(15)
 v_add_f32 v44, v44, v45
 v_add_f32 v48, v48, v49
 v_add_f32 v46, v46, v47
 v_add_f32 v50, v50, v51
 v_add_f32 v44, v44, v46
 v_add_f32_e64 v48, v48, v50
 v_mul_f32 v44, 0x3baaaaab, v44
 v_mul_f32 v48, 0x3baaaaab, v48
 v_pk_add_f32 v[54:55], v[200:201], v[202:203]
 v_pk_mul_f32 v[56:57], v[200:201], v[200:201]
 v_fma_f32 v48, -v44, v44, v48
 v_pk_add_f32 v[96:97], v[204:205], v[206:207]
 v_pk_mul_f32 v[98:99], v[202:203], v[202:203]
 v_max_f32_e64 v48, 0, v48
 v_pk_fma_f32 v[56:57], v[204:205], v[204:205], v[56:57]
 v_pk_fma_f32 v[98:99], v[206:207], v[206:207], v[98:99]
 v_add_f32 v48, 0x3727c5ac, v48
 v_pk_add_f32 v[54:55], v[54:55], v[208:209]
 v_pk_fma_f32 v[56:57], v[208:209], v[208:209], v[56:57]
 v_rsq_f32_e64 v48, v48
 v_pk_add_f32 v[96:97], v[96:97], v[210:211]
 v_pk_fma_f32 v[98:99], v[210:211], v[210:211], v[98:99]
 v_sub_f32_e64 v44, 0, v44
 v_pk_add_f32 v[54:55], v[54:55], v[212:213]
 v_pk_fma_f32 v[56:57], v[212:213], v[212:213], v[56:57]
 v_mul_f32 v52, 0xbeeff558, v48
 v_pk_add_f32 v[96:97], v[96:97], v[214:215]
 v_pk_fma_f32 v[98:99], v[214:215], v[214:215], v[98:99]
 v_mul_f32_e64 v53, v44, v52
 v_pk_add_f32 v[54:55], v[54:55], v[216:217]
 v_pk_fma_f32 v[56:57], v[216:217], v[216:217], v[56:57]
 v_pk_add_f32 v[96:97], v[96:97], v[218:219]
 v_pk_fma_f32 v[98:99], v[218:219], v[218:219], v[98:99]
 v_pk_add_f32 v[54:55], v[54:55], v[220:221]
 v_pk_fma_f32 v[56:57], v[220:221], v[220:221], v[56:57]
 v_pk_add_f32 v[96:97], v[96:97], v[222:223]
 v_pk_fma_f32 v[98:99], v[222:223], v[222:223], v[98:99]
 v_pk_add_f32 v[54:55], v[54:55], v[96:97]
 v_pk_add_f32 v[56:57], v[56:57], v[98:99]
 v_add_f32 v54, v54, v55
 v_add_f32 v56, v56, v57
 s_nop 1
 v_permlane32_swap_b32 v54, v56
 v_add_f32_e64 v54, v54, v56
 ds_write_b32 v74, v54 offset:1024
 v_pk_fma_f32 v[176:177], v[176:177], v[52:53], v[52:53] op_sel:[0,0,1] op_sel_hi:[1,0,1]
 v_pk_fma_f32 v[178:179], v[178:179], v[52:53], v[52:53] op_sel:[0,0,1] op_sel_hi:[1,0,1]
 v_pk_fma_f32 v[180:181], v[180:181], v[52:53], v[52:53] op_sel:[0,0,1] op_sel_hi:[1,0,1]
 v_pk_fma_f32 v[182:183], v[182:183], v[52:53], v[52:53] op_sel:[0,0,1] op_sel_hi:[1,0,1]
 v_pk_fma_f32 v[184:185], v[184:185], v[52:53], v[52:53] op_sel:[0,0,1] op_sel_hi:[1,0,1]
 v_pk_fma_f32 v[186:187], v[186:187], v[52:53], v[52:53] op_sel:[0,0,1] op_sel_hi:[1,0,1]
 v_pk_fma_f32 v[188:189], v[188:189], v[52:53], v[52:53] op_sel:[0,0,1] op_sel_hi:[1,0,1]
 v_pk_fma_f32 v[190:191], v[190:191], v[52:53], v[52:53] op_sel:[0,0,1] op_sel_hi:[1,0,1]
 v_pk_fma_f32 v[192:193], v[192:193], v[52:53], v[52:53] op_sel:[0,0,1] op_sel_hi:[1,0,1]
 v_pk_fma_f32 v[194:195], v[194:195], v[52:53], v[52:53] op_sel:[0,0,1] op_sel_hi:[1,0,1]
 v_pk_fma_f32 v[196:197], v[196:197], v[52:53], v[52:53] op_sel:[0,0,1] op_sel_hi:[1,0,1]
 v_pk_fma_f32 v[198:199], v[198:199], v[52:53], v[52:53] op_sel:[0,0,1] op_sel_hi:[1,0,1]
 v_cvt_pk_bf16_f32 v60, v176, v177
 v_cvt_pk_bf16_f32 v61, v178, v179
 v_cvt_pk_bf16_f32 v62, v180, v181
 v_cvt_pk_bf16_f32 v63, v182, v183
 v_cvt_pk_bf16_f32 v64, v184, v185
 v_cvt_pk_bf16_f32 v65, v186, v187
 v_cvt_pk_bf16_f32 v66, v188, v189
 v_cvt_pk_bf16_f32 v67, v190, v191
 v_cvt_pk_bf16_f32 v68, v192, v193
 v_cvt_pk_bf16_f32 v69, v194, v195
 v_cvt_pk_bf16_f32 v70, v196, v197
 v_cvt_pk_bf16_f32 v71, v198, v199
 s_mov_b64 exec, s[88:89]
 ds_write_b128 v58, v[60:63] offset:0
 ds_write_b128 v58, v[64:67] offset:1024
 ds_write_b128 v58, v[68:71] offset:2048
 s_mov_b64 exec, -1
 v_cmp_le_u32 vcc, 20, v72
 v_mov_b32 v58, 48832
 v_mov_b32 v59, 147648
 v_cndmask_b32 v58, v59, v58, vcc
 v_add_u32_e64 v58, v58, v73
 s_waitcnt lgkmcnt(15)
 v_mfma_f32_16x16x32_bf16 v[176:179], v[104:107], a[0:3], 0
 v_mfma_f32_16x16x32_bf16 v[176:179], v[108:111], a[4:7], v[176:179]
 v_mfma_f32_16x16x32_bf16 v[176:179], v[112:115], a[8:11], v[176:179]
 v_mfma_f32_16x16x32_bf16 v[180:183], v[116:119], a[12:15], 0
 v_mfma_f32_16x16x32_bf16 v[180:183], v[120:123], a[16:19], v[180:183]
 v_mfma_f32_16x16x32_bf16 v[180:183], v[124:127], a[20:23], v[180:183]
 s_waitcnt lgkmcnt(10)
 v_mfma_f32_16x16x32_bf16 v[184:187], v[128:131], a[24:27], 0
 s_waitcnt lgkmcnt(0)
 s_barrier
 ds_read_b128 v[44:47], v75 offset:1024
 ds_read_b128 v[48:51], v75 offset:1536
 v_mfma_f32_16x16x32_bf16 v[184:187], v[132:135], a[28:31], v[184:187]
 v_mfma_f32_16x16x32_bf16 v[184:187], v[136:139], a[32:35], v[184:187]
 v_mfma_f32_16x16x32_bf16 v[188:191], v[140:143], a[36:39], 0
 v_mfma_f32_16x16x32_bf16 v[188:191], v[144:147], a[40:43], v[188:191]
 v_mfma_f32_16x16x32_bf16 v[188:191], v[148:151], a[44:47], v[188:191]
 v_mfma_f32_16x16x32_bf16 v[192:195], v[152:155], a[48:51], 0
 v_mfma_f32_16x16x32_bf16 v[192:195], v[156:159], a[52:55], v[192:195]
 v_mfma_f32_16x16x32_bf16 v[192:195], v[160:163], a[56:59], v[192:195]
 v_mfma_f32_16x16x32_bf16 v[196:199], v[164:167], a[60:63], 0
 v_mfma_f32_16x16x32_bf16 v[196:199], v[168:171], a[64:67], v[196:199]
 v_mfma_f32_16x16x32_bf16 v[196:199], v[172:175], a[68:71], v[196:199]
 s_waitcnt lgkmcnt(1)
 v_add_f32 v44, v44, v45
 s_waitcnt lgkmcnt(0)
 v_add_f32 v48, v48, v49
 v_add_f32 v46, v46, v47
 v_add_f32 v50, v50, v51
 v_add_f32 v44, v44, v46
 v_add_f32 v48, v48, v50
 v_mul_f32 v44, 0x3baaaaab, v44
 v_mul_f32 v48, 0x3baaaaab, v48
 v_pk_add_f32 v[54:55], v[176:177], v[178:179]
 v_pk_mul_f32 v[56:57], v[176:177], v[176:177]
 v_fma_f32 v48, -v44, v44, v48
 v_pk_add_f32 v[96:97], v[180:181], v[182:183]
 v_pk_mul_f32 v[98:99], v[178:179], v[178:179]
 v_max_f32_e64 v48, 0, v48
 v_pk_fma_f32 v[56:57], v[180:181], v[180:181], v[56:57]
 v_pk_fma_f32 v[98:99], v[182:183], v[182:183], v[98:99]
 v_add_f32 v48, 0x3727c5ac, v48
 v_pk_add_f32 v[54:55], v[54:55], v[184:185]
 v_pk_fma_f32 v[56:57], v[184:185], v[184:185], v[56:57]
 v_rsq_f32_e64 v48, v48
 v_pk_add_f32 v[96:97], v[96:97], v[186:187]
 v_pk_fma_f32 v[98:99], v[186:187], v[186:187], v[98:99]
 v_sub_f32_e64 v44, 0, v44
 v_pk_add_f32 v[54:55], v[54:55], v[188:189]
 v_pk_fma_f32 v[56:57], v[188:189], v[188:189], v[56:57]
 v_mul_f32 v52, 0xbeeff558, v48
 v_pk_add_f32 v[96:97], v[96:97], v[190:191]
 v_pk_fma_f32 v[98:99], v[190:191], v[190:191], v[98:99]
 v_mul_f32_e64 v53, v44, v52
 v_pk_add_f32 v[54:55], v[54:55], v[192:193]
 v_pk_fma_f32 v[56:57], v[192:193], v[192:193], v[56:57]
 v_pk_add_f32 v[96:97], v[96:97], v[194:195]
 v_pk_fma_f32 v[98:99], v[194:195], v[194:195], v[98:99]
 v_pk_add_f32 v[54:55], v[54:55], v[196:197]
 v_pk_fma_f32 v[56:57], v[196:197], v[196:197], v[56:57]
 v_pk_add_f32 v[96:97], v[96:97], v[198:199]
 v_pk_fma_f32 v[98:99], v[198:199], v[198:199], v[98:99]
 v_pk_add_f32 v[54:55], v[54:55], v[96:97]
 v_pk_add_f32 v[56:57], v[56:57], v[98:99]
 v_add_f32 v54, v54, v55
 v_add_f32 v56, v56, v57
 s_nop 1
 v_permlane32_swap_b32 v54, v56
 v_add_f32_e64 v54, v54, v56
 ds_write_b32 v74, v54 offset:0
 s_waitcnt vmcnt(8)
 v_lshlrev_b32 v86, 16, v86
 s_waitcnt vmcnt(7)
 v_lshlrev_b32 v87, 16, v87
 s_waitcnt vmcnt(6)
 v_lshlrev_b32 v88, 16, v88
 v_lshlrev_b32 v94, 16, v80
 v_mul_f32 v90, v94, v86
 v_lshlrev_b32 v94, 16, v82
 v_fmac_f32 v90, v94, v87
 v_lshlrev_b32 v94, 16, v84
 v_fmac_f32 v90, v94, v88
 v_and_b32 v94, 0xffff0000, v80
 v_mul_f32 v91, v94, v86
 v_and_b32 v94, 0xffff0000, v82
 v_fmac_f32 v91, v94, v87
 v_and_b32 v94, 0xffff0000, v84
 v_fmac_f32 v91, v94, v88
 v_lshlrev_b32 v94, 16, v81
 v_mul_f32_e64 v92, v94, v86
 v_lshlrev_b32 v94, 16, v83
 v_fmac_f32 v92, v94, v87
 v_lshlrev_b32 v94, 16, v85
 v_fmac_f32 v92, v94, v88
 v_and_b32 v94, 0xffff0000, v81
 v_mul_f32 v93, v94, v86
 v_and_b32 v94, 0xffff0000, v83
 v_fmac_f32 v93, v94, v87
 v_and_b32 v94, 0xffff0000, v85
 v_fmac_f32 v93, v94, v88
 v_lshrrev_b32 v94, 3, v0
 v_lshlrev_b32 v94, 15, v94
 v_and_b32 v89, 7, v0
 v_lshl_add_u32 v94, v89, 4, v94
 s_lshl_b32 s6, s2, 7
 s_add_u32 s6, s6, 0xc0000
 v_add_u32 v94, s6, v94
 v_mov_b32 v89, 0x40000000
 v_cmp_gt_u32 vcc, 48, v0
 s_nop 1
 v_cndmask_b32 v94, v89, v94, vcc
 buffer_store_dwordx4 v[90:93], v94, s[24:27], 0 offen sc1
 v_pk_fma_f32 v[200:201], v[200:201], v[52:53], v[52:53] op_sel:[0,0,1] op_sel_hi:[1,0,1]
 v_pk_fma_f32 v[202:203], v[202:203], v[52:53], v[52:53] op_sel:[0,0,1] op_sel_hi:[1,0,1]
 v_pk_fma_f32 v[204:205], v[204:205], v[52:53], v[52:53] op_sel:[0,0,1] op_sel_hi:[1,0,1]
 v_pk_fma_f32 v[206:207], v[206:207], v[52:53], v[52:53] op_sel:[0,0,1] op_sel_hi:[1,0,1]
 v_pk_fma_f32 v[208:209], v[208:209], v[52:53], v[52:53] op_sel:[0,0,1] op_sel_hi:[1,0,1]
 v_pk_fma_f32 v[210:211], v[210:211], v[52:53], v[52:53] op_sel:[0,0,1] op_sel_hi:[1,0,1]
 v_pk_fma_f32 v[212:213], v[212:213], v[52:53], v[52:53] op_sel:[0,0,1] op_sel_hi:[1,0,1]
 v_pk_fma_f32 v[214:215], v[214:215], v[52:53], v[52:53] op_sel:[0,0,1] op_sel_hi:[1,0,1]
 v_pk_fma_f32 v[216:217], v[216:217], v[52:53], v[52:53] op_sel:[0,0,1] op_sel_hi:[1,0,1]
 v_pk_fma_f32 v[218:219], v[218:219], v[52:53], v[52:53] op_sel:[0,0,1] op_sel_hi:[1,0,1]
 v_pk_fma_f32 v[220:221], v[220:221], v[52:53], v[52:53] op_sel:[0,0,1] op_sel_hi:[1,0,1]
 v_pk_fma_f32 v[222:223], v[222:223], v[52:53], v[52:53] op_sel:[0,0,1] op_sel_hi:[1,0,1]
 v_cvt_pk_bf16_f32 v60, v200, v201
 v_cvt_pk_bf16_f32 v61, v202, v203
 v_cvt_pk_bf16_f32 v62, v204, v205
 v_cvt_pk_bf16_f32 v63, v206, v207
 v_cvt_pk_bf16_f32 v64, v208, v209
 v_cvt_pk_bf16_f32 v65, v210, v211
 v_cvt_pk_bf16_f32 v66, v212, v213
 v_cvt_pk_bf16_f32 v67, v214, v215
 v_cvt_pk_bf16_f32 v68, v216, v217
 v_cvt_pk_bf16_f32 v69, v218, v219
 v_cvt_pk_bf16_f32 v70, v220, v221
 v_cvt_pk_bf16_f32 v71, v222, v223
 s_mov_b64 exec, s[88:89]
 ds_write_b128 v58, v[60:63] offset:0
 ds_write_b128 v58, v[64:67] offset:1024
 ds_write_b128 v58, v[68:71] offset:2048
 s_mov_b64 exec, -1
 s_waitcnt lgkmcnt(0)
 s_barrier
 ds_read_b128 v[44:47], v75 offset:0
 ds_read_b128 v[48:51], v75 offset:512
 v_cmp_le_u32 vcc, 24, v72
 v_mov_b32 v58, 61056
 v_mov_b32 v59, 49280
 v_cndmask_b32 v58, v59, v58, vcc
 v_add_u32 v58, v58, v73
 s_waitcnt lgkmcnt(1)
 v_add_f32 v44, v44, v45
 s_waitcnt lgkmcnt(0)
 v_add_f32 v48, v48, v49
 v_add_f32 v46, v46, v47
 v_add_f32 v50, v50, v51
 v_add_f32 v44, v44, v46
 v_add_f32_e64 v48, v48, v50
 v_mul_f32 v44, 0x3baaaaab, v44
 v_mul_f32 v48, 0x3baaaaab, v48
 v_fma_f32 v48, -v44, v44, v48
 v_max_f32_e64 v48, 0, v48
 v_add_f32 v48, 0x3727c5ac, v48
 v_rsq_f32 v48, v48
 v_sub_f32 v44, 0, v44
 v_mul_f32 v52, 0xbeeff558, v48
 v_mul_f32_e64 v53, v44, v52
 v_pk_fma_f32 v[176:177], v[176:177], v[52:53], v[52:53] op_sel:[0,0,1] op_sel_hi:[1,0,1]
 v_pk_fma_f32 v[178:179], v[178:179], v[52:53], v[52:53] op_sel:[0,0,1] op_sel_hi:[1,0,1]
 v_pk_fma_f32 v[180:181], v[180:181], v[52:53], v[52:53] op_sel:[0,0,1] op_sel_hi:[1,0,1]
 v_pk_fma_f32 v[182:183], v[182:183], v[52:53], v[52:53] op_sel:[0,0,1] op_sel_hi:[1,0,1]
 v_pk_fma_f32 v[184:185], v[184:185], v[52:53], v[52:53] op_sel:[0,0,1] op_sel_hi:[1,0,1]
 v_pk_fma_f32 v[186:187], v[186:187], v[52:53], v[52:53] op_sel:[0,0,1] op_sel_hi:[1,0,1]
 v_pk_fma_f32 v[188:189], v[188:189], v[52:53], v[52:53] op_sel:[0,0,1] op_sel_hi:[1,0,1]
 v_pk_fma_f32 v[190:191], v[190:191], v[52:53], v[52:53] op_sel:[0,0,1] op_sel_hi:[1,0,1]
 v_pk_fma_f32 v[192:193], v[192:193], v[52:53], v[52:53] op_sel:[0,0,1] op_sel_hi:[1,0,1]
 v_pk_fma_f32 v[194:195], v[194:195], v[52:53], v[52:53] op_sel:[0,0,1] op_sel_hi:[1,0,1]
 v_pk_fma_f32 v[196:197], v[196:197], v[52:53], v[52:53] op_sel:[0,0,1] op_sel_hi:[1,0,1]
 v_pk_fma_f32 v[198:199], v[198:199], v[52:53], v[52:53] op_sel:[0,0,1] op_sel_hi:[1,0,1]
 v_cvt_pk_bf16_f32 v60, v176, v177
 v_cvt_pk_bf16_f32 v61, v178, v179
 v_cvt_pk_bf16_f32 v62, v180, v181
 v_cvt_pk_bf16_f32 v63, v182, v183
 v_cvt_pk_bf16_f32 v64, v184, v185
 v_cvt_pk_bf16_f32 v65, v186, v187
 v_cvt_pk_bf16_f32 v66, v188, v189
 v_cvt_pk_bf16_f32 v67, v190, v191
 v_cvt_pk_bf16_f32 v68, v192, v193
 v_cvt_pk_bf16_f32 v69, v194, v195
 v_cvt_pk_bf16_f32 v70, v196, v197
 v_cvt_pk_bf16_f32 v71, v198, v199
 s_mov_b32 s88, 0x03ff3fff
 s_mov_b32 s89, 0x03ff3fff
 s_mov_b64 exec, s[88:89]
 ds_write_b128 v58, v[60:63] offset:0
 ds_write_b128 v58, v[64:67] offset:1024
 ds_write_b128 v58, v[68:71] offset:2048
 s_mov_b32 s88, 0x3c000000
 s_mov_b32 s89, 0x3c000000
 s_mov_b64 exec, s[88:89]
 buffer_store_dwordx4 v[60:63], v103, s[24:27], 0 offen offset:0 sc1
 buffer_store_dwordx4 v[64:67], v103, s[24:27], 0 offen offset:1024 sc1
 buffer_store_dwordx4 v[68:71], v103, s[24:27], 0 offen offset:2048 sc1
 s_mov_b64 exec, -1
 s_waitcnt vmcnt(4)
 s_waitcnt lgkmcnt(0)
 s_barrier
 ds_read_b64_tr_b16 a[152:153], v4 offset:0
 ds_read_b64_tr_b16 a[154:155], v4 offset:1024
 ds_read_b64_tr_b16 a[156:157], v4 offset:2048
 ds_read_b64_tr_b16 a[158:159], v4 offset:3072
 ds_read_b64_tr_b16 a[160:161], v4 offset:4096
 ds_read_b64_tr_b16 a[162:163], v4 offset:5120
 ds_read_b64_tr_b16 a[164:165], v4 offset:6144
 ds_read_b64_tr_b16 a[166:167], v4 offset:7168
 ds_read_b64_tr_b16 a[168:169], v4 offset:8192
 ds_read_b64_tr_b16 a[170:171], v4 offset:9216
 ds_read_b64_tr_b16 a[172:173], v4 offset:10240
 ds_read_b64_tr_b16 a[174:175], v4 offset:11264
 ds_read_b64_tr_b16 a[176:177], v4 offset:12288
 ds_read_b64_tr_b16 a[178:179], v4 offset:13312
 ds_read_b64_tr_b16 a[180:181], v4 offset:14336
 ds_read_b64_tr_b16 a[182:183], v4 offset:15360
 ds_read_b64_tr_b16 a[184:185], v4 offset:16384
 ds_read_b64_tr_b16 a[186:187], v4 offset:17408
 ds_read_b64_tr_b16 a[188:189], v4 offset:18432
 ds_read_b64_tr_b16 a[190:191], v4 offset:19456
 ds_read_b64_tr_b16 a[192:193], v4 offset:20480
 ds_read_b64_tr_b16 a[194:195], v4 offset:21504
 ds_read_b64_tr_b16 a[196:197], v4 offset:22528
 ds_read_b64_tr_b16 a[198:199], v4 offset:23552
 v_bfe_u32 v240, v1, 3, 1
 v_bfe_u32 v241, v1, 2, 1
 v_lshl_add_u32 v240, v241, 1, v240
 v_bfe_u32 v241, v1, 4, 1
 v_lshl_add_u32 v240, v241, 3, v240
 v_bfe_u32 v241, v1, 1, 1
 v_lshl_add_u32 v240, v241, 4, v240
 v_lshrrev_b32_e64 v241, 5, v1
 v_lshl_add_u32 v240, v241, 2, v240
 s_lshr_b32 s6, s3, 1
 s_mul_i32 s6, s6, 1536
 s_and_b32 s7, s3, 1
 s_lshl_b32 s7, s7, 7
 s_add_u32 s6, s6, s7
 s_add_u32 s6, s6, 73728
 v_lshlrev_b32 v240, 2, v240
 v_add_u32 v6, s6, v240
 s_mov_b32 s52, 0xcccccccc
 s_mov_b32 s53, 0xcccccccc
 v_lshrrev_b32 v241, 3, v1
 v_lshlrev_b32 v241, 6, v241
 v_and_b32 v240, 7, v1
 v_lshl_add_u32 v241, v240, 2, v241
 s_lshr_b32 s6, s3, 1
 s_mul_i32 s6, s6, 384
 s_and_b32 s7, s3, 1
 s_lshl_b32 s7, s7, 5
 s_add_u32 s6, s6, s7
 v_add_u32 v241, s6, v241
 v_cmp_gt_u32 vcc, 48, v1
 v_lshlrev_b32 v240, 2, v241
 v_add_u32 v240, 73728, v240
 v_mov_b32 v242, 73728
 v_cndmask_b32 v240, v242, v240, vcc
 v_lshrrev_b32 v242, 5, v241
 v_lshlrev_b32 v242, 15, v242
 v_and_b32 v241, 31, v241
 v_lshl_add_u32 v241, v241, 2, v242
 s_lshl_b32 s6, s2, 7
 s_add_u32 s6, s6, 0x0
 v_add_u32 v241, s6, v241
 v_mov_b32 v242, 0x40000000
 v_cndmask_b32_e64 v241, v242, v241, vcc
 s_lshr_b32 s6, s3, 1
 s_mul_i32 s6, s6, 12
 s_and_b32 s7, s3, 1
 s_add_u32 s6, s6, s7
 s_mul_i32 s54, s6, 12288
 s_add_u32 s54, s54, 0x400000
 v_lshlrev_b32 v5, 4, v1
 ds_read_b128 v[104:107], v2 offset:0
 ds_read_b128 v[108:111], v2 offset:1024
 ds_read_b128 v[112:115], v2 offset:2048
 ds_read_b128 v[116:119], v2 offset:3072
 ds_read_b128 v[120:123], v2 offset:4096
 ds_read_b128 v[124:127], v2 offset:5120
 ds_read_b128 v[128:131], v2 offset:6144
 s_waitcnt lgkmcnt(4)
 v_mfma_f32_32x32x16_bf16 v[8:23], a[152:155], v[104:107], 0
 ds_read_b128 v[132:135], v2 offset:7168
 v_mfma_f32_32x32x16_bf16 v[8:23], a[156:159], v[108:111], v[8:23]
 ds_read_b128 v[136:139], v2 offset:8192
 v_mfma_f32_32x32x16_bf16 v[8:23], a[160:163], v[112:115], v[8:23]
 ds_read_b128 v[140:143], v2 offset:9216
 s_waitcnt lgkmcnt(4)
 v_mfma_f32_32x32x16_bf16 v[8:23], a[164:167], v[116:119], v[8:23]
 ds_read_b128 v[144:147], v2 offset:10240
 v_mfma_f32_32x32x16_bf16 v[8:23], a[168:171], v[120:123], v[8:23]
 ds_read_b128 v[148:151], v2 offset:11264
 v_mfma_f32_32x32x16_bf16 v[8:23], a[172:175], v[124:127], v[8:23]
 ds_read_b128 v[152:155], v2 offset:12288
 s_waitcnt lgkmcnt(4)
 v_mfma_f32_32x32x16_bf16 v[8:23], a[176:179], v[128:131], v[8:23]
 ds_read_b128 v[156:159], v2 offset:13312
 v_mfma_f32_32x32x16_bf16 v[8:23], a[180:183], v[132:135], v[8:23]
 ds_read_b128 v[160:163], v2 offset:14336
 v_mfma_f32_32x32x16_bf16 v[8:23], a[184:187], v[136:139], v[8:23]
 ds_read_b128 v[164:167], v2 offset:15360
 s_waitcnt lgkmcnt(4)
 v_mfma_f32_32x32x16_bf16 v[8:23], a[188:191], v[140:143], v[8:23]
 ds_read_b128 v[168:171], v2 offset:16384
 v_mfma_f32_32x32x16_bf16 v[8:23], a[192:195], v[144:147], v[8:23]
 ds_read_b128 v[172:175], v2 offset:17408
 v_mfma_f32_32x32x16_bf16 v[8:23], a[196:199], v[148:151], v[8:23]
 ds_read_b128 v[176:179], v2 offset:18432
 s_nop 10
 v_pk_fma_f32 v[56:57], v[8:9], v[8:9], s[50:51]
 v_pk_fma_f32 v[58:59], v[10:11], v[10:11], s[50:51]
 v_pk_fma_f32 v[60:61], v[12:13], v[12:13], s[50:51]
 v_pk_fma_f32 v[62:63], v[14:15], v[14:15], s[50:51]
 v_pk_fma_f32 v[64:65], v[16:17], v[16:17], s[50:51]
 v_pk_fma_f32 v[66:67], v[18:19], v[18:19], s[50:51]
 v_pk_fma_f32 v[68:69], v[20:21], v[20:21], s[50:51]
 v_pk_fma_f32 v[70:71], v[22:23], v[22:23], s[50:51]
 v_pk_mul_f32 v[56:57], v[56:57], v[8:9]
 v_pk_mul_f32 v[58:59], v[58:59], v[10:11]
 v_pk_mul_f32 v[60:61], v[60:61], v[12:13]
 v_pk_mul_f32 v[62:63], v[62:63], v[14:15]
 v_pk_mul_f32 v[64:65], v[64:65], v[16:17]
 v_pk_mul_f32 v[66:67], v[66:67], v[18:19]
 v_pk_mul_f32 v[68:69], v[68:69], v[20:21]
 v_pk_mul_f32 v[70:71], v[70:71], v[22:23]
 s_waitcnt lgkmcnt(4)
 v_mfma_f32_32x32x16_bf16 v[24:39], a[152:155], v[152:155], 0
 ds_read_b128 v[180:183], v2 offset:19456
 v_mfma_f32_32x32x16_bf16 v[24:39], a[156:159], v[156:159], v[24:39]
 ds_read_b128 v[184:187], v2 offset:20480
 v_exp_f32 v56, v56
 v_mfma_f32_32x32x16_bf16 v[24:39], a[160:163], v[160:163], v[24:39]
 ds_read_b128 v[188:191], v2 offset:21504
 v_exp_f32 v57, v57
 s_waitcnt lgkmcnt(4)
 v_mfma_f32_32x32x16_bf16 v[24:39], a[164:167], v[164:167], v[24:39]
 ds_read_b128 v[192:195], v2 offset:22528
 v_exp_f32_e64 v58, v58
 v_mfma_f32_32x32x16_bf16 v[24:39], a[168:171], v[168:171], v[24:39]
 ds_read_b128 v[196:199], v2 offset:23552
 v_exp_f32_e64 v59, v59
 v_mfma_f32_32x32x16_bf16 v[24:39], a[172:175], v[172:175], v[24:39]
 ds_read_b128 a[96:99], v2 offset:24576
 v_exp_f32 v60, v60
 s_waitcnt lgkmcnt(4)
 v_mfma_f32_32x32x16_bf16 v[24:39], a[176:179], v[176:179], v[24:39]
 ds_read_b128 a[100:103], v2 offset:25600
 v_exp_f32_e64 v61, v61
 v_mfma_f32_32x32x16_bf16 v[24:39], a[180:183], v[180:183], v[24:39]
 ds_read_b128 a[104:107], v2 offset:26624
 v_exp_f32_e64 v62, v62
 v_mfma_f32_32x32x16_bf16 v[24:39], a[184:187], v[184:187], v[24:39]
 ds_read_b128 a[108:111], v2 offset:27648
 v_exp_f32 v63, v63
 s_waitcnt lgkmcnt(4)
 v_mfma_f32_32x32x16_bf16 v[24:39], a[188:191], v[188:191], v[24:39]
 ds_read_b128 a[112:115], v2 offset:28672
 v_exp_f32_e64 v64, v64
 v_mfma_f32_32x32x16_bf16 v[24:39], a[192:195], v[192:195], v[24:39]
 ds_read_b128 a[116:119], v2 offset:29696
 v_exp_f32_e64 v65, v65
 v_mfma_f32_32x32x16_bf16 v[24:39], a[196:199], v[196:199], v[24:39]
 ds_read_b128 a[120:123], v2 offset:30720
 v_exp_f32 v66, v66
 v_exp_f32 v67, v67
 v_exp_f32 v68, v68
 v_exp_f32 v69, v69
 v_exp_f32 v70, v70
 v_exp_f32 v71, v71
 v_pk_add_f32 v[56:57], v[56:57], 1.0
 v_pk_add_f32 v[58:59], v[58:59], 1.0
 v_pk_add_f32 v[60:61], v[60:61], 1.0
 v_pk_add_f32 v[62:63], v[62:63], 1.0
 v_pk_add_f32 v[64:65], v[64:65], 1.0
 v_pk_add_f32 v[66:67], v[66:67], 1.0
 v_pk_add_f32 v[68:69], v[68:69], 1.0
 v_pk_add_f32 v[70:71], v[70:71], 1.0
 v_pk_fma_f32 v[72:73], v[24:25], v[24:25], s[50:51]
 v_pk_fma_f32 v[74:75], v[26:27], v[26:27], s[50:51]
 v_pk_fma_f32 v[76:77], v[28:29], v[28:29], s[50:51]
 v_pk_fma_f32 v[78:79], v[30:31], v[30:31], s[50:51]
 v_pk_fma_f32 v[80:81], v[32:33], v[32:33], s[50:51]
 v_pk_fma_f32 v[82:83], v[34:35], v[34:35], s[50:51]
 v_pk_fma_f32 v[84:85], v[36:37], v[36:37], s[50:51]
 v_pk_fma_f32 v[86:87], v[38:39], v[38:39], s[50:51]
 v_pk_mul_f32 v[72:73], v[72:73], v[24:25]
 v_pk_mul_f32 v[74:75], v[74:75], v[26:27]
 v_pk_mul_f32 v[76:77], v[76:77], v[28:29]
 v_pk_mul_f32 v[78:79], v[78:79], v[30:31]
 v_pk_mul_f32 v[80:81], v[80:81], v[32:33]
 v_pk_mul_f32 v[82:83], v[82:83], v[34:35]
 v_pk_mul_f32 v[84:85], v[84:85], v[36:37]
 v_pk_mul_f32 v[86:87], v[86:87], v[38:39]
 s_waitcnt lgkmcnt(4)
 v_mfma_f32_32x32x16_bf16 v[40:55], a[152:155], a[96:99], 0
 ds_read_b128 a[124:127], v2 offset:31744
 v_rcp_f32 v56, v56
 v_exp_f32_e64 v72, v72
 v_mfma_f32_32x32x16_bf16 v[40:55], a[156:159], a[100:103], v[40:55]
 ds_read_b128 a[128:131], v2 offset:32768
 s_mul_i32 s62, s57, 24576
 s_add_u32 s62, s62, s54
 s_add_u32 s63, s62, 4096
 s_add_u32 s55, s62, 8192
 v_rcp_f32 v57, v57
 v_exp_f32_e64 v73, v73
 v_mfma_f32_32x32x16_bf16 v[40:55], a[160:163], a[104:107], v[40:55]
 ds_read_b128 a[132:135], v2 offset:33792
 v_rcp_f32_e64 v58, v58
 v_exp_f32 v74, v74
 s_waitcnt lgkmcnt(4)
 v_mfma_f32_32x32x16_bf16 v[40:55], a[164:167], a[108:111], v[40:55]
 ds_read_b128 a[136:139], v2 offset:34816
 v_rcp_f32 v59, v59
 v_exp_f32 v75, v75
 v_rcp_f32_e64 v60, v60
 v_mfma_f32_32x32x16_bf16 v[40:55], a[168:171], a[112:115], v[40:55]
 ds_read_b128 a[140:143], v2 offset:35840
 v_exp_f32 v76, v76
 v_rcp_f32 v61, v61
 v_mfma_f32_32x32x16_bf16 v[40:55], a[172:175], a[116:119], v[40:55]
 ds_read_b128 v[200:203], v2 offset:36864
 v_exp_f32_e64 v77, v77
 v_rcp_f32 v62, v62
 s_waitcnt lgkmcnt(4)
 v_mfma_f32_32x32x16_bf16 v[40:55], a[176:179], a[120:123], v[40:55]
 ds_read_b128 v[204:207], v2 offset:37888
 v_exp_f32 v78, v78
 v_rcp_f32 v63, v63
 v_mfma_f32_32x32x16_bf16 v[40:55], a[180:183], a[124:127], v[40:55]
 ds_read_b128 v[208:211], v2 offset:38912
 v_exp_f32 v79, v79
 v_rcp_f32 v64, v64
 v_exp_f32_e64 v80, v80
 v_mfma_f32_32x32x16_bf16 v[40:55], a[184:187], a[128:131], v[40:55]
 ds_read_b128 v[212:215], v2 offset:39936
 v_rcp_f32_e64 v65, v65
 v_exp_f32 v81, v81
 s_waitcnt lgkmcnt(4)
 v_mfma_f32_32x32x16_bf16 v[40:55], a[188:191], a[132:135], v[40:55]
 ds_read_b128 v[216:219], v2 offset:40960
 v_rcp_f32 v66, v66
 v_exp_f32 v82, v82
 v_mfma_f32_32x32x16_bf16 v[40:55], a[192:195], a[136:139], v[40:55]
 ds_read_b128 v[220:223], v2 offset:41984
 v_rcp_f32 v67, v67
 v_exp_f32 v83, v83
 v_mfma_f32_32x32x16_bf16 v[40:55], a[196:199], a[140:143], v[40:55]
 ds_read_b128 v[224:227], v2 offset:43008
 v_rcp_f32 v68, v68
 v_exp_f32 v84, v84
 v_rcp_f32 v69, v69
 v_exp_f32 v85, v85
 v_rcp_f32 v70, v70
 v_exp_f32 v86, v86
 v_rcp_f32 v71, v71
 v_exp_f32 v87, v87
 v_pk_mul_f32 v[56:57], v[8:9], v[56:57]
 v_pk_mul_f32 v[58:59], v[10:11], v[58:59]
 v_pk_mul_f32 v[60:61], v[12:13], v[60:61]
 v_pk_mul_f32 v[62:63], v[14:15], v[62:63]
 v_pk_mul_f32 v[64:65], v[16:17], v[64:65]
 v_pk_mul_f32 v[66:67], v[18:19], v[66:67]
 v_pk_mul_f32 v[68:69], v[20:21], v[68:69]
 v_pk_mul_f32 v[70:71], v[22:23], v[70:71]
 v_pk_add_f32 v[72:73], v[72:73], 1.0
 v_pk_add_f32 v[74:75], v[74:75], 1.0
 v_pk_add_f32 v[76:77], v[76:77], 1.0
 v_pk_add_f32 v[78:79], v[78:79], 1.0
 v_pk_add_f32 v[80:81], v[80:81], 1.0
 v_pk_add_f32 v[82:83], v[82:83], 1.0
 v_pk_add_f32 v[84:85], v[84:85], 1.0
 v_pk_add_f32 v[86:87], v[86:87], 1.0
 v_pk_mul_f32 v[88:89], v[56:57], v[56:57]
 v_pk_mul_f32 v[90:91], v[58:59], v[58:59]
 v_pk_mul_f32 v[92:93], v[60:61], v[60:61]
 v_pk_mul_f32 v[94:95], v[62:63], v[62:63]
 v_pk_mul_f32 v[96:97], v[64:65], v[64:65]
 v_pk_mul_f32 v[98:99], v[66:67], v[66:67]
 v_pk_mul_f32 v[100:101], v[68:69], v[68:69]
 v_pk_mul_f32 v[102:103], v[70:71], v[70:71]
 v_cvt_pk_bf16_f32 v56, v56, v57
 v_cvt_pk_bf16_f32 v58, v58, v59
 v_cvt_pk_bf16_f32 v60, v60, v61
 v_cvt_pk_bf16_f32 v62, v62, v63
 v_cvt_pk_bf16_f32 v64, v64, v65
 v_cvt_pk_bf16_f32 v66, v66, v67
 v_cvt_pk_bf16_f32 v68, v68, v69
 v_cvt_pk_bf16_f32 v70, v70, v71
 v_accvgpr_write_b32 a0, v56
 v_accvgpr_write_b32 a1, v58
 v_accvgpr_write_b32 a2, v60
 v_accvgpr_write_b32 a3, v62
 v_accvgpr_write_b32 a4, v64
 v_accvgpr_write_b32 a5, v66
 v_accvgpr_write_b32 a6, v68
 v_accvgpr_write_b32 a7, v70
 v_pk_fma_f32 v[56:57], v[40:41], v[40:41], s[50:51]
 v_pk_fma_f32 v[58:59], v[42:43], v[42:43], s[50:51]
 v_pk_fma_f32 v[60:61], v[44:45], v[44:45], s[50:51]
 v_pk_fma_f32 v[62:63], v[46:47], v[46:47], s[50:51]
 v_pk_fma_f32 v[64:65], v[48:49], v[48:49], s[50:51]
 v_pk_fma_f32 v[66:67], v[50:51], v[50:51], s[50:51]
 v_pk_fma_f32 v[68:69], v[52:53], v[52:53], s[50:51]
 v_pk_fma_f32 v[70:71], v[54:55], v[54:55], s[50:51]
 v_pk_mul_f32 v[56:57], v[56:57], v[40:41]
 v_pk_mul_f32 v[58:59], v[58:59], v[42:43]
 v_pk_mul_f32 v[60:61], v[60:61], v[44:45]
 v_pk_mul_f32 v[62:63], v[62:63], v[46:47]
 v_pk_mul_f32 v[64:65], v[64:65], v[48:49]
 v_pk_mul_f32 v[66:67], v[66:67], v[50:51]
 v_pk_mul_f32 v[68:69], v[68:69], v[52:53]
 v_pk_mul_f32 v[70:71], v[70:71], v[54:55]
 v_and_b32_e64 v242, 3, v1
 v_lshlrev_b32 v242, 6, v242
 buffer_load_dword v243, v242, s[40:43], 0 offen sc1
 s_waitcnt lgkmcnt(4)
 v_mfma_f32_32x32x16_bf16 v[8:23], a[152:155], v[200:203], 0
 ds_read_b128 v[228:231], v2 offset:44032
 v_rcp_f32 v72, v72
 v_exp_f32 v56, v56
 v_mfma_f32_32x32x16_bf16 v[8:23], a[156:159], v[204:207], v[8:23]
 ds_read_b128 v[232:235], v2 offset:45056
 v_rcp_f32 v73, v73
 v_exp_f32 v57, v57
 v_mfma_f32_32x32x16_bf16 v[8:23], a[160:163], v[208:211], v[8:23]
 ds_read_b128 v[236:239], v2 offset:46080
 v_rcp_f32_e64 v74, v74
 v_exp_f32 v58, v58
 s_waitcnt lgkmcnt(4)
 v_mfma_f32_32x32x16_bf16 v[8:23], a[164:167], v[212:215], v[8:23]
 ds_read_b128 a[200:203], v2 offset:47104
 v_rcp_f32 v75, v75
 v_exp_f32 v59, v59
 v_rcp_f32_e64 v76, v76
 v_mfma_f32_32x32x16_bf16 v[8:23], a[168:171], v[216:219], v[8:23]
 ds_read_b128 a[204:207], v2 offset:48128
 v_exp_f32 v60, v60
 v_rcp_f32 v77, v77
 v_mfma_f32_32x32x16_bf16 v[8:23], a[172:175], v[220:223], v[8:23]
 ds_read_b128 a[208:211], v2 offset:49152
 v_exp_f32_e64 v61, v61
 v_rcp_f32 v78, v78
 s_waitcnt lgkmcnt(4)
 v_mfma_f32_32x32x16_bf16 v[8:23], a[176:179], v[224:227], v[8:23]
 ds_read_b128 a[212:215], v2 offset:50176
 v_exp_f32 v62, v62
 v_rcp_f32 v79, v79
 v_mfma_f32_32x32x16_bf16 v[8:23], a[180:183], v[228:231], v[8:23]
 ds_read_b128 a[216:219], v2 offset:51200
 v_exp_f32 v63, v63
 v_rcp_f32 v80, v80
 v_exp_f32_e64 v64, v64
 v_mfma_f32_32x32x16_bf16 v[8:23], a[184:187], v[232:235], v[8:23]
 ds_read_b128 a[220:223], v2 offset:52224
 v_rcp_f32_e64 v81, v81
 v_exp_f32 v65, v65
 s_waitcnt lgkmcnt(4)
 v_mfma_f32_32x32x16_bf16 v[8:23], a[188:191], v[236:239], v[8:23]
 ds_read_b128 a[224:227], v2 offset:53248
 v_rcp_f32 v82, v82
 v_exp_f32 v66, v66
 v_mfma_f32_32x32x16_bf16 v[8:23], a[192:195], a[200:203], v[8:23]
 ds_read_b128 a[228:231], v2 offset:54272
 v_rcp_f32 v83, v83
 v_exp_f32 v67, v67
 v_mfma_f32_32x32x16_bf16 v[8:23], a[196:199], a[204:207], v[8:23]
 ds_read_b128 a[200:203], v2 offset:55296
 v_rcp_f32 v84, v84
 v_exp_f32 v68, v68
 v_rcp_f32 v85, v85
 v_exp_f32 v69, v69
 v_rcp_f32 v86, v86
 v_exp_f32 v70, v70
 v_rcp_f32 v87, v87
 v_exp_f32 v71, v71
 v_pk_mul_f32 v[72:73], v[24:25], v[72:73]
 v_pk_mul_f32 v[74:75], v[26:27], v[74:75]
 v_pk_mul_f32 v[76:77], v[28:29], v[76:77]
 v_pk_mul_f32 v[78:79], v[30:31], v[78:79]
 v_pk_mul_f32 v[80:81], v[32:33], v[80:81]
 v_pk_mul_f32 v[82:83], v[34:35], v[82:83]
 v_pk_mul_f32 v[84:85], v[36:37], v[84:85]
 v_pk_mul_f32 v[86:87], v[38:39], v[86:87]
 v_pk_add_f32 v[56:57], v[56:57], 1.0
 v_pk_add_f32 v[58:59], v[58:59], 1.0
 v_pk_add_f32 v[60:61], v[60:61], 1.0
 v_pk_add_f32 v[62:63], v[62:63], 1.0
 v_pk_add_f32 v[64:65], v[64:65], 1.0
 v_pk_add_f32 v[66:67], v[66:67], 1.0
 v_pk_add_f32 v[68:69], v[68:69], 1.0
 v_pk_add_f32 v[70:71], v[70:71], 1.0
 v_pk_fma_f32 v[88:89], v[72:73], v[72:73], v[88:89]
 v_pk_fma_f32 v[90:91], v[74:75], v[74:75], v[90:91]
 v_pk_fma_f32 v[92:93], v[76:77], v[76:77], v[92:93]
 v_pk_fma_f32 v[94:95], v[78:79], v[78:79], v[94:95]
 v_pk_fma_f32 v[96:97], v[80:81], v[80:81], v[96:97]
 v_pk_fma_f32 v[98:99], v[82:83], v[82:83], v[98:99]
 v_pk_fma_f32 v[100:101], v[84:85], v[84:85], v[100:101]
 v_pk_fma_f32 v[102:103], v[86:87], v[86:87], v[102:103]
 v_cvt_pk_bf16_f32 v72, v72, v73
 v_cvt_pk_bf16_f32 v74, v74, v75
 v_cvt_pk_bf16_f32 v76, v76, v77
 v_cvt_pk_bf16_f32 v78, v78, v79
 v_cvt_pk_bf16_f32 v80, v80, v81
 v_cvt_pk_bf16_f32 v82, v82, v83
 v_cvt_pk_bf16_f32 v84, v84, v85
 v_cvt_pk_bf16_f32 v86, v86, v87
 v_accvgpr_write_b32 a8, v72
 v_accvgpr_write_b32 a9, v74
 v_accvgpr_write_b32 a10, v76
 v_accvgpr_write_b32 a11, v78
 v_accvgpr_write_b32 a12, v80
 v_accvgpr_write_b32 a13, v82
 v_accvgpr_write_b32 a14, v84
 v_accvgpr_write_b32 a15, v86
 v_pk_fma_f32 v[72:73], v[8:9], v[8:9], s[50:51]
 v_pk_fma_f32 v[74:75], v[10:11], v[10:11], s[50:51]
 v_pk_fma_f32 v[76:77], v[12:13], v[12:13], s[50:51]
 v_pk_fma_f32 v[78:79], v[14:15], v[14:15], s[50:51]
 v_pk_fma_f32 v[80:81], v[16:17], v[16:17], s[50:51]
 v_pk_fma_f32 v[82:83], v[18:19], v[18:19], s[50:51]
 v_pk_fma_f32 v[84:85], v[20:21], v[20:21], s[50:51]
 v_pk_fma_f32 v[86:87], v[22:23], v[22:23], s[50:51]
 v_pk_mul_f32 v[72:73], v[72:73], v[8:9]
 v_pk_mul_f32 v[74:75], v[74:75], v[10:11]
 v_pk_mul_f32 v[76:77], v[76:77], v[12:13]
 v_pk_mul_f32 v[78:79], v[78:79], v[14:15]
 v_pk_mul_f32 v[80:81], v[80:81], v[16:17]
 v_pk_mul_f32 v[82:83], v[82:83], v[18:19]
 v_pk_mul_f32 v[84:85], v[84:85], v[20:21]
 v_pk_mul_f32 v[86:87], v[86:87], v[22:23]
 s_waitcnt vmcnt(0) lgkmcnt(0)
 v_cmp_gt_u32 vcc, 64, v243
 s_nop 4
 s_cmp_eq_u64 vcc, 0
 s_cbranch_scc1 L_hs_done2
 s_mov_b32 s84, 0
L_hs_loop:
 buffer_load_dword v243, v242, s[40:43], 0 offen sc1
 s_waitcnt vmcnt(0)
 v_cmp_gt_u32 vcc, 64, v243
 s_nop 4
 s_cmp_eq_u64 vcc, 0
 s_cbranch_scc1 L_hs_done
 s_add_u32 s84, s84, 1
 s_cmp_lt_u32 s84, 0x40000
 s_cbranch_scc1 L_hs_loop
L_hs_done:
L_hs_done2:
 v_mfma_f32_32x32x16_bf16 v[24:39], a[152:155], a[208:211], 0
 ds_read_b128 a[204:207], v2 offset:56320
 v_rcp_f32 v56, v56
 v_exp_f32_e64 v72, v72
 v_mfma_f32_32x32x16_bf16 v[24:39], a[156:159], a[212:215], v[24:39]
 ds_read_b128 a[208:211], v2 offset:57344
 buffer_load_dwordx4 a[232:235], v5, s[24:27], s62 offen offset:0 sc1
 v_rcp_f32 v57, v57
 v_exp_f32 v73, v73
 v_mfma_f32_32x32x16_bf16 v[24:39], a[160:163], a[216:219], v[24:39]
 ds_read_b128 a[212:215], v2 offset:58368
 v_rcp_f32 v58, v58
 v_exp_f32 v74, v74
 v_mfma_f32_32x32x16_bf16 v[24:39], a[164:167], a[220:223], v[24:39]
 ds_read_b128 a[216:219], v2 offset:59392
 buffer_load_dwordx4 a[248:251], v5, s[24:27], s63 offen offset:0 sc1
 v_rcp_f32 v59, v59
 v_exp_f32 v75, v75
 v_rcp_f32_e64 v60, v60
 v_mfma_f32_32x32x16_bf16 v[24:39], a[168:171], a[224:227], v[24:39]
 ds_read_b128 a[220:223], v2 offset:60416
 v_exp_f32 v76, v76
 v_rcp_f32 v61, v61
 v_mfma_f32_32x32x16_bf16 v[24:39], a[172:175], a[228:231], v[24:39]
 ds_read_b128 a[224:227], v3 offset:36864
 buffer_load_dwordx4 a[236:239], v5, s[24:27], s62 offen offset:1024 sc1
 v_exp_f32_e64 v77, v77
 v_rcp_f32 v62, v62
 s_waitcnt lgkmcnt(4)
 v_mfma_f32_32x32x16_bf16 v[24:39], a[176:179], a[200:203], v[24:39]
 ds_read_b128 a[228:231], v3 offset:37888
 buffer_load_dwordx4 a[240:243], v5, s[24:27], s62 offen offset:2048 sc1
 v_exp_f32 v78, v78
 v_rcp_f32 v63, v63
 v_mfma_f32_32x32x16_bf16 v[24:39], a[180:183], a[204:207], v[24:39]
 ds_read_b128 a[200:203], v3 offset:38912
 v_exp_f32 v79, v79
 v_rcp_f32 v64, v64
 v_exp_f32_e64 v80, v80
 v_mfma_f32_32x32x16_bf16 v[24:39], a[184:187], a[208:211], v[24:39]
 ds_read_b128 a[204:207], v3 offset:39936
 buffer_load_dwordx4 a[252:255], v5, s[24:27], s63 offen offset:1024 sc1
 v_rcp_f32_e64 v65, v65
 v_exp_f32 v81, v81
 s_waitcnt lgkmcnt(4)
 v_mfma_f32_32x32x16_bf16 v[24:39], a[188:191], a[212:215], v[24:39]
 ds_read_b128 a[208:211], v3 offset:40960
 v_rcp_f32 v66, v66
 v_exp_f32 v82, v82
 v_mfma_f32_32x32x16_bf16 v[24:39], a[192:195], a[216:219], v[24:39]
 ds_read_b128 a[212:215], v3 offset:41984
 buffer_load_dwordx4 a[244:247], v5, s[24:27], s62 offen offset:3072 sc1
 v_rcp_f32 v67, v67
 v_exp_f32 v83, v83
 v_mfma_f32_32x32x16_bf16 v[24:39], a[196:199], a[220:223], v[24:39]
 ds_read_b128 a[216:219], v3 offset:43008
 v_rcp_f32 v68, v68
 v_exp_f32 v84, v84
 v_rcp_f32 v69, v69
 v_exp_f32 v85, v85
 v_rcp_f32 v70, v70
 v_exp_f32 v86, v86
 v_rcp_f32 v71, v71
 v_exp_f32 v87, v87
 v_pk_mul_f32 v[56:57], v[40:41], v[56:57]
 v_pk_mul_f32 v[58:59], v[42:43], v[58:59]
 v_pk_mul_f32 v[60:61], v[44:45], v[60:61]
 v_pk_mul_f32 v[62:63], v[46:47], v[62:63]
 v_pk_mul_f32 v[64:65], v[48:49], v[64:65]
 v_pk_mul_f32 v[66:67], v[50:51], v[66:67]
 v_pk_mul_f32 v[68:69], v[52:53], v[68:69]
 v_pk_mul_f32 v[70:71], v[54:55], v[70:71]
 v_pk_add_f32 v[72:73], v[72:73], 1.0
 v_pk_add_f32 v[74:75], v[74:75], 1.0
 v_pk_add_f32 v[76:77], v[76:77], 1.0
 v_pk_add_f32 v[78:79], v[78:79], 1.0
 v_pk_add_f32 v[80:81], v[80:81], 1.0
 v_pk_add_f32 v[82:83], v[82:83], 1.0
 v_pk_add_f32 v[84:85], v[84:85], 1.0
 v_pk_add_f32 v[86:87], v[86:87], 1.0
 v_pk_fma_f32 v[88:89], v[56:57], v[56:57], v[88:89]
 v_pk_fma_f32 v[90:91], v[58:59], v[58:59], v[90:91]
 v_pk_fma_f32 v[92:93], v[60:61], v[60:61], v[92:93]
 v_pk_fma_f32 v[94:95], v[62:63], v[62:63], v[94:95]
 v_pk_fma_f32 v[96:97], v[64:65], v[64:65], v[96:97]
 v_pk_fma_f32 v[98:99], v[66:67], v[66:67], v[98:99]
 v_pk_fma_f32 v[100:101], v[68:69], v[68:69], v[100:101]
 v_pk_fma_f32 v[102:103], v[70:71], v[70:71], v[102:103]
 v_cvt_pk_bf16_f32 v56, v56, v57
 v_cvt_pk_bf16_f32 v58, v58, v59
 v_cvt_pk_bf16_f32 v60, v60, v61
 v_cvt_pk_bf16_f32 v62, v62, v63
 v_cvt_pk_bf16_f32 v64, v64, v65
 v_cvt_pk_bf16_f32 v66, v66, v67
 v_cvt_pk_bf16_f32 v68, v68, v69
 v_cvt_pk_bf16_f32 v70, v70, v71
 v_accvgpr_write_b32 a16, v56
 v_accvgpr_write_b32 a17, v58
 v_accvgpr_write_b32 a18, v60
 v_accvgpr_write_b32 a19, v62
 v_accvgpr_write_b32 a20, v64
 v_accvgpr_write_b32 a21, v66
 v_accvgpr_write_b32 a22, v68
 v_accvgpr_write_b32 a23, v70
 v_pk_fma_f32 v[56:57], v[24:25], v[24:25], s[50:51]
 v_pk_fma_f32 v[58:59], v[26:27], v[26:27], s[50:51]
 v_pk_fma_f32 v[60:61], v[28:29], v[28:29], s[50:51]
 v_pk_fma_f32 v[62:63], v[30:31], v[30:31], s[50:51]
 v_pk_fma_f32 v[64:65], v[32:33], v[32:33], s[50:51]
 v_pk_fma_f32 v[66:67], v[34:35], v[34:35], s[50:51]
 v_pk_fma_f32 v[68:69], v[36:37], v[36:37], s[50:51]
 v_pk_fma_f32 v[70:71], v[38:39], v[38:39], s[50:51]
 v_pk_mul_f32 v[56:57], v[56:57], v[24:25]
 v_pk_mul_f32 v[58:59], v[58:59], v[26:27]
 v_pk_mul_f32 v[60:61], v[60:61], v[28:29]
 v_pk_mul_f32 v[62:63], v[62:63], v[30:31]
 v_pk_mul_f32 v[64:65], v[64:65], v[32:33]
 v_pk_mul_f32 v[66:67], v[66:67], v[34:35]
 v_pk_mul_f32 v[68:69], v[68:69], v[36:37]
 v_pk_mul_f32 v[70:71], v[70:71], v[38:39]
 s_waitcnt lgkmcnt(4)
 v_mfma_f32_32x32x16_bf16 v[40:55], a[152:155], a[224:227], 0
 ds_read_b128 a[220:223], v3 offset:44032
 v_rcp_f32 v72, v72
 v_exp_f32_e64 v56, v56
 v_mfma_f32_32x32x16_bf16 v[40:55], a[156:159], a[228:231], v[40:55]
 ds_read_b128 a[224:227], v3 offset:45056
 v_rcp_f32 v73, v73
 v_exp_f32 v57, v57
 v_mfma_f32_32x32x16_bf16 v[40:55], a[160:163], a[200:203], v[40:55]
 ds_read_b128 a[228:231], v3 offset:46080
 v_rcp_f32_e64 v74, v74
 v_exp_f32 v58, v58
 s_waitcnt lgkmcnt(4)
 v_mfma_f32_32x32x16_bf16 v[40:55], a[164:167], a[204:207], v[40:55]
 ds_read_b128 a[200:203], v3 offset:47104
 v_rcp_f32 v75, v75
 v_exp_f32 v59, v59
 v_rcp_f32_e64 v76, v76
 v_mfma_f32_32x32x16_bf16 v[40:55], a[168:171], a[208:211], v[40:55]
 ds_read_b128 a[204:207], v3 offset:48128
 v_exp_f32 v60, v60
 v_rcp_f32 v77, v77
 v_mfma_f32_32x32x16_bf16 v[40:55], a[172:175], a[212:215], v[40:55]
 v_exp_f32_e64 v61, v61
 v_rcp_f32 v78, v78
 s_waitcnt lgkmcnt(3)
 v_mfma_f32_32x32x16_bf16 v[40:55], a[176:179], a[216:219], v[40:55]
 buffer_load_dwordx4 a[176:179], v5, s[24:27], s63 offen offset:2048 sc1
 v_exp_f32 v62, v62
 v_rcp_f32 v79, v79
 v_mfma_f32_32x32x16_bf16 v[40:55], a[180:183], a[220:223], v[40:55]
 buffer_load_dwordx4 a[180:183], v5, s[24:27], s63 offen offset:3072 sc1
 v_exp_f32 v63, v63
 v_rcp_f32 v80, v80
 v_exp_f32_e64 v64, v64
 v_mfma_f32_32x32x16_bf16 v[40:55], a[184:187], a[224:227], v[40:55]
 buffer_load_dwordx4 a[184:187], v5, s[24:27], s55 offen offset:0 sc1
 v_rcp_f32_e64 v81, v81
 v_exp_f32 v65, v65
 s_waitcnt lgkmcnt(0)
 v_mfma_f32_32x32x16_bf16 v[40:55], a[188:191], a[228:231], v[40:55]
 buffer_load_dwordx4 a[188:191], v5, s[24:27], s55 offen offset:1024 sc1
 v_rcp_f32 v82, v82
 v_exp_f32 v66, v66
 v_mfma_f32_32x32x16_bf16 v[40:55], a[192:195], a[200:203], v[40:55]
 buffer_load_dwordx4 a[192:195], v5, s[24:27], s55 offen offset:2048 sc1
 v_rcp_f32 v83, v83
 v_exp_f32 v67, v67
 v_mfma_f32_32x32x16_bf16 v[40:55], a[196:199], a[204:207], v[40:55]
 buffer_load_dwordx4 a[196:199], v5, s[24:27], s55 offen offset:3072 sc1
 v_rcp_f32 v84, v84
 v_exp_f32 v68, v68
 v_rcp_f32 v85, v85
 v_exp_f32 v69, v69
 v_rcp_f32 v86, v86
 v_exp_f32 v70, v70
 v_rcp_f32 v87, v87
 v_exp_f32 v71, v71
 v_pk_mul_f32 v[72:73], v[8:9], v[72:73]
 v_pk_mul_f32 v[74:75], v[10:11], v[74:75]
 v_pk_mul_f32 v[76:77], v[12:13], v[76:77]
 v_pk_mul_f32 v[78:79], v[14:15], v[78:79]
 v_pk_mul_f32 v[80:81], v[16:17], v[80:81]
 v_pk_mul_f32 v[82:83], v[18:19], v[82:83]
 v_pk_mul_f32 v[84:85], v[20:21], v[84:85]
 v_pk_mul_f32 v[86:87], v[22:23], v[86:87]
 v_pk_add_f32 v[56:57], v[56:57], 1.0
 v_pk_add_f32 v[58:59], v[58:59], 1.0
 v_pk_add_f32 v[60:61], v[60:61], 1.0
 v_pk_add_f32 v[62:63], v[62:63], 1.0
 v_pk_add_f32 v[64:65], v[64:65], 1.0
 v_pk_add_f32 v[66:67], v[66:67], 1.0
 v_pk_add_f32 v[68:69], v[68:69], 1.0
 v_pk_add_f32 v[70:71], v[70:71], 1.0
 v_pk_fma_f32 v[88:89], v[72:73], v[72:73], v[88:89]
 v_pk_fma_f32 v[90:91], v[74:75], v[74:75], v[90:91]
 v_pk_fma_f32 v[92:93], v[76:77], v[76:77], v[92:93]
 v_pk_fma_f32 v[94:95], v[78:79], v[78:79], v[94:95]
 v_pk_fma_f32 v[96:97], v[80:81], v[80:81], v[96:97]
 v_pk_fma_f32 v[98:99], v[82:83], v[82:83], v[98:99]
 v_pk_fma_f32 v[100:101], v[84:85], v[84:85], v[100:101]
 v_pk_fma_f32 v[102:103], v[86:87], v[86:87], v[102:103]
 v_cvt_pk_bf16_f32 v72, v72, v73
 v_cvt_pk_bf16_f32 v74, v74, v75
 v_cvt_pk_bf16_f32 v76, v76, v77
 v_cvt_pk_bf16_f32 v78, v78, v79
 v_cvt_pk_bf16_f32 v80, v80, v81
 v_cvt_pk_bf16_f32 v82, v82, v83
 v_cvt_pk_bf16_f32 v84, v84, v85
 v_cvt_pk_bf16_f32 v86, v86, v87
 v_accvgpr_write_b32 a24, v72
 v_accvgpr_write_b32 a25, v74
 v_accvgpr_write_b32 a26, v76
 v_accvgpr_write_b32 a27, v78
 v_accvgpr_write_b32 a28, v80
 v_accvgpr_write_b32 a29, v82
 v_accvgpr_write_b32 a30, v84
 v_accvgpr_write_b32 a31, v86
 v_pk_fma_f32 v[72:73], v[40:41], v[40:41], s[50:51]
 v_pk_fma_f32 v[74:75], v[42:43], v[42:43], s[50:51]
 v_pk_fma_f32 v[76:77], v[44:45], v[44:45], s[50:51]
 v_pk_fma_f32 v[78:79], v[46:47], v[46:47], s[50:51]
 v_pk_fma_f32 v[80:81], v[48:49], v[48:49], s[50:51]
 v_pk_fma_f32 v[82:83], v[50:51], v[50:51], s[50:51]
 v_pk_fma_f32 v[84:85], v[52:53], v[52:53], s[50:51]
 v_pk_fma_f32 v[86:87], v[54:55], v[54:55], s[50:51]
 v_pk_mul_f32 v[72:73], v[72:73], v[40:41]
 v_pk_mul_f32 v[74:75], v[74:75], v[42:43]
 v_pk_mul_f32 v[76:77], v[76:77], v[44:45]
 v_pk_mul_f32 v[78:79], v[78:79], v[46:47]
 v_pk_mul_f32 v[80:81], v[80:81], v[48:49]
 v_pk_mul_f32 v[82:83], v[82:83], v[50:51]
 v_pk_mul_f32 v[84:85], v[84:85], v[52:53]
 v_pk_mul_f32 v[86:87], v[86:87], v[54:55]
 s_waitcnt vmcnt(8)
 v_mfma_f32_32x32x16_bf16 v[8:23], a[232:235], v[104:107], 0
 v_rcp_f32 v56, v56
 v_exp_f32_e64 v72, v72
 v_mfma_f32_32x32x16_bf16 v[8:23], a[236:239], v[108:111], v[8:23]
 v_rcp_f32 v57, v57
 v_exp_f32 v73, v73
 v_mfma_f32_32x32x16_bf16 v[8:23], a[240:243], v[112:115], v[8:23]
 v_rcp_f32_e64 v58, v58
 v_exp_f32 v74, v74
 s_waitcnt vmcnt(6)
 v_mfma_f32_32x32x16_bf16 v[8:23], a[244:247], v[116:119], v[8:23]
 v_rcp_f32 v59, v59
 v_exp_f32 v75, v75
 v_rcp_f32_e64 v60, v60
 v_mfma_f32_32x32x16_bf16 v[8:23], a[248:251], v[120:123], v[8:23]
 v_exp_f32 v76, v76
 v_rcp_f32 v61, v61
 v_mfma_f32_32x32x16_bf16 v[8:23], a[252:255], v[124:127], v[8:23]
 v_exp_f32_e64 v77, v77
 v_rcp_f32 v62, v62
 s_waitcnt vmcnt(3)
 v_mfma_f32_32x32x16_bf16 v[8:23], a[176:179], v[128:131], v[8:23]
 v_exp_f32 v78, v78
 v_rcp_f32 v63, v63
 v_mfma_f32_32x32x16_bf16 v[8:23], a[180:183], v[132:135], v[8:23]
 v_exp_f32 v79, v79
 v_rcp_f32 v64, v64
 v_exp_f32_e64 v80, v80
 v_mfma_f32_32x32x16_bf16 v[8:23], a[184:187], v[136:139], v[8:23]
 v_rcp_f32_e64 v65, v65
 v_exp_f32 v81, v81
 s_waitcnt vmcnt(0)
 v_mfma_f32_32x32x16_bf16 v[8:23], a[188:191], v[140:143], v[8:23]
 v_rcp_f32 v66, v66
 v_exp_f32 v82, v82
 v_mfma_f32_32x32x16_bf16 v[8:23], a[192:195], v[144:147], v[8:23]
 v_rcp_f32 v67, v67
 v_exp_f32 v83, v83
 v_mfma_f32_32x32x16_bf16 v[8:23], a[196:199], v[148:151], v[8:23]
 v_rcp_f32 v68, v68
 v_exp_f32 v84, v84
 v_rcp_f32 v69, v69
 v_exp_f32 v85, v85
 v_rcp_f32 v70, v70
 v_exp_f32 v86, v86
 v_rcp_f32 v71, v71
 v_exp_f32 v87, v87
 v_pk_mul_f32 v[56:57], v[24:25], v[56:57]
 v_pk_mul_f32 v[58:59], v[26:27], v[58:59]
 v_pk_mul_f32 v[60:61], v[28:29], v[60:61]
 v_pk_mul_f32 v[62:63], v[30:31], v[62:63]
 v_pk_mul_f32 v[64:65], v[32:33], v[64:65]
 v_pk_mul_f32 v[66:67], v[34:35], v[66:67]
 v_pk_mul_f32 v[68:69], v[36:37], v[68:69]
 v_pk_mul_f32 v[70:71], v[38:39], v[70:71]
 v_pk_add_f32 v[72:73], v[72:73], 1.0
 v_pk_add_f32 v[74:75], v[74:75], 1.0
 v_pk_add_f32 v[76:77], v[76:77], 1.0
 v_pk_add_f32 v[78:79], v[78:79], 1.0
 v_pk_add_f32 v[80:81], v[80:81], 1.0
 v_pk_add_f32 v[82:83], v[82:83], 1.0
 v_pk_add_f32 v[84:85], v[84:85], 1.0
 v_pk_add_f32 v[86:87], v[86:87], 1.0
 v_pk_fma_f32 v[88:89], v[56:57], v[56:57], v[88:89]
 v_pk_fma_f32 v[90:91], v[58:59], v[58:59], v[90:91]
 v_pk_fma_f32 v[92:93], v[60:61], v[60:61], v[92:93]
 v_pk_fma_f32 v[94:95], v[62:63], v[62:63], v[94:95]
 v_pk_fma_f32 v[96:97], v[64:65], v[64:65], v[96:97]
 v_pk_fma_f32 v[98:99], v[66:67], v[66:67], v[98:99]
 v_pk_fma_f32 v[100:101], v[68:69], v[68:69], v[100:101]
 v_pk_fma_f32 v[102:103], v[70:71], v[70:71], v[102:103]
 v_cvt_pk_bf16_f32 v56, v56, v57
 v_cvt_pk_bf16_f32 v58, v58, v59
 v_cvt_pk_bf16_f32 v60, v60, v61
 v_cvt_pk_bf16_f32 v62, v62, v63
 v_cvt_pk_bf16_f32 v64, v64, v65
 v_cvt_pk_bf16_f32 v66, v66, v67
 v_cvt_pk_bf16_f32 v68, v68, v69
 v_cvt_pk_bf16_f32 v70, v70, v71
 v_accvgpr_write_b32 a32, v56
 v_accvgpr_write_b32 a33, v58
 v_accvgpr_write_b32 a34, v60
 v_accvgpr_write_b32 a35, v62
 v_accvgpr_write_b32 a36, v64
 v_accvgpr_write_b32 a37, v66
 v_accvgpr_write_b32 a38, v68
 v_accvgpr_write_b32 a39, v70
 v_pk_fma_f32 v[56:57], v[8:9], v[8:9], s[50:51]
 v_pk_fma_f32 v[58:59], v[10:11], v[10:11], s[50:51]
 v_pk_fma_f32 v[60:61], v[12:13], v[12:13], s[50:51]
 v_pk_fma_f32 v[62:63], v[14:15], v[14:15], s[50:51]
 v_pk_fma_f32 v[64:65], v[16:17], v[16:17], s[50:51]
 v_pk_fma_f32 v[66:67], v[18:19], v[18:19], s[50:51]
 v_pk_fma_f32 v[68:69], v[20:21], v[20:21], s[50:51]
 v_pk_fma_f32 v[70:71], v[22:23], v[22:23], s[50:51]
 v_pk_mul_f32 v[56:57], v[56:57], v[8:9]
 v_pk_mul_f32 v[58:59], v[58:59], v[10:11]
 v_pk_mul_f32 v[60:61], v[60:61], v[12:13]
 v_pk_mul_f32 v[62:63], v[62:63], v[14:15]
 v_pk_mul_f32 v[64:65], v[64:65], v[16:17]
 v_pk_mul_f32 v[66:67], v[66:67], v[18:19]
 v_pk_mul_f32 v[68:69], v[68:69], v[20:21]
 v_pk_mul_f32 v[70:71], v[70:71], v[22:23]
 v_mfma_f32_32x32x16_bf16 v[24:39], a[232:235], v[152:155], 0
 v_rcp_f32 v72, v72
 v_exp_f32 v56, v56
 v_mfma_f32_32x32x16_bf16 v[24:39], a[236:239], v[156:159], v[24:39]
 v_rcp_f32 v73, v73
 v_exp_f32 v57, v57
 v_mfma_f32_32x32x16_bf16 v[24:39], a[240:243], v[160:163], v[24:39]
 v_rcp_f32 v74, v74
 v_exp_f32 v58, v58
 v_mfma_f32_32x32x16_bf16 v[24:39], a[244:247], v[164:167], v[24:39]
 v_rcp_f32 v75, v75
 v_exp_f32 v59, v59
 v_rcp_f32_e64 v76, v76
 v_mfma_f32_32x32x16_bf16 v[24:39], a[248:251], v[168:171], v[24:39]
 v_exp_f32 v60, v60
 v_rcp_f32 v77, v77
 v_mfma_f32_32x32x16_bf16 v[24:39], a[252:255], v[172:175], v[24:39]
 v_exp_f32 v61, v61
 v_rcp_f32 v78, v78
 v_mfma_f32_32x32x16_bf16 v[24:39], a[176:179], v[176:179], v[24:39]
 v_exp_f32 v62, v62
 v_rcp_f32 v79, v79
 v_mfma_f32_32x32x16_bf16 v[24:39], a[180:183], v[180:183], v[24:39]
 v_exp_f32 v63, v63
 v_rcp_f32 v80, v80
 v_exp_f32_e64 v64, v64
 v_mfma_f32_32x32x16_bf16 v[24:39], a[184:187], v[184:187], v[24:39]
 v_rcp_f32 v81, v81
 v_exp_f32 v65, v65
 v_mfma_f32_32x32x16_bf16 v[24:39], a[188:191], v[188:191], v[24:39]
 v_rcp_f32 v82, v82
 v_exp_f32 v66, v66
 v_mfma_f32_32x32x16_bf16 v[24:39], a[192:195], v[192:195], v[24:39]
 v_rcp_f32 v83, v83
 v_exp_f32 v67, v67
 v_mfma_f32_32x32x16_bf16 v[24:39], a[196:199], v[196:199], v[24:39]
 v_rcp_f32 v84, v84
 v_exp_f32 v68, v68
 v_rcp_f32 v85, v85
 v_exp_f32 v69, v69
 v_rcp_f32 v86, v86
 v_exp_f32 v70, v70
 v_rcp_f32 v87, v87
 v_exp_f32 v71, v71
 v_pk_mul_f32 v[72:73], v[40:41], v[72:73]
 v_pk_mul_f32 v[74:75], v[42:43], v[74:75]
 v_pk_mul_f32 v[76:77], v[44:45], v[76:77]
 v_pk_mul_f32 v[78:79], v[46:47], v[78:79]
 v_pk_mul_f32 v[80:81], v[48:49], v[80:81]
 v_pk_mul_f32 v[82:83], v[50:51], v[82:83]
 v_pk_mul_f32 v[84:85], v[52:53], v[84:85]
 v_pk_mul_f32 v[86:87], v[54:55], v[86:87]
 v_pk_add_f32 v[56:57], v[56:57], 1.0
 v_pk_add_f32 v[58:59], v[58:59], 1.0
 v_pk_add_f32 v[60:61], v[60:61], 1.0
 v_pk_add_f32 v[62:63], v[62:63], 1.0
 v_pk_add_f32 v[64:65], v[64:65], 1.0
 v_pk_add_f32 v[66:67], v[66:67], 1.0
 v_pk_add_f32 v[68:69], v[68:69], 1.0
 v_pk_add_f32 v[70:71], v[70:71], 1.0
 v_pk_fma_f32 v[88:89], v[72:73], v[72:73], v[88:89]
 v_pk_fma_f32 v[90:91], v[74:75], v[74:75], v[90:91]
 v_pk_fma_f32 v[92:93], v[76:77], v[76:77], v[92:93]
 v_pk_fma_f32 v[94:95], v[78:79], v[78:79], v[94:95]
 v_pk_fma_f32 v[96:97], v[80:81], v[80:81], v[96:97]
 v_pk_fma_f32 v[98:99], v[82:83], v[82:83], v[98:99]
 v_pk_fma_f32 v[100:101], v[84:85], v[84:85], v[100:101]
 v_pk_fma_f32 v[102:103], v[86:87], v[86:87], v[102:103]
 v_cvt_pk_bf16_f32 v72, v72, v73
 v_cvt_pk_bf16_f32 v74, v74, v75
 v_cvt_pk_bf16_f32 v76, v76, v77
 v_cvt_pk_bf16_f32 v78, v78, v79
 v_cvt_pk_bf16_f32 v80, v80, v81
 v_cvt_pk_bf16_f32 v82, v82, v83
 v_cvt_pk_bf16_f32 v84, v84, v85
 v_cvt_pk_bf16_f32 v86, v86, v87
 v_accvgpr_write_b32 a40, v72
 v_accvgpr_write_b32 a41, v74
 v_accvgpr_write_b32 a42, v76
 v_accvgpr_write_b32 a43, v78
 v_accvgpr_write_b32 a44, v80
 v_accvgpr_write_b32 a45, v82
 v_accvgpr_write_b32 a46, v84
 v_accvgpr_write_b32 a47, v86
 v_pk_fma_f32 v[72:73], v[24:25], v[24:25], s[50:51]
 v_pk_fma_f32 v[74:75], v[26:27], v[26:27], s[50:51]
 v_pk_fma_f32 v[76:77], v[28:29], v[28:29], s[50:51]
 v_pk_fma_f32 v[78:79], v[30:31], v[30:31], s[50:51]
 v_pk_fma_f32 v[80:81], v[32:33], v[32:33], s[50:51]
 v_pk_fma_f32 v[82:83], v[34:35], v[34:35], s[50:51]
 v_pk_fma_f32 v[84:85], v[36:37], v[36:37], s[50:51]
 v_pk_fma_f32 v[86:87], v[38:39], v[38:39], s[50:51]
 v_pk_mul_f32 v[72:73], v[72:73], v[24:25]
 v_pk_mul_f32 v[74:75], v[74:75], v[26:27]
 v_pk_mul_f32 v[76:77], v[76:77], v[28:29]
 v_pk_mul_f32 v[78:79], v[78:79], v[30:31]
 v_pk_mul_f32 v[80:81], v[80:81], v[32:33]
 v_pk_mul_f32 v[82:83], v[82:83], v[34:35]
 v_pk_mul_f32 v[84:85], v[84:85], v[36:37]
 v_pk_mul_f32 v[86:87], v[86:87], v[38:39]
 v_mfma_f32_32x32x16_bf16 v[40:55], a[232:235], a[96:99], 0
 v_add_f32_dpp v88, v88, v88 row_ror:8 row_mask:0xf bank_mask:0x3
 v_rcp_f32_e64 v56, v56
 v_add_f32_dpp v90, v90, v90 row_ror:8 row_mask:0xf bank_mask:0x3
 v_exp_f32_e64 v72, v72
 v_add_f32_dpp v92, v92, v92 row_ror:8 row_mask:0xf bank_mask:0x3
 v_add_f32_dpp v94, v94, v94 row_ror:8 row_mask:0xf bank_mask:0x3
 v_mfma_f32_32x32x16_bf16 v[40:55], a[236:239], a[100:103], v[40:55]
 s_mul_i32 s62, s58, 24576
 s_add_u32 s62, s62, s54
 s_add_u32 s63, s62, 4096
 s_add_u32 s55, s62, 8192
 v_add_f32_dpp v96, v96, v96 row_ror:8 row_mask:0xf bank_mask:0x3
 v_rcp_f32 v57, v57
 v_add_f32_dpp v98, v98, v98 row_ror:8 row_mask:0xf bank_mask:0x3
 v_exp_f32_e64 v73, v73
 v_add_f32_dpp v100, v100, v100 row_ror:8 row_mask:0xf bank_mask:0x3
 v_add_f32_dpp v102, v102, v102 row_ror:8 row_mask:0xf bank_mask:0x3
 v_mfma_f32_32x32x16_bf16 v[40:55], a[240:243], a[104:107], v[40:55]
 v_add_f32_dpp v88, v89, v89 row_ror:8 row_mask:0xf bank_mask:0xc
 v_rcp_f32_e64 v58, v58
 v_add_f32_dpp v90, v91, v91 row_ror:8 row_mask:0xf bank_mask:0xc
 v_exp_f32_e64 v74, v74
 v_add_f32_dpp v92, v93, v93 row_ror:8 row_mask:0xf bank_mask:0xc
 v_add_f32_dpp v94, v95, v95 row_ror:8 row_mask:0xf bank_mask:0xc
 v_mfma_f32_32x32x16_bf16 v[40:55], a[244:247], a[108:111], v[40:55]
 buffer_load_dwordx4 a[152:155], v5, s[24:27], s62 offen offset:0 sc1
 v_add_f32_dpp v96, v97, v97 row_ror:8 row_mask:0xf bank_mask:0xc
 v_rcp_f32_e64 v59, v59
 v_add_f32_dpp v98, v99, v99 row_ror:8 row_mask:0xf bank_mask:0xc
 v_exp_f32_e64 v75, v75
 v_add_f32_dpp v100, v101, v101 row_ror:8 row_mask:0xf bank_mask:0xc
 v_rcp_f32_e64 v60, v60
 v_add_f32_dpp v102, v103, v103 row_ror:8 row_mask:0xf bank_mask:0xc
 v_mfma_f32_32x32x16_bf16 v[40:55], a[248:251], a[112:115], v[40:55]
 v_add_f32_dpp v88, v88, v88 row_shl:4 row_mask:0xf bank_mask:0x5
 v_exp_f32_e64 v76, v76
 v_add_f32_dpp v92, v92, v92 row_shl:4 row_mask:0xf bank_mask:0x5
 v_rcp_f32_e64 v61, v61
 v_add_f32_dpp v96, v96, v96 row_shl:4 row_mask:0xf bank_mask:0x5
 v_add_f32_dpp v100, v100, v100 row_shl:4 row_mask:0xf bank_mask:0x5
 v_mfma_f32_32x32x16_bf16 v[40:55], a[252:255], a[116:119], v[40:55]
 v_add_f32_dpp v88, v90, v90 row_shr:4 row_mask:0xf bank_mask:0xa
 v_exp_f32_e64 v77, v77
 v_add_f32_dpp v92, v94, v94 row_shr:4 row_mask:0xf bank_mask:0xa
 v_rcp_f32_e64 v62, v62
 v_add_f32_dpp v96, v98, v98 row_shr:4 row_mask:0xf bank_mask:0xa
 v_add_f32_dpp v100, v102, v102 row_shr:4 row_mask:0xf bank_mask:0xa
 v_mfma_f32_32x32x16_bf16 v[40:55], a[176:179], a[120:123], v[40:55]
 s_lshl_b32 s6, s56, 8
 v_exp_f32 v78, v78
 v_add_u32_e64 v7, s6, v6
 v_rcp_f32 v63, v63
 v_permlane16_swap_b32 v88, v92
 v_mfma_f32_32x32x16_bf16 v[40:55], a[180:183], a[124:127], v[40:55]
 v_permlane16_swap_b32 v96, v100
 v_exp_f32 v79, v79
 v_add_f32 v88, v88, v92
 v_rcp_f32 v64, v64
 v_add_f32 v96, v96, v100
 v_exp_f32 v80, v80
 v_mfma_f32_32x32x16_bf16 v[40:55], a[184:187], a[128:131], v[40:55]
 buffer_load_dwordx4 a[156:159], v5, s[24:27], s62 offen offset:1024 sc1
 v_add_f32_dpp v88, v88, v88 quad_perm:[2,3,0,1] row_mask:0xf bank_mask:0xf
 v_rcp_f32_e64 v65, v65
 v_add_f32_dpp v96, v96, v96 quad_perm:[2,3,0,1] row_mask:0xf bank_mask:0xf
 v_exp_f32_e64 v81, v81
 v_mfma_f32_32x32x16_bf16 v[40:55], a[188:191], a[132:135], v[40:55]
 v_cndmask_b32 v88, v88, v96, s[52:53]
 v_rcp_f32 v66, v66
 s_nop 0
 v_add_f32_dpp v89, v88, v88 quad_perm:[1,0,3,2] row_mask:0xf bank_mask:0xf
 v_exp_f32_e64 v82, v82
 v_mfma_f32_32x32x16_bf16 v[40:55], a[192:195], a[136:139], v[40:55]
 ds_read_b128 a[208:211], v2 offset:47104
 ds_write_b32 v7, v89
 v_rcp_f32 v67, v67
 v_exp_f32 v83, v83
 v_mfma_f32_32x32x16_bf16 v[40:55], a[196:199], a[140:143], v[40:55]
 ds_read_b128 a[212:215], v2 offset:48128
 v_rcp_f32 v68, v68
 v_exp_f32 v84, v84
 v_rcp_f32 v69, v69
 v_exp_f32 v85, v85
 v_rcp_f32 v70, v70
 v_exp_f32 v86, v86
 v_rcp_f32 v71, v71
 v_exp_f32 v87, v87
 v_pk_mul_f32 v[56:57], v[8:9], v[56:57]
 v_pk_mul_f32 v[58:59], v[10:11], v[58:59]
 v_pk_mul_f32 v[60:61], v[12:13], v[60:61]
 v_pk_mul_f32 v[62:63], v[14:15], v[62:63]
 v_pk_mul_f32 v[64:65], v[16:17], v[64:65]
 v_pk_mul_f32 v[66:67], v[18:19], v[66:67]
 v_pk_mul_f32 v[68:69], v[20:21], v[68:69]
 v_pk_mul_f32 v[70:71], v[22:23], v[70:71]
 v_pk_add_f32 v[72:73], v[72:73], 1.0
 v_pk_add_f32 v[74:75], v[74:75], 1.0
 v_pk_add_f32 v[76:77], v[76:77], 1.0
 v_pk_add_f32 v[78:79], v[78:79], 1.0
 v_pk_add_f32 v[80:81], v[80:81], 1.0
 v_pk_add_f32 v[82:83], v[82:83], 1.0
 v_pk_add_f32 v[84:85], v[84:85], 1.0
 v_pk_add_f32 v[86:87], v[86:87], 1.0
 v_pk_mul_f32 v[88:89], v[56:57], v[56:57]
 v_pk_mul_f32 v[90:91], v[58:59], v[58:59]
 v_pk_mul_f32 v[92:93], v[60:61], v[60:61]
 v_pk_mul_f32 v[94:95], v[62:63], v[62:63]
 v_pk_mul_f32 v[96:97], v[64:65], v[64:65]
 v_pk_mul_f32 v[98:99], v[66:67], v[66:67]
 v_pk_mul_f32 v[100:101], v[68:69], v[68:69]
 v_pk_mul_f32 v[102:103], v[70:71], v[70:71]
 v_cvt_pk_bf16_f32 v56, v56, v57
 v_cvt_pk_bf16_f32 v58, v58, v59
 v_cvt_pk_bf16_f32 v60, v60, v61
 v_cvt_pk_bf16_f32 v62, v62, v63
 v_cvt_pk_bf16_f32 v64, v64, v65
 v_cvt_pk_bf16_f32 v66, v66, v67
 v_cvt_pk_bf16_f32 v68, v68, v69
 v_cvt_pk_bf16_f32 v70, v70, v71
 v_accvgpr_write_b32 a48, v56
 v_accvgpr_write_b32 a49, v58
 v_accvgpr_write_b32 a50, v60
 v_accvgpr_write_b32 a51, v62
 v_accvgpr_write_b32 a52, v64
 v_accvgpr_write_b32 a53, v66
 v_accvgpr_write_b32 a54, v68
 v_accvgpr_write_b32 a55, v70
 v_pk_fma_f32 v[56:57], v[40:41], v[40:41], s[50:51]
 v_pk_fma_f32 v[58:59], v[42:43], v[42:43], s[50:51]
 v_pk_fma_f32 v[60:61], v[44:45], v[44:45], s[50:51]
 v_pk_fma_f32 v[62:63], v[46:47], v[46:47], s[50:51]
 v_pk_fma_f32 v[64:65], v[48:49], v[48:49], s[50:51]
 v_pk_fma_f32 v[66:67], v[50:51], v[50:51], s[50:51]
 v_pk_fma_f32 v[68:69], v[52:53], v[52:53], s[50:51]
 v_pk_fma_f32 v[70:71], v[54:55], v[54:55], s[50:51]
 v_pk_mul_f32 v[56:57], v[56:57], v[40:41]
 v_pk_mul_f32 v[58:59], v[58:59], v[42:43]
 v_pk_mul_f32 v[60:61], v[60:61], v[44:45]
 v_pk_mul_f32 v[62:63], v[62:63], v[46:47]
 v_pk_mul_f32 v[64:65], v[64:65], v[48:49]
 v_pk_mul_f32 v[66:67], v[66:67], v[50:51]
 v_pk_mul_f32 v[68:69], v[68:69], v[52:53]
 v_pk_mul_f32 v[70:71], v[70:71], v[54:55]
 v_mfma_f32_32x32x16_bf16 v[8:23], a[232:235], v[200:203], 0
 ds_read_b128 a[216:219], v2 offset:49152
 v_rcp_f32 v72, v72
 v_exp_f32 v56, v56
 v_mfma_f32_32x32x16_bf16 v[8:23], a[236:239], v[204:207], v[8:23]
 ds_read_b128 a[220:223], v2 offset:50176
 v_rcp_f32 v73, v73
 v_exp_f32 v57, v57
 v_mfma_f32_32x32x16_bf16 v[8:23], a[240:243], v[208:211], v[8:23]
 ds_read_b128 a[224:227], v2 offset:51200
 v_rcp_f32 v74, v74
 v_exp_f32 v58, v58
 v_mfma_f32_32x32x16_bf16 v[8:23], a[244:247], v[212:215], v[8:23]
 ds_read_b128 a[228:231], v2 offset:52224
 buffer_load_dwordx4 a[160:163], v5, s[24:27], s62 offen offset:2048 sc1
 v_rcp_f32 v75, v75
 v_exp_f32 v59, v59
 v_rcp_f32_e64 v76, v76
 v_mfma_f32_32x32x16_bf16 v[8:23], a[248:251], v[216:219], v[8:23]
 ds_read_b128 a[200:203], v2 offset:53248
 v_exp_f32 v60, v60
 v_rcp_f32 v77, v77
 v_mfma_f32_32x32x16_bf16 v[8:23], a[252:255], v[220:223], v[8:23]
 v_exp_f32 v61, v61
 v_rcp_f32 v78, v78
 v_mfma_f32_32x32x16_bf16 v[8:23], a[176:179], v[224:227], v[8:23]
 v_exp_f32 v62, v62
 v_rcp_f32 v79, v79
 v_mfma_f32_32x32x16_bf16 v[8:23], a[180:183], v[228:231], v[8:23]
 v_exp_f32 v63, v63
 v_rcp_f32 v80, v80
 v_exp_f32_e64 v64, v64
 v_mfma_f32_32x32x16_bf16 v[8:23], a[184:187], v[232:235], v[8:23]
 buffer_load_dwordx4 a[164:167], v5, s[24:27], s62 offen offset:3072 sc1
 v_rcp_f32_e64 v81, v81
 v_exp_f32 v65, v65
 s_waitcnt lgkmcnt(5)
 v_mfma_f32_32x32x16_bf16 v[8:23], a[188:191], v[236:239], v[8:23]
 v_rcp_f32 v82, v82
 v_exp_f32 v66, v66
 v_mfma_f32_32x32x16_bf16 v[8:23], a[192:195], a[208:211], v[8:23]
 ds_read_b128 a[204:207], v2 offset:54272
 v_rcp_f32 v83, v83
 v_exp_f32 v67, v67
 v_mfma_f32_32x32x16_bf16 v[8:23], a[196:199], a[212:215], v[8:23]
 ds_read_b128 a[208:211], v2 offset:55296
 v_rcp_f32 v84, v84
 v_exp_f32 v68, v68
 v_rcp_f32 v85, v85
 v_exp_f32 v69, v69
 v_rcp_f32 v86, v86
 v_exp_f32 v70, v70
 v_rcp_f32 v87, v87
 v_exp_f32 v71, v71
 v_pk_mul_f32 v[72:73], v[24:25], v[72:73]
 v_pk_mul_f32 v[74:75], v[26:27], v[74:75]
 v_pk_mul_f32 v[76:77], v[28:29], v[76:77]
 v_pk_mul_f32 v[78:79], v[30:31], v[78:79]
 v_pk_mul_f32 v[80:81], v[32:33], v[80:81]
 v_pk_mul_f32 v[82:83], v[34:35], v[82:83]
 v_pk_mul_f32 v[84:85], v[36:37], v[84:85]
 v_pk_mul_f32 v[86:87], v[38:39], v[86:87]
 v_pk_add_f32 v[56:57], v[56:57], 1.0
 v_pk_add_f32 v[58:59], v[58:59], 1.0
 v_pk_add_f32 v[60:61], v[60:61], 1.0
 v_pk_add_f32 v[62:63], v[62:63], 1.0
 v_pk_add_f32 v[64:65], v[64:65], 1.0
 v_pk_add_f32 v[66:67], v[66:67], 1.0
 v_pk_add_f32 v[68:69], v[68:69], 1.0
 v_pk_add_f32 v[70:71], v[70:71], 1.0
 v_pk_fma_f32 v[88:89], v[72:73], v[72:73], v[88:89]
 v_pk_fma_f32 v[90:91], v[74:75], v[74:75], v[90:91]
 v_pk_fma_f32 v[92:93], v[76:77], v[76:77], v[92:93]
 v_pk_fma_f32 v[94:95], v[78:79], v[78:79], v[94:95]
 v_pk_fma_f32 v[96:97], v[80:81], v[80:81], v[96:97]
 v_pk_fma_f32 v[98:99], v[82:83], v[82:83], v[98:99]
 v_pk_fma_f32 v[100:101], v[84:85], v[84:85], v[100:101]
 v_pk_fma_f32 v[102:103], v[86:87], v[86:87], v[102:103]
 v_cvt_pk_bf16_f32 v72, v72, v73
 v_cvt_pk_bf16_f32 v74, v74, v75
 v_cvt_pk_bf16_f32 v76, v76, v77
 v_cvt_pk_bf16_f32 v78, v78, v79
 v_cvt_pk_bf16_f32 v80, v80, v81
 v_cvt_pk_bf16_f32 v82, v82, v83
 v_cvt_pk_bf16_f32 v84, v84, v85
 v_cvt_pk_bf16_f32 v86, v86, v87
 v_accvgpr_write_b32 a56, v72
 v_accvgpr_write_b32 a57, v74
 v_accvgpr_write_b32 a58, v76
 v_accvgpr_write_b32 a59, v78
 v_accvgpr_write_b32 a60, v80
 v_accvgpr_write_b32 a61, v82
 v_accvgpr_write_b32 a62, v84
 v_accvgpr_write_b32 a63, v86
 v_pk_fma_f32 v[72:73], v[8:9], v[8:9], s[50:51]
 v_pk_fma_f32 v[74:75], v[10:11], v[10:11], s[50:51]
 v_pk_fma_f32 v[76:77], v[12:13], v[12:13], s[50:51]
 v_pk_fma_f32 v[78:79], v[14:15], v[14:15], s[50:51]
 v_pk_fma_f32 v[80:81], v[16:17], v[16:17], s[50:51]
 v_pk_fma_f32 v[82:83], v[18:19], v[18:19], s[50:51]
 v_pk_fma_f32 v[84:85], v[20:21], v[20:21], s[50:51]
 v_pk_fma_f32 v[86:87], v[22:23], v[22:23], s[50:51]
 v_pk_mul_f32 v[72:73], v[72:73], v[8:9]
 v_pk_mul_f32 v[74:75], v[74:75], v[10:11]
 v_pk_mul_f32 v[76:77], v[76:77], v[12:13]
 v_pk_mul_f32 v[78:79], v[78:79], v[14:15]
 v_pk_mul_f32 v[80:81], v[80:81], v[16:17]
 v_pk_mul_f32 v[82:83], v[82:83], v[18:19]
 v_pk_mul_f32 v[84:85], v[84:85], v[20:21]
 v_pk_mul_f32 v[86:87], v[86:87], v[22:23]
 s_waitcnt lgkmcnt(4)
 v_mfma_f32_32x32x16_bf16 v[24:39], a[232:235], a[216:219], 0
 ds_read_b128 a[212:215], v2 offset:56320
 v_rcp_f32 v56, v56
 v_exp_f32_e64 v72, v72
 v_mfma_f32_32x32x16_bf16 v[24:39], a[236:239], a[220:223], v[24:39]
 ds_read_b128 a[216:219], v2 offset:57344
 v_rcp_f32 v57, v57
 v_exp_f32 v73, v73
 v_mfma_f32_32x32x16_bf16 v[24:39], a[240:243], a[224:227], v[24:39]
 ds_read_b128 a[220:223], v2 offset:58368
 v_rcp_f32_e64 v58, v58
 v_exp_f32 v74, v74
 s_waitcnt lgkmcnt(4)
 v_mfma_f32_32x32x16_bf16 v[24:39], a[244:247], a[228:231], v[24:39]
 ds_read_b128 a[224:227], v2 offset:59392
 buffer_load_dwordx4 a[168:171], v5, s[24:27], s63 offen offset:0 sc1
 v_rcp_f32 v59, v59
 v_exp_f32 v75, v75
 v_rcp_f32_e64 v60, v60
 v_mfma_f32_32x32x16_bf16 v[24:39], a[248:251], a[200:203], v[24:39]
 ds_read_b128 a[228:231], v2 offset:60416
 v_exp_f32 v76, v76
 v_rcp_f32 v61, v61
 v_mfma_f32_32x32x16_bf16 v[24:39], a[252:255], a[204:207], v[24:39]
 ds_read_b128 a[200:203], v3 offset:36864
 v_exp_f32_e64 v77, v77
 v_rcp_f32 v62, v62
 s_waitcnt lgkmcnt(4)
 v_mfma_f32_32x32x16_bf16 v[24:39], a[176:179], a[208:211], v[24:39]
 ds_read_b128 a[204:207], v3 offset:37888
 v_exp_f32 v78, v78
 v_rcp_f32 v63, v63
 v_mfma_f32_32x32x16_bf16 v[24:39], a[180:183], a[212:215], v[24:39]
 ds_read_b128 a[208:211], v3 offset:38912
 v_exp_f32 v79, v79
 v_rcp_f32 v64, v64
 v_exp_f32_e64 v80, v80
 v_mfma_f32_32x32x16_bf16 v[24:39], a[184:187], a[216:219], v[24:39]
 ds_read_b128 a[212:215], v3 offset:39936
 buffer_load_dwordx4 a[172:175], v5, s[24:27], s63 offen offset:1024 sc1
 v_rcp_f32_e64 v65, v65
 v_exp_f32 v81, v81
 s_waitcnt lgkmcnt(4)
 v_mfma_f32_32x32x16_bf16 v[24:39], a[188:191], a[220:223], v[24:39]
 ds_read_b128 a[216:219], v3 offset:40960
 v_rcp_f32 v66, v66
 v_exp_f32 v82, v82
 v_mfma_f32_32x32x16_bf16 v[24:39], a[192:195], a[224:227], v[24:39]
 ds_read_b128 a[220:223], v3 offset:41984
 v_rcp_f32 v67, v67
 v_exp_f32 v83, v83
 v_mfma_f32_32x32x16_bf16 v[24:39], a[196:199], a[228:231], v[24:39]
 ds_read_b128 a[224:227], v3 offset:43008
 v_rcp_f32 v68, v68
 v_exp_f32 v84, v84
 v_rcp_f32 v69, v69
 v_exp_f32 v85, v85
 v_rcp_f32 v70, v70
 v_exp_f32 v86, v86
 v_rcp_f32 v71, v71
 v_exp_f32 v87, v87
 v_pk_mul_f32 v[56:57], v[40:41], v[56:57]
 v_pk_mul_f32 v[58:59], v[42:43], v[58:59]
 v_pk_mul_f32 v[60:61], v[44:45], v[60:61]
 v_pk_mul_f32 v[62:63], v[46:47], v[62:63]
 v_pk_mul_f32 v[64:65], v[48:49], v[64:65]
 v_pk_mul_f32 v[66:67], v[50:51], v[66:67]
 v_pk_mul_f32 v[68:69], v[52:53], v[68:69]
 v_pk_mul_f32 v[70:71], v[54:55], v[70:71]
 v_pk_add_f32 v[72:73], v[72:73], 1.0
 v_pk_add_f32 v[74:75], v[74:75], 1.0
 v_pk_add_f32 v[76:77], v[76:77], 1.0
 v_pk_add_f32 v[78:79], v[78:79], 1.0
 v_pk_add_f32 v[80:81], v[80:81], 1.0
 v_pk_add_f32 v[82:83], v[82:83], 1.0
 v_pk_add_f32 v[84:85], v[84:85], 1.0
 v_pk_add_f32 v[86:87], v[86:87], 1.0
 v_pk_fma_f32 v[88:89], v[56:57], v[56:57], v[88:89]
 v_pk_fma_f32 v[90:91], v[58:59], v[58:59], v[90:91]
 v_pk_fma_f32 v[92:93], v[60:61], v[60:61], v[92:93]
 v_pk_fma_f32 v[94:95], v[62:63], v[62:63], v[94:95]
 v_pk_fma_f32 v[96:97], v[64:65], v[64:65], v[96:97]
 v_pk_fma_f32 v[98:99], v[66:67], v[66:67], v[98:99]
 v_pk_fma_f32 v[100:101], v[68:69], v[68:69], v[100:101]
 v_pk_fma_f32 v[102:103], v[70:71], v[70:71], v[102:103]
 v_cvt_pk_bf16_f32 v56, v56, v57
 v_cvt_pk_bf16_f32 v58, v58, v59
 v_cvt_pk_bf16_f32 v60, v60, v61
 v_cvt_pk_bf16_f32 v62, v62, v63
 v_cvt_pk_bf16_f32 v64, v64, v65
 v_cvt_pk_bf16_f32 v66, v66, v67
 v_cvt_pk_bf16_f32 v68, v68, v69
 v_cvt_pk_bf16_f32 v70, v70, v71
 v_accvgpr_write_b32 a64, v56
 v_accvgpr_write_b32 a65, v58
 v_accvgpr_write_b32 a66, v60
 v_accvgpr_write_b32 a67, v62
 v_accvgpr_write_b32 a68, v64
 v_accvgpr_write_b32 a69, v66
 v_accvgpr_write_b32 a70, v68
 v_accvgpr_write_b32 a71, v70
 v_pk_fma_f32 v[56:57], v[24:25], v[24:25], s[50:51]
 v_pk_fma_f32 v[58:59], v[26:27], v[26:27], s[50:51]
 v_pk_fma_f32 v[60:61], v[28:29], v[28:29], s[50:51]
 v_pk_fma_f32 v[62:63], v[30:31], v[30:31], s[50:51]
 v_pk_fma_f32 v[64:65], v[32:33], v[32:33], s[50:51]
 v_pk_fma_f32 v[66:67], v[34:35], v[34:35], s[50:51]
 v_pk_fma_f32 v[68:69], v[36:37], v[36:37], s[50:51]
 v_pk_fma_f32 v[70:71], v[38:39], v[38:39], s[50:51]
 v_pk_mul_f32 v[56:57], v[56:57], v[24:25]
 v_pk_mul_f32 v[58:59], v[58:59], v[26:27]
 v_pk_mul_f32 v[60:61], v[60:61], v[28:29]
 v_pk_mul_f32 v[62:63], v[62:63], v[30:31]
 v_pk_mul_f32 v[64:65], v[64:65], v[32:33]
 v_pk_mul_f32 v[66:67], v[66:67], v[34:35]
 v_pk_mul_f32 v[68:69], v[68:69], v[36:37]
 v_pk_mul_f32 v[70:71], v[70:71], v[38:39]
 s_waitcnt lgkmcnt(4)
 v_mfma_f32_32x32x16_bf16 v[40:55], a[232:235], a[200:203], 0
 ds_read_b128 a[228:231], v3 offset:44032
 v_rcp_f32 v72, v72
 v_exp_f32_e64 v56, v56
 v_mfma_f32_32x32x16_bf16 v[40:55], a[236:239], a[204:207], v[40:55]
 ds_read_b128 a[200:203], v3 offset:45056
 v_rcp_f32 v73, v73
 v_exp_f32 v57, v57
 v_mfma_f32_32x32x16_bf16 v[40:55], a[240:243], a[208:211], v[40:55]
 ds_read_b128 a[204:207], v3 offset:46080
 v_rcp_f32_e64 v74, v74
 v_exp_f32 v58, v58
 s_waitcnt lgkmcnt(4)
 v_mfma_f32_32x32x16_bf16 v[40:55], a[244:247], a[212:215], v[40:55]
 ds_read_b128 a[208:211], v3 offset:47104
 v_rcp_f32 v75, v75
 v_exp_f32 v59, v59
 v_rcp_f32_e64 v76, v76
 v_mfma_f32_32x32x16_bf16 v[40:55], a[248:251], a[216:219], v[40:55]
 ds_read_b128 a[212:215], v3 offset:48128
 v_exp_f32 v60, v60
 v_rcp_f32 v77, v77
 v_mfma_f32_32x32x16_bf16 v[40:55], a[252:255], a[220:223], v[40:55]
 v_exp_f32_e64 v61, v61
 v_rcp_f32 v78, v78
 s_waitcnt lgkmcnt(3)
 v_mfma_f32_32x32x16_bf16 v[40:55], a[176:179], a[224:227], v[40:55]
 buffer_load_dwordx4 a[176:179], v5, s[24:27], s63 offen offset:2048 sc1
 v_exp_f32 v62, v62
 v_rcp_f32 v79, v79
 v_mfma_f32_32x32x16_bf16 v[40:55], a[180:183], a[228:231], v[40:55]
 buffer_load_dwordx4 a[180:183], v5, s[24:27], s63 offen offset:3072 sc1
 v_exp_f32 v63, v63
 v_rcp_f32 v80, v80
 v_exp_f32_e64 v64, v64
 v_mfma_f32_32x32x16_bf16 v[40:55], a[184:187], a[200:203], v[40:55]
 buffer_load_dwordx4 a[184:187], v5, s[24:27], s55 offen offset:0 sc1
 v_rcp_f32_e64 v81, v81
 v_exp_f32 v65, v65
 s_waitcnt lgkmcnt(0)
 v_mfma_f32_32x32x16_bf16 v[40:55], a[188:191], a[204:207], v[40:55]
 buffer_load_dwordx4 a[188:191], v5, s[24:27], s55 offen offset:1024 sc1
 v_rcp_f32 v82, v82
 v_exp_f32 v66, v66
 v_mfma_f32_32x32x16_bf16 v[40:55], a[192:195], a[208:211], v[40:55]
 buffer_load_dwordx4 a[192:195], v5, s[24:27], s55 offen offset:2048 sc1
 v_rcp_f32 v83, v83
 v_exp_f32 v67, v67
 v_mfma_f32_32x32x16_bf16 v[40:55], a[196:199], a[212:215], v[40:55]
 buffer_load_dwordx4 a[196:199], v5, s[24:27], s55 offen offset:3072 sc1
 v_rcp_f32 v84, v84
 v_exp_f32 v68, v68
 v_rcp_f32 v85, v85
 v_exp_f32 v69, v69
 v_rcp_f32 v86, v86
 v_exp_f32 v70, v70
 v_rcp_f32 v87, v87
 v_exp_f32 v71, v71
 v_pk_mul_f32 v[72:73], v[8:9], v[72:73]
 v_pk_mul_f32 v[74:75], v[10:11], v[74:75]
 v_pk_mul_f32 v[76:77], v[12:13], v[76:77]
 v_pk_mul_f32 v[78:79], v[14:15], v[78:79]
 v_pk_mul_f32 v[80:81], v[16:17], v[80:81]
 v_pk_mul_f32 v[82:83], v[18:19], v[82:83]
 v_pk_mul_f32 v[84:85], v[20:21], v[84:85]
 v_pk_mul_f32 v[86:87], v[22:23], v[86:87]
 v_pk_add_f32 v[56:57], v[56:57], 1.0
 v_pk_add_f32 v[58:59], v[58:59], 1.0
 v_pk_add_f32 v[60:61], v[60:61], 1.0
 v_pk_add_f32 v[62:63], v[62:63], 1.0
 v_pk_add_f32 v[64:65], v[64:65], 1.0
 v_pk_add_f32 v[66:67], v[66:67], 1.0
 v_pk_add_f32 v[68:69], v[68:69], 1.0
 v_pk_add_f32 v[70:71], v[70:71], 1.0
 v_pk_fma_f32 v[88:89], v[72:73], v[72:73], v[88:89]
 v_pk_fma_f32 v[90:91], v[74:75], v[74:75], v[90:91]
 v_pk_fma_f32 v[92:93], v[76:77], v[76:77], v[92:93]
 v_pk_fma_f32 v[94:95], v[78:79], v[78:79], v[94:95]
 v_pk_fma_f32 v[96:97], v[80:81], v[80:81], v[96:97]
 v_pk_fma_f32 v[98:99], v[82:83], v[82:83], v[98:99]
 v_pk_fma_f32 v[100:101], v[84:85], v[84:85], v[100:101]
 v_pk_fma_f32 v[102:103], v[86:87], v[86:87], v[102:103]
 v_cvt_pk_bf16_f32 v72, v72, v73
 v_cvt_pk_bf16_f32 v74, v74, v75
 v_cvt_pk_bf16_f32 v76, v76, v77
 v_cvt_pk_bf16_f32 v78, v78, v79
 v_cvt_pk_bf16_f32 v80, v80, v81
 v_cvt_pk_bf16_f32 v82, v82, v83
 v_cvt_pk_bf16_f32 v84, v84, v85
 v_cvt_pk_bf16_f32 v86, v86, v87
 v_accvgpr_write_b32 a72, v72
 v_accvgpr_write_b32 a73, v74
 v_accvgpr_write_b32 a74, v76
 v_accvgpr_write_b32 a75, v78
 v_accvgpr_write_b32 a76, v80
 v_accvgpr_write_b32 a77, v82
 v_accvgpr_write_b32 a78, v84
 v_accvgpr_write_b32 a79, v86
 v_pk_fma_f32 v[72:73], v[40:41], v[40:41], s[50:51]
 v_pk_fma_f32 v[74:75], v[42:43], v[42:43], s[50:51]
 v_pk_fma_f32 v[76:77], v[44:45], v[44:45], s[50:51]
 v_pk_fma_f32 v[78:79], v[46:47], v[46:47], s[50:51]
 v_pk_fma_f32 v[80:81], v[48:49], v[48:49], s[50:51]
 v_pk_fma_f32 v[82:83], v[50:51], v[50:51], s[50:51]
 v_pk_fma_f32 v[84:85], v[52:53], v[52:53], s[50:51]
 v_pk_fma_f32 v[86:87], v[54:55], v[54:55], s[50:51]
 v_pk_mul_f32 v[72:73], v[72:73], v[40:41]
 v_pk_mul_f32 v[74:75], v[74:75], v[42:43]
 v_pk_mul_f32 v[76:77], v[76:77], v[44:45]
 v_pk_mul_f32 v[78:79], v[78:79], v[46:47]
 v_pk_mul_f32 v[80:81], v[80:81], v[48:49]
 v_pk_mul_f32 v[82:83], v[82:83], v[50:51]
 v_pk_mul_f32 v[84:85], v[84:85], v[52:53]
 v_pk_mul_f32 v[86:87], v[86:87], v[54:55]
 s_waitcnt vmcnt(9)
 v_mfma_f32_32x32x16_bf16 v[8:23], a[152:155], v[104:107], 0
 v_rcp_f32 v56, v56
 v_exp_f32_e64 v72, v72
 v_mfma_f32_32x32x16_bf16 v[8:23], a[156:159], v[108:111], v[8:23]
 v_rcp_f32 v57, v57
 v_exp_f32 v73, v73
 v_mfma_f32_32x32x16_bf16 v[8:23], a[160:163], v[112:115], v[8:23]
 v_rcp_f32_e64 v58, v58
 v_exp_f32 v74, v74
 s_waitcnt vmcnt(6)
 v_mfma_f32_32x32x16_bf16 v[8:23], a[164:167], v[116:119], v[8:23]
 v_rcp_f32 v59, v59
 v_exp_f32 v75, v75
 v_rcp_f32_e64 v60, v60
 v_mfma_f32_32x32x16_bf16 v[8:23], a[168:171], v[120:123], v[8:23]
 v_exp_f32 v76, v76
 v_rcp_f32 v61, v61
 v_mfma_f32_32x32x16_bf16 v[8:23], a[172:175], v[124:127], v[8:23]
 v_exp_f32_e64 v77, v77
 v_rcp_f32 v62, v62
 s_waitcnt vmcnt(3)
 v_mfma_f32_32x32x16_bf16 v[8:23], a[176:179], v[128:131], v[8:23]
 v_exp_f32 v78, v78
 v_rcp_f32 v63, v63
 v_mfma_f32_32x32x16_bf16 v[8:23], a[180:183], v[132:135], v[8:23]
 v_exp_f32 v79, v79
 v_rcp_f32 v64, v64
 v_exp_f32_e64 v80, v80
 v_mfma_f32_32x32x16_bf16 v[8:23], a[184:187], v[136:139], v[8:23]
 v_rcp_f32_e64 v65, v65
 v_exp_f32 v81, v81
 s_waitcnt vmcnt(0)
 v_mfma_f32_32x32x16_bf16 v[8:23], a[188:191], v[140:143], v[8:23]
 v_rcp_f32 v66, v66
 v_exp_f32 v82, v82
 v_mfma_f32_32x32x16_bf16 v[8:23], a[192:195], v[144:147], v[8:23]
 v_rcp_f32 v67, v67
 v_exp_f32 v83, v83
 v_mfma_f32_32x32x16_bf16 v[8:23], a[196:199], v[148:151], v[8:23]
 v_rcp_f32 v68, v68
 v_exp_f32 v84, v84
 v_rcp_f32 v69, v69
 v_exp_f32 v85, v85
 v_rcp_f32 v70, v70
 v_exp_f32 v86, v86
 v_rcp_f32 v71, v71
 v_exp_f32 v87, v87
 v_pk_mul_f32 v[56:57], v[24:25], v[56:57]
 v_pk_mul_f32 v[58:59], v[26:27], v[58:59]
 v_pk_mul_f32 v[60:61], v[28:29], v[60:61]
 v_pk_mul_f32 v[62:63], v[30:31], v[62:63]
 v_pk_mul_f32 v[64:65], v[32:33], v[64:65]
 v_pk_mul_f32 v[66:67], v[34:35], v[66:67]
 v_pk_mul_f32 v[68:69], v[36:37], v[68:69]
 v_pk_mul_f32 v[70:71], v[38:39], v[70:71]
 v_pk_add_f32 v[72:73], v[72:73], 1.0
 v_pk_add_f32 v[74:75], v[74:75], 1.0
 v_pk_add_f32 v[76:77], v[76:77], 1.0
 v_pk_add_f32 v[78:79], v[78:79], 1.0
 v_pk_add_f32 v[80:81], v[80:81], 1.0
 v_pk_add_f32 v[82:83], v[82:83], 1.0
 v_pk_add_f32 v[84:85], v[84:85], 1.0
 v_pk_add_f32 v[86:87], v[86:87], 1.0
 v_pk_fma_f32 v[88:89], v[56:57], v[56:57], v[88:89]
 v_pk_fma_f32 v[90:91], v[58:59], v[58:59], v[90:91]
 v_pk_fma_f32 v[92:93], v[60:61], v[60:61], v[92:93]
 v_pk_fma_f32 v[94:95], v[62:63], v[62:63], v[94:95]
 v_pk_fma_f32 v[96:97], v[64:65], v[64:65], v[96:97]
 v_pk_fma_f32 v[98:99], v[66:67], v[66:67], v[98:99]
 v_pk_fma_f32 v[100:101], v[68:69], v[68:69], v[100:101]
 v_pk_fma_f32 v[102:103], v[70:71], v[70:71], v[102:103]
 v_cvt_pk_bf16_f32 v56, v56, v57
 v_cvt_pk_bf16_f32 v58, v58, v59
 v_cvt_pk_bf16_f32 v60, v60, v61
 v_cvt_pk_bf16_f32 v62, v62, v63
 v_cvt_pk_bf16_f32 v64, v64, v65
 v_cvt_pk_bf16_f32 v66, v66, v67
 v_cvt_pk_bf16_f32 v68, v68, v69
 v_cvt_pk_bf16_f32 v70, v70, v71
 v_accvgpr_write_b32 a80, v56
 v_accvgpr_write_b32 a81, v58
 v_accvgpr_write_b32 a82, v60
 v_accvgpr_write_b32 a83, v62
 v_accvgpr_write_b32 a84, v64
 v_accvgpr_write_b32 a85, v66
 v_accvgpr_write_b32 a86, v68
 v_accvgpr_write_b32 a87, v70
 v_pk_fma_f32 v[56:57], v[8:9], v[8:9], s[50:51]
 v_pk_fma_f32 v[58:59], v[10:11], v[10:11], s[50:51]
 v_pk_fma_f32 v[60:61], v[12:13], v[12:13], s[50:51]
 v_pk_fma_f32 v[62:63], v[14:15], v[14:15], s[50:51]
 v_pk_fma_f32 v[64:65], v[16:17], v[16:17], s[50:51]
 v_pk_fma_f32 v[66:67], v[18:19], v[18:19], s[50:51]
 v_pk_fma_f32 v[68:69], v[20:21], v[20:21], s[50:51]
 v_pk_fma_f32 v[70:71], v[22:23], v[22:23], s[50:51]
 v_pk_mul_f32 v[56:57], v[56:57], v[8:9]
 v_pk_mul_f32 v[58:59], v[58:59], v[10:11]
 v_pk_mul_f32 v[60:61], v[60:61], v[12:13]
 v_pk_mul_f32 v[62:63], v[62:63], v[14:15]
 v_pk_mul_f32 v[64:65], v[64:65], v[16:17]
 v_pk_mul_f32 v[66:67], v[66:67], v[18:19]
 v_pk_mul_f32 v[68:69], v[68:69], v[20:21]
 v_pk_mul_f32 v[70:71], v[70:71], v[22:23]
 v_mfma_f32_32x32x16_bf16 v[24:39], a[152:155], v[152:155], 0
 v_rcp_f32 v72, v72
 v_exp_f32 v56, v56
 v_mfma_f32_32x32x16_bf16 v[24:39], a[156:159], v[156:159], v[24:39]
 v_rcp_f32 v73, v73
 v_exp_f32 v57, v57
 v_mfma_f32_32x32x16_bf16 v[24:39], a[160:163], v[160:163], v[24:39]
 v_rcp_f32 v74, v74
 v_exp_f32 v58, v58
 v_mfma_f32_32x32x16_bf16 v[24:39], a[164:167], v[164:167], v[24:39]
 v_rcp_f32 v75, v75
 v_exp_f32 v59, v59
 v_rcp_f32_e64 v76, v76
 v_mfma_f32_32x32x16_bf16 v[24:39], a[168:171], v[168:171], v[24:39]
 v_exp_f32 v60, v60
 v_rcp_f32 v77, v77
 v_mfma_f32_32x32x16_bf16 v[24:39], a[172:175], v[172:175], v[24:39]
 v_exp_f32 v61, v61
 v_rcp_f32 v78, v78
 v_mfma_f32_32x32x16_bf16 v[24:39], a[176:179], v[176:179], v[24:39]
 v_exp_f32 v62, v62
 v_rcp_f32 v79, v79
 v_mfma_f32_32x32x16_bf16 v[24:39], a[180:183], v[180:183], v[24:39]
 v_exp_f32 v63, v63
 v_rcp_f32 v80, v80
 v_exp_f32_e64 v64, v64
 v_mfma_f32_32x32x16_bf16 v[24:39], a[184:187], v[184:187], v[24:39]
 v_rcp_f32 v81, v81
 v_exp_f32 v65, v65
 v_mfma_f32_32x32x16_bf16 v[24:39], a[188:191], v[188:191], v[24:39]
 v_rcp_f32 v82, v82
 v_exp_f32 v66, v66
 v_mfma_f32_32x32x16_bf16 v[24:39], a[192:195], v[192:195], v[24:39]
 v_rcp_f32 v83, v83
 v_exp_f32 v67, v67
 v_mfma_f32_32x32x16_bf16 v[24:39], a[196:199], v[196:199], v[24:39]
 v_rcp_f32 v84, v84
 v_exp_f32 v68, v68
 v_rcp_f32 v85, v85
 v_exp_f32 v69, v69
 v_rcp_f32 v86, v86
 v_exp_f32 v70, v70
 v_rcp_f32 v87, v87
 v_exp_f32 v71, v71
 v_pk_mul_f32 v[72:73], v[40:41], v[72:73]
 v_pk_mul_f32 v[74:75], v[42:43], v[74:75]
 v_pk_mul_f32 v[76:77], v[44:45], v[76:77]
 v_pk_mul_f32 v[78:79], v[46:47], v[78:79]
 v_pk_mul_f32 v[80:81], v[48:49], v[80:81]
 v_pk_mul_f32 v[82:83], v[50:51], v[82:83]
 v_pk_mul_f32 v[84:85], v[52:53], v[84:85]
 v_pk_mul_f32 v[86:87], v[54:55], v[86:87]
 v_pk_add_f32 v[56:57], v[56:57], 1.0
 v_pk_add_f32 v[58:59], v[58:59], 1.0
 v_pk_add_f32 v[60:61], v[60:61], 1.0
 v_pk_add_f32 v[62:63], v[62:63], 1.0
 v_pk_add_f32 v[64:65], v[64:65], 1.0
 v_pk_add_f32 v[66:67], v[66:67], 1.0
 v_pk_add_f32 v[68:69], v[68:69], 1.0
 v_pk_add_f32 v[70:71], v[70:71], 1.0
 v_pk_fma_f32 v[88:89], v[72:73], v[72:73], v[88:89]
 v_pk_fma_f32 v[90:91], v[74:75], v[74:75], v[90:91]
 v_pk_fma_f32 v[92:93], v[76:77], v[76:77], v[92:93]
 v_pk_fma_f32 v[94:95], v[78:79], v[78:79], v[94:95]
 v_pk_fma_f32 v[96:97], v[80:81], v[80:81], v[96:97]
 v_pk_fma_f32 v[98:99], v[82:83], v[82:83], v[98:99]
 v_pk_fma_f32 v[100:101], v[84:85], v[84:85], v[100:101]
 v_pk_fma_f32 v[102:103], v[86:87], v[86:87], v[102:103]
 v_cvt_pk_bf16_f32 v72, v72, v73
 v_cvt_pk_bf16_f32 v74, v74, v75
 v_cvt_pk_bf16_f32 v76, v76, v77
 v_cvt_pk_bf16_f32 v78, v78, v79
 v_cvt_pk_bf16_f32 v80, v80, v81
 v_cvt_pk_bf16_f32 v82, v82, v83
 v_cvt_pk_bf16_f32 v84, v84, v85
 v_cvt_pk_bf16_f32 v86, v86, v87
 v_accvgpr_write_b32 a88, v72
 v_accvgpr_write_b32 a89, v74
 v_accvgpr_write_b32 a90, v76
 v_accvgpr_write_b32 a91, v78
 v_accvgpr_write_b32 a92, v80
 v_accvgpr_write_b32 a93, v82
 v_accvgpr_write_b32 a94, v84
 v_accvgpr_write_b32 a95, v86
 v_pk_fma_f32 v[72:73], v[24:25], v[24:25], s[50:51]
 v_pk_fma_f32 v[74:75], v[26:27], v[26:27], s[50:51]
 v_pk_fma_f32 v[76:77], v[28:29], v[28:29], s[50:51]
 v_pk_fma_f32 v[78:79], v[30:31], v[30:31], s[50:51]
 v_pk_fma_f32 v[80:81], v[32:33], v[32:33], s[50:51]
 v_pk_fma_f32 v[82:83], v[34:35], v[34:35], s[50:51]
 v_pk_fma_f32 v[84:85], v[36:37], v[36:37], s[50:51]
 v_pk_fma_f32 v[86:87], v[38:39], v[38:39], s[50:51]
 v_pk_mul_f32 v[72:73], v[72:73], v[24:25]
 v_pk_mul_f32 v[74:75], v[74:75], v[26:27]
 v_pk_mul_f32 v[76:77], v[76:77], v[28:29]
 v_pk_mul_f32 v[78:79], v[78:79], v[30:31]
 v_pk_mul_f32 v[80:81], v[80:81], v[32:33]
 v_pk_mul_f32 v[82:83], v[82:83], v[34:35]
 v_pk_mul_f32 v[84:85], v[84:85], v[36:37]
 v_pk_mul_f32 v[86:87], v[86:87], v[38:39]
 v_mfma_f32_32x32x16_bf16 v[40:55], a[152:155], a[96:99], 0
 v_add_f32_dpp v88, v88, v88 row_ror:8 row_mask:0xf bank_mask:0x3
 v_rcp_f32_e64 v56, v56
 v_add_f32_dpp v90, v90, v90 row_ror:8 row_mask:0xf bank_mask:0x3
 v_exp_f32_e64 v72, v72
 v_add_f32_dpp v92, v92, v92 row_ror:8 row_mask:0xf bank_mask:0x3
 v_add_f32_dpp v94, v94, v94 row_ror:8 row_mask:0xf bank_mask:0x3
 v_mfma_f32_32x32x16_bf16 v[40:55], a[156:159], a[100:103], v[40:55]
 s_mul_i32 s62, s59, 24576
 s_add_u32 s62, s62, s54
 s_add_u32 s63, s62, 4096
 s_add_u32 s55, s62, 8192
 v_add_f32_dpp v96, v96, v96 row_ror:8 row_mask:0xf bank_mask:0x3
 v_rcp_f32 v57, v57
 v_add_f32_dpp v98, v98, v98 row_ror:8 row_mask:0xf bank_mask:0x3
 v_exp_f32_e64 v73, v73
 v_add_f32_dpp v100, v100, v100 row_ror:8 row_mask:0xf bank_mask:0x3
 v_add_f32_dpp v102, v102, v102 row_ror:8 row_mask:0xf bank_mask:0x3
 v_mfma_f32_32x32x16_bf16 v[40:55], a[160:163], a[104:107], v[40:55]
 v_add_f32_dpp v88, v89, v89 row_ror:8 row_mask:0xf bank_mask:0xc
 v_rcp_f32_e64 v58, v58
 v_add_f32_dpp v90, v91, v91 row_ror:8 row_mask:0xf bank_mask:0xc
 v_exp_f32_e64 v74, v74
 v_add_f32_dpp v92, v93, v93 row_ror:8 row_mask:0xf bank_mask:0xc
 v_add_f32_dpp v94, v95, v95 row_ror:8 row_mask:0xf bank_mask:0xc
 v_mfma_f32_32x32x16_bf16 v[40:55], a[164:167], a[108:111], v[40:55]
 buffer_load_dwordx4 a[232:235], v5, s[24:27], s62 offen offset:0 sc1
 v_add_f32_dpp v96, v97, v97 row_ror:8 row_mask:0xf bank_mask:0xc
 v_rcp_f32_e64 v59, v59
 v_add_f32_dpp v98, v99, v99 row_ror:8 row_mask:0xf bank_mask:0xc
 v_exp_f32_e64 v75, v75
 v_add_f32_dpp v100, v101, v101 row_ror:8 row_mask:0xf bank_mask:0xc
 v_rcp_f32_e64 v60, v60
 v_add_f32_dpp v102, v103, v103 row_ror:8 row_mask:0xf bank_mask:0xc
 v_mfma_f32_32x32x16_bf16 v[40:55], a[168:171], a[112:115], v[40:55]
 v_add_f32_dpp v88, v88, v88 row_shl:4 row_mask:0xf bank_mask:0x5
 v_exp_f32_e64 v76, v76
 v_add_f32_dpp v92, v92, v92 row_shl:4 row_mask:0xf bank_mask:0x5
 v_rcp_f32_e64 v61, v61
 v_add_f32_dpp v96, v96, v96 row_shl:4 row_mask:0xf bank_mask:0x5
 v_add_f32_dpp v100, v100, v100 row_shl:4 row_mask:0xf bank_mask:0x5
 v_mfma_f32_32x32x16_bf16 v[40:55], a[172:175], a[116:119], v[40:55]
 v_add_f32_dpp v88, v90, v90 row_shr:4 row_mask:0xf bank_mask:0xa
 v_exp_f32_e64 v77, v77
 v_add_f32_dpp v92, v94, v94 row_shr:4 row_mask:0xf bank_mask:0xa
 v_rcp_f32_e64 v62, v62
 v_add_f32_dpp v96, v98, v98 row_shr:4 row_mask:0xf bank_mask:0xa
 v_add_f32_dpp v100, v102, v102 row_shr:4 row_mask:0xf bank_mask:0xa
 v_mfma_f32_32x32x16_bf16 v[40:55], a[176:179], a[120:123], v[40:55]
 s_lshl_b32 s6, s57, 8
 v_exp_f32 v78, v78
 v_add_u32_e64 v7, s6, v6
 v_rcp_f32 v63, v63
 v_permlane16_swap_b32 v88, v92
 v_mfma_f32_32x32x16_bf16 v[40:55], a[180:183], a[124:127], v[40:55]
 v_permlane16_swap_b32 v96, v100
 v_exp_f32 v79, v79
 v_add_f32 v88, v88, v92
 v_rcp_f32 v64, v64
 v_add_f32 v96, v96, v100
 v_exp_f32 v80, v80
 v_mfma_f32_32x32x16_bf16 v[40:55], a[184:187], a[128:131], v[40:55]
 buffer_load_dwordx4 a[236:239], v5, s[24:27], s62 offen offset:1024 sc1
 v_add_f32_dpp v88, v88, v88 quad_perm:[2,3,0,1] row_mask:0xf bank_mask:0xf
 v_rcp_f32_e64 v65, v65
 v_add_f32_dpp v96, v96, v96 quad_perm:[2,3,0,1] row_mask:0xf bank_mask:0xf
 v_exp_f32_e64 v81, v81
 v_mfma_f32_32x32x16_bf16 v[40:55], a[188:191], a[132:135], v[40:55]
 v_cndmask_b32 v88, v88, v96, s[52:53]
 v_rcp_f32 v66, v66
 s_nop 0
 v_add_f32_dpp v89, v88, v88 quad_perm:[1,0,3,2] row_mask:0xf bank_mask:0xf
 v_exp_f32_e64 v82, v82
 v_mfma_f32_32x32x16_bf16 v[40:55], a[192:195], a[136:139], v[40:55]
 ds_read_b128 a[216:219], v2 offset:47104
 ds_write_b32 v7, v89
 v_rcp_f32 v67, v67
 v_exp_f32 v83, v83
 v_mfma_f32_32x32x16_bf16 v[40:55], a[196:199], a[140:143], v[40:55]
 ds_read_b128 a[220:223], v2 offset:48128
 v_rcp_f32 v68, v68
 v_exp_f32 v84, v84
 v_rcp_f32 v69, v69
 v_exp_f32 v85, v85
 v_rcp_f32 v70, v70
 v_exp_f32 v86, v86
 v_rcp_f32 v71, v71
 v_exp_f32 v87, v87
 v_pk_mul_f32 v[56:57], v[8:9], v[56:57]
 v_pk_mul_f32 v[58:59], v[10:11], v[58:59]
 v_pk_mul_f32 v[60:61], v[12:13], v[60:61]
 v_pk_mul_f32 v[62:63], v[14:15], v[62:63]
 v_pk_mul_f32 v[64:65], v[16:17], v[64:65]
 v_pk_mul_f32 v[66:67], v[18:19], v[66:67]
 v_pk_mul_f32 v[68:69], v[20:21], v[68:69]
 v_pk_mul_f32 v[70:71], v[22:23], v[70:71]
 v_pk_add_f32 v[72:73], v[72:73], 1.0
 v_pk_add_f32 v[74:75], v[74:75], 1.0
 v_pk_add_f32 v[76:77], v[76:77], 1.0
 v_pk_add_f32 v[78:79], v[78:79], 1.0
 v_pk_add_f32 v[80:81], v[80:81], 1.0
 v_pk_add_f32 v[82:83], v[82:83], 1.0
 v_pk_add_f32 v[84:85], v[84:85], 1.0
 v_pk_add_f32 v[86:87], v[86:87], 1.0
 v_pk_mul_f32 v[88:89], v[56:57], v[56:57]
 v_pk_mul_f32 v[90:91], v[58:59], v[58:59]
 v_pk_mul_f32 v[92:93], v[60:61], v[60:61]
 v_pk_mul_f32 v[94:95], v[62:63], v[62:63]
 v_pk_mul_f32 v[96:97], v[64:65], v[64:65]
 v_pk_mul_f32 v[98:99], v[66:67], v[66:67]
 v_pk_mul_f32 v[100:101], v[68:69], v[68:69]
 v_pk_mul_f32 v[102:103], v[70:71], v[70:71]
 v_cvt_pk_bf16_f32 v56, v56, v57
 v_cvt_pk_bf16_f32 v58, v58, v59
 v_cvt_pk_bf16_f32 v60, v60, v61
 v_cvt_pk_bf16_f32 v62, v62, v63
 v_cvt_pk_bf16_f32 v64, v64, v65
 v_cvt_pk_bf16_f32 v66, v66, v67
 v_cvt_pk_bf16_f32 v68, v68, v69
 v_cvt_pk_bf16_f32 v70, v70, v71
 v_accvgpr_write_b32 a96, v56
 v_accvgpr_write_b32 a97, v58
 v_accvgpr_write_b32 a98, v60
 v_accvgpr_write_b32 a99, v62
 v_accvgpr_write_b32 a100, v64
 v_accvgpr_write_b32 a101, v66
 v_accvgpr_write_b32 a102, v68
 v_accvgpr_write_b32 a103, v70
 v_pk_fma_f32 v[56:57], v[40:41], v[40:41], s[50:51]
 v_pk_fma_f32 v[58:59], v[42:43], v[42:43], s[50:51]
 v_pk_fma_f32 v[60:61], v[44:45], v[44:45], s[50:51]
 v_pk_fma_f32 v[62:63], v[46:47], v[46:47], s[50:51]
 v_pk_fma_f32 v[64:65], v[48:49], v[48:49], s[50:51]
 v_pk_fma_f32 v[66:67], v[50:51], v[50:51], s[50:51]
 v_pk_fma_f32 v[68:69], v[52:53], v[52:53], s[50:51]
 v_pk_fma_f32 v[70:71], v[54:55], v[54:55], s[50:51]
 v_pk_mul_f32 v[56:57], v[56:57], v[40:41]
 v_pk_mul_f32 v[58:59], v[58:59], v[42:43]
 v_pk_mul_f32 v[60:61], v[60:61], v[44:45]
 v_pk_mul_f32 v[62:63], v[62:63], v[46:47]
 v_pk_mul_f32 v[64:65], v[64:65], v[48:49]
 v_pk_mul_f32 v[66:67], v[66:67], v[50:51]
 v_pk_mul_f32 v[68:69], v[68:69], v[52:53]
 v_pk_mul_f32 v[70:71], v[70:71], v[54:55]
 v_mfma_f32_32x32x16_bf16 v[8:23], a[152:155], v[200:203], 0
 ds_read_b128 a[224:227], v2 offset:49152
 v_rcp_f32 v72, v72
 v_exp_f32 v56, v56
 v_mfma_f32_32x32x16_bf16 v[8:23], a[156:159], v[204:207], v[8:23]
 ds_read_b128 a[228:231], v2 offset:50176
 v_rcp_f32 v73, v73
 v_exp_f32 v57, v57
 v_mfma_f32_32x32x16_bf16 v[8:23], a[160:163], v[208:211], v[8:23]
 ds_read_b128 a[200:203], v2 offset:51200
 v_rcp_f32 v74, v74
 v_exp_f32 v58, v58
 v_mfma_f32_32x32x16_bf16 v[8:23], a[164:167], v[212:215], v[8:23]
 ds_read_b128 a[204:207], v2 offset:52224
 buffer_load_dwordx4 a[240:243], v5, s[24:27], s62 offen offset:2048 sc1
 v_rcp_f32 v75, v75
 v_exp_f32 v59, v59
 v_rcp_f32_e64 v76, v76
 v_mfma_f32_32x32x16_bf16 v[8:23], a[168:171], v[216:219], v[8:23]
 ds_read_b128 a[208:211], v2 offset:53248
 v_exp_f32 v60, v60
 v_rcp_f32 v77, v77
 v_mfma_f32_32x32x16_bf16 v[8:23], a[172:175], v[220:223], v[8:23]
 v_exp_f32 v61, v61
 v_rcp_f32 v78, v78
 v_mfma_f32_32x32x16_bf16 v[8:23], a[176:179], v[224:227], v[8:23]
 v_exp_f32 v62, v62
 v_rcp_f32 v79, v79
 v_mfma_f32_32x32x16_bf16 v[8:23], a[180:183], v[228:231], v[8:23]
 v_exp_f32 v63, v63
 v_rcp_f32 v80, v80
 v_exp_f32_e64 v64, v64
 v_mfma_f32_32x32x16_bf16 v[8:23], a[184:187], v[232:235], v[8:23]
 buffer_load_dwordx4 a[244:247], v5, s[24:27], s62 offen offset:3072 sc1
 v_rcp_f32_e64 v81, v81
 v_exp_f32 v65, v65
 s_waitcnt lgkmcnt(5)
 v_mfma_f32_32x32x16_bf16 v[8:23], a[188:191], v[236:239], v[8:23]
 v_rcp_f32 v82, v82
 v_exp_f32 v66, v66
 v_mfma_f32_32x32x16_bf16 v[8:23], a[192:195], a[216:219], v[8:23]
 ds_read_b128 a[212:215], v2 offset:54272
 v_rcp_f32 v83, v83
 v_exp_f32 v67, v67
 v_mfma_f32_32x32x16_bf16 v[8:23], a[196:199], a[220:223], v[8:23]
 ds_read_b128 a[216:219], v2 offset:55296
 v_rcp_f32 v84, v84
 v_exp_f32 v68, v68
 v_rcp_f32 v85, v85
 v_exp_f32 v69, v69
 v_rcp_f32 v86, v86
 v_exp_f32 v70, v70
 v_rcp_f32 v87, v87
 v_exp_f32 v71, v71
 v_pk_mul_f32 v[72:73], v[24:25], v[72:73]
 v_pk_mul_f32 v[74:75], v[26:27], v[74:75]
 v_pk_mul_f32 v[76:77], v[28:29], v[76:77]
 v_pk_mul_f32 v[78:79], v[30:31], v[78:79]
 v_pk_mul_f32 v[80:81], v[32:33], v[80:81]
 v_pk_mul_f32 v[82:83], v[34:35], v[82:83]
 v_pk_mul_f32 v[84:85], v[36:37], v[84:85]
 v_pk_mul_f32 v[86:87], v[38:39], v[86:87]
 v_pk_add_f32 v[56:57], v[56:57], 1.0
 v_pk_add_f32 v[58:59], v[58:59], 1.0
 v_pk_add_f32 v[60:61], v[60:61], 1.0
 v_pk_add_f32 v[62:63], v[62:63], 1.0
 v_pk_add_f32 v[64:65], v[64:65], 1.0
 v_pk_add_f32 v[66:67], v[66:67], 1.0
 v_pk_add_f32 v[68:69], v[68:69], 1.0
 v_pk_add_f32 v[70:71], v[70:71], 1.0
 v_pk_fma_f32 v[88:89], v[72:73], v[72:73], v[88:89]
 v_pk_fma_f32 v[90:91], v[74:75], v[74:75], v[90:91]
 v_pk_fma_f32 v[92:93], v[76:77], v[76:77], v[92:93]
 v_pk_fma_f32 v[94:95], v[78:79], v[78:79], v[94:95]
 v_pk_fma_f32 v[96:97], v[80:81], v[80:81], v[96:97]
 v_pk_fma_f32 v[98:99], v[82:83], v[82:83], v[98:99]
 v_pk_fma_f32 v[100:101], v[84:85], v[84:85], v[100:101]
 v_pk_fma_f32 v[102:103], v[86:87], v[86:87], v[102:103]
 v_cvt_pk_bf16_f32 v72, v72, v73
 v_cvt_pk_bf16_f32 v74, v74, v75
 v_cvt_pk_bf16_f32 v76, v76, v77
 v_cvt_pk_bf16_f32 v78, v78, v79
 v_cvt_pk_bf16_f32 v80, v80, v81
 v_cvt_pk_bf16_f32 v82, v82, v83
 v_cvt_pk_bf16_f32 v84, v84, v85
 v_cvt_pk_bf16_f32 v86, v86, v87
 v_accvgpr_write_b32 a104, v72
 v_accvgpr_write_b32 a105, v74
 v_accvgpr_write_b32 a106, v76
 v_accvgpr_write_b32 a107, v78
 v_accvgpr_write_b32 a108, v80
 v_accvgpr_write_b32 a109, v82
 v_accvgpr_write_b32 a110, v84
 v_accvgpr_write_b32 a111, v86
 v_pk_fma_f32 v[72:73], v[8:9], v[8:9], s[50:51]
 v_pk_fma_f32 v[74:75], v[10:11], v[10:11], s[50:51]
 v_pk_fma_f32 v[76:77], v[12:13], v[12:13], s[50:51]
 v_pk_fma_f32 v[78:79], v[14:15], v[14:15], s[50:51]
 v_pk_fma_f32 v[80:81], v[16:17], v[16:17], s[50:51]
 v_pk_fma_f32 v[82:83], v[18:19], v[18:19], s[50:51]
 v_pk_fma_f32 v[84:85], v[20:21], v[20:21], s[50:51]
 v_pk_fma_f32 v[86:87], v[22:23], v[22:23], s[50:51]
 v_pk_mul_f32 v[72:73], v[72:73], v[8:9]
 v_pk_mul_f32 v[74:75], v[74:75], v[10:11]
 v_pk_mul_f32 v[76:77], v[76:77], v[12:13]
 v_pk_mul_f32 v[78:79], v[78:79], v[14:15]
 v_pk_mul_f32 v[80:81], v[80:81], v[16:17]
 v_pk_mul_f32 v[82:83], v[82:83], v[18:19]
 v_pk_mul_f32 v[84:85], v[84:85], v[20:21]
 v_pk_mul_f32 v[86:87], v[86:87], v[22:23]
 s_waitcnt lgkmcnt(4)
 v_mfma_f32_32x32x16_bf16 v[24:39], a[152:155], a[224:227], 0
 ds_read_b128 a[220:223], v2 offset:56320
 v_rcp_f32 v56, v56
 v_exp_f32_e64 v72, v72
 v_mfma_f32_32x32x16_bf16 v[24:39], a[156:159], a[228:231], v[24:39]
 ds_read_b128 a[224:227], v2 offset:57344
 v_rcp_f32 v57, v57
 v_exp_f32 v73, v73
 v_mfma_f32_32x32x16_bf16 v[24:39], a[160:163], a[200:203], v[24:39]
 ds_read_b128 a[228:231], v2 offset:58368
 v_rcp_f32_e64 v58, v58
 v_exp_f32 v74, v74
 s_waitcnt lgkmcnt(4)
 v_mfma_f32_32x32x16_bf16 v[24:39], a[164:167], a[204:207], v[24:39]
 ds_read_b128 a[200:203], v2 offset:59392
 buffer_load_dwordx4 a[248:251], v5, s[24:27], s63 offen offset:0 sc1
 v_rcp_f32 v59, v59
 v_exp_f32 v75, v75
 v_rcp_f32_e64 v60, v60
 v_mfma_f32_32x32x16_bf16 v[24:39], a[168:171], a[208:211], v[24:39]
 ds_read_b128 a[204:207], v2 offset:60416
 v_exp_f32 v76, v76
 v_rcp_f32 v61, v61
 v_mfma_f32_32x32x16_bf16 v[24:39], a[172:175], a[212:215], v[24:39]
 ds_read_b128 a[208:211], v3 offset:36864
 v_exp_f32_e64 v77, v77
 v_rcp_f32 v62, v62
 s_waitcnt lgkmcnt(4)
 v_mfma_f32_32x32x16_bf16 v[24:39], a[176:179], a[216:219], v[24:39]
 ds_read_b128 a[212:215], v3 offset:37888
 v_exp_f32 v78, v78
 v_rcp_f32 v63, v63
 v_mfma_f32_32x32x16_bf16 v[24:39], a[180:183], a[220:223], v[24:39]
 ds_read_b128 a[216:219], v3 offset:38912
 v_exp_f32 v79, v79
 v_rcp_f32 v64, v64
 v_exp_f32_e64 v80, v80
 v_mfma_f32_32x32x16_bf16 v[24:39], a[184:187], a[224:227], v[24:39]
 ds_read_b128 a[220:223], v3 offset:39936
 buffer_load_dwordx4 a[252:255], v5, s[24:27], s63 offen offset:1024 sc1
 v_rcp_f32_e64 v65, v65
 v_exp_f32 v81, v81
 s_waitcnt lgkmcnt(4)
 v_mfma_f32_32x32x16_bf16 v[24:39], a[188:191], a[228:231], v[24:39]
 ds_read_b128 a[224:227], v3 offset:40960
 v_rcp_f32 v66, v66
 v_exp_f32 v82, v82
 v_mfma_f32_32x32x16_bf16 v[24:39], a[192:195], a[200:203], v[24:39]
 ds_read_b128 a[228:231], v3 offset:41984
 v_rcp_f32 v67, v67
 v_exp_f32 v83, v83
 v_mfma_f32_32x32x16_bf16 v[24:39], a[196:199], a[204:207], v[24:39]
 ds_read_b128 a[200:203], v3 offset:43008
 v_rcp_f32 v68, v68
 v_exp_f32 v84, v84
 v_rcp_f32 v69, v69
 v_exp_f32 v85, v85
 v_rcp_f32 v70, v70
 v_exp_f32 v86, v86
 v_rcp_f32 v71, v71
 v_exp_f32 v87, v87
 v_pk_mul_f32 v[56:57], v[40:41], v[56:57]
 v_pk_mul_f32 v[58:59], v[42:43], v[58:59]
 v_pk_mul_f32 v[60:61], v[44:45], v[60:61]
 v_pk_mul_f32 v[62:63], v[46:47], v[62:63]
 v_pk_mul_f32 v[64:65], v[48:49], v[64:65]
 v_pk_mul_f32 v[66:67], v[50:51], v[66:67]
 v_pk_mul_f32 v[68:69], v[52:53], v[68:69]
 v_pk_mul_f32 v[70:71], v[54:55], v[70:71]
 v_pk_add_f32 v[72:73], v[72:73], 1.0
 v_pk_add_f32 v[74:75], v[74:75], 1.0
 v_pk_add_f32 v[76:77], v[76:77], 1.0
 v_pk_add_f32 v[78:79], v[78:79], 1.0
 v_pk_add_f32 v[80:81], v[80:81], 1.0
 v_pk_add_f32 v[82:83], v[82:83], 1.0
 v_pk_add_f32 v[84:85], v[84:85], 1.0
 v_pk_add_f32 v[86:87], v[86:87], 1.0
 v_pk_fma_f32 v[88:89], v[56:57], v[56:57], v[88:89]
 v_pk_fma_f32 v[90:91], v[58:59], v[58:59], v[90:91]
 v_pk_fma_f32 v[92:93], v[60:61], v[60:61], v[92:93]
 v_pk_fma_f32 v[94:95], v[62:63], v[62:63], v[94:95]
 v_pk_fma_f32 v[96:97], v[64:65], v[64:65], v[96:97]
 v_pk_fma_f32 v[98:99], v[66:67], v[66:67], v[98:99]
 v_pk_fma_f32 v[100:101], v[68:69], v[68:69], v[100:101]
 v_pk_fma_f32 v[102:103], v[70:71], v[70:71], v[102:103]
 v_cvt_pk_bf16_f32 v56, v56, v57
 v_cvt_pk_bf16_f32 v58, v58, v59
 v_cvt_pk_bf16_f32 v60, v60, v61
 v_cvt_pk_bf16_f32 v62, v62, v63
 v_cvt_pk_bf16_f32 v64, v64, v65
 v_cvt_pk_bf16_f32 v66, v66, v67
 v_cvt_pk_bf16_f32 v68, v68, v69
 v_cvt_pk_bf16_f32 v70, v70, v71
 v_accvgpr_write_b32 a112, v56
 v_accvgpr_write_b32 a113, v58
 v_accvgpr_write_b32 a114, v60
 v_accvgpr_write_b32 a115, v62
 v_accvgpr_write_b32 a116, v64
 v_accvgpr_write_b32 a117, v66
 v_accvgpr_write_b32 a118, v68
 v_accvgpr_write_b32 a119, v70
 v_pk_fma_f32 v[56:57], v[24:25], v[24:25], s[50:51]
 v_pk_fma_f32 v[58:59], v[26:27], v[26:27], s[50:51]
 v_pk_fma_f32 v[60:61], v[28:29], v[28:29], s[50:51]
 v_pk_fma_f32 v[62:63], v[30:31], v[30:31], s[50:51]
 v_pk_fma_f32 v[64:65], v[32:33], v[32:33], s[50:51]
 v_pk_fma_f32 v[66:67], v[34:35], v[34:35], s[50:51]
 v_pk_fma_f32 v[68:69], v[36:37], v[36:37], s[50:51]
 v_pk_fma_f32 v[70:71], v[38:39], v[38:39], s[50:51]
 v_pk_mul_f32 v[56:57], v[56:57], v[24:25]
 v_pk_mul_f32 v[58:59], v[58:59], v[26:27]
 v_pk_mul_f32 v[60:61], v[60:61], v[28:29]
 v_pk_mul_f32 v[62:63], v[62:63], v[30:31]
 v_pk_mul_f32 v[64:65], v[64:65], v[32:33]
 v_pk_mul_f32 v[66:67], v[66:67], v[34:35]
 v_pk_mul_f32 v[68:69], v[68:69], v[36:37]
 v_pk_mul_f32 v[70:71], v[70:71], v[38:39]
 s_waitcnt lgkmcnt(4)
 v_mfma_f32_32x32x16_bf16 v[40:55], a[152:155], a[208:211], 0
 ds_read_b128 a[204:207], v3 offset:44032
 v_rcp_f32 v72, v72
 v_exp_f32_e64 v56, v56
 v_mfma_f32_32x32x16_bf16 v[40:55], a[156:159], a[212:215], v[40:55]
 ds_read_b128 a[208:211], v3 offset:45056
 v_rcp_f32 v73, v73
 v_exp_f32 v57, v57
 v_mfma_f32_32x32x16_bf16 v[40:55], a[160:163], a[216:219], v[40:55]
 ds_read_b128 a[212:215], v3 offset:46080
 v_rcp_f32_e64 v74, v74
 v_exp_f32 v58, v58
 s_waitcnt lgkmcnt(4)
 v_mfma_f32_32x32x16_bf16 v[40:55], a[164:167], a[220:223], v[40:55]
 ds_read_b128 a[216:219], v3 offset:47104
 v_rcp_f32 v75, v75
 v_exp_f32 v59, v59
 v_rcp_f32_e64 v76, v76
 v_mfma_f32_32x32x16_bf16 v[40:55], a[168:171], a[224:227], v[40:55]
 ds_read_b128 a[220:223], v3 offset:48128
 v_exp_f32 v60, v60
 v_rcp_f32 v77, v77
 v_mfma_f32_32x32x16_bf16 v[40:55], a[172:175], a[228:231], v[40:55]
 v_exp_f32_e64 v61, v61
 v_rcp_f32 v78, v78
 s_waitcnt lgkmcnt(3)
 v_mfma_f32_32x32x16_bf16 v[40:55], a[176:179], a[200:203], v[40:55]
 buffer_load_dwordx4 a[176:179], v5, s[24:27], s63 offen offset:2048 sc1
 v_exp_f32 v62, v62
 v_rcp_f32 v79, v79
 v_mfma_f32_32x32x16_bf16 v[40:55], a[180:183], a[204:207], v[40:55]
 buffer_load_dwordx4 a[180:183], v5, s[24:27], s63 offen offset:3072 sc1
 v_exp_f32 v63, v63
 v_rcp_f32 v80, v80
 v_exp_f32_e64 v64, v64
 v_mfma_f32_32x32x16_bf16 v[40:55], a[184:187], a[208:211], v[40:55]
 buffer_load_dwordx4 a[184:187], v5, s[24:27], s55 offen offset:0 sc1
 v_rcp_f32_e64 v81, v81
 v_exp_f32 v65, v65
 s_waitcnt lgkmcnt(0)
 v_mfma_f32_32x32x16_bf16 v[40:55], a[188:191], a[212:215], v[40:55]
 buffer_load_dwordx4 a[188:191], v5, s[24:27], s55 offen offset:1024 sc1
 v_rcp_f32 v82, v82
 v_exp_f32 v66, v66
 v_mfma_f32_32x32x16_bf16 v[40:55], a[192:195], a[216:219], v[40:55]
 buffer_load_dwordx4 a[192:195], v5, s[24:27], s55 offen offset:2048 sc1
 v_rcp_f32 v83, v83
 v_exp_f32 v67, v67
 v_mfma_f32_32x32x16_bf16 v[40:55], a[196:199], a[220:223], v[40:55]
 buffer_load_dwordx4 a[196:199], v5, s[24:27], s55 offen offset:3072 sc1
 v_rcp_f32 v84, v84
 v_exp_f32 v68, v68
 v_rcp_f32 v85, v85
 v_exp_f32 v69, v69
 v_rcp_f32 v86, v86
 v_exp_f32 v70, v70
 v_rcp_f32 v87, v87
 v_exp_f32 v71, v71
 v_pk_mul_f32 v[72:73], v[8:9], v[72:73]
 v_pk_mul_f32 v[74:75], v[10:11], v[74:75]
 v_pk_mul_f32 v[76:77], v[12:13], v[76:77]
 v_pk_mul_f32 v[78:79], v[14:15], v[78:79]
 v_pk_mul_f32 v[80:81], v[16:17], v[80:81]
 v_pk_mul_f32 v[82:83], v[18:19], v[82:83]
 v_pk_mul_f32 v[84:85], v[20:21], v[84:85]
 v_pk_mul_f32 v[86:87], v[22:23], v[86:87]
 v_pk_add_f32 v[56:57], v[56:57], 1.0
 v_pk_add_f32 v[58:59], v[58:59], 1.0
 v_pk_add_f32 v[60:61], v[60:61], 1.0
 v_pk_add_f32 v[62:63], v[62:63], 1.0
 v_pk_add_f32 v[64:65], v[64:65], 1.0
 v_pk_add_f32 v[66:67], v[66:67], 1.0
 v_pk_add_f32 v[68:69], v[68:69], 1.0
 v_pk_add_f32 v[70:71], v[70:71], 1.0
 v_pk_fma_f32 v[88:89], v[72:73], v[72:73], v[88:89]
 v_pk_fma_f32 v[90:91], v[74:75], v[74:75], v[90:91]
 v_pk_fma_f32 v[92:93], v[76:77], v[76:77], v[92:93]
 v_pk_fma_f32 v[94:95], v[78:79], v[78:79], v[94:95]
 v_pk_fma_f32 v[96:97], v[80:81], v[80:81], v[96:97]
 v_pk_fma_f32 v[98:99], v[82:83], v[82:83], v[98:99]
 v_pk_fma_f32 v[100:101], v[84:85], v[84:85], v[100:101]
 v_pk_fma_f32 v[102:103], v[86:87], v[86:87], v[102:103]
 v_cvt_pk_bf16_f32 v72, v72, v73
 v_cvt_pk_bf16_f32 v74, v74, v75
 v_cvt_pk_bf16_f32 v76, v76, v77
 v_cvt_pk_bf16_f32 v78, v78, v79
 v_cvt_pk_bf16_f32 v80, v80, v81
 v_cvt_pk_bf16_f32 v82, v82, v83
 v_cvt_pk_bf16_f32 v84, v84, v85
 v_cvt_pk_bf16_f32 v86, v86, v87
 v_accvgpr_write_b32 a120, v72
 v_accvgpr_write_b32 a121, v74
 v_accvgpr_write_b32 a122, v76
 v_accvgpr_write_b32 a123, v78
 v_accvgpr_write_b32 a124, v80
 v_accvgpr_write_b32 a125, v82
 v_accvgpr_write_b32 a126, v84
 v_accvgpr_write_b32 a127, v86
 v_pk_fma_f32 v[72:73], v[40:41], v[40:41], s[50:51]
 v_pk_fma_f32 v[74:75], v[42:43], v[42:43], s[50:51]
 v_pk_fma_f32 v[76:77], v[44:45], v[44:45], s[50:51]
 v_pk_fma_f32 v[78:79], v[46:47], v[46:47], s[50:51]
 v_pk_fma_f32 v[80:81], v[48:49], v[48:49], s[50:51]
 v_pk_fma_f32 v[82:83], v[50:51], v[50:51], s[50:51]
 v_pk_fma_f32 v[84:85], v[52:53], v[52:53], s[50:51]
 v_pk_fma_f32 v[86:87], v[54:55], v[54:55], s[50:51]
 v_pk_mul_f32 v[72:73], v[72:73], v[40:41]
 v_pk_mul_f32 v[74:75], v[74:75], v[42:43]
 v_pk_mul_f32 v[76:77], v[76:77], v[44:45]
 v_pk_mul_f32 v[78:79], v[78:79], v[46:47]
 v_pk_mul_f32 v[80:81], v[80:81], v[48:49]
 v_pk_mul_f32 v[82:83], v[82:83], v[50:51]
 v_pk_mul_f32 v[84:85], v[84:85], v[52:53]
 v_pk_mul_f32 v[86:87], v[86:87], v[54:55]
 s_waitcnt vmcnt(9)
 v_mfma_f32_32x32x16_bf16 v[8:23], a[232:235], v[104:107], 0
 v_rcp_f32 v56, v56
 v_exp_f32_e64 v72, v72
 v_mfma_f32_32x32x16_bf16 v[8:23], a[236:239], v[108:111], v[8:23]
 v_rcp_f32 v57, v57
 v_exp_f32 v73, v73
 v_mfma_f32_32x32x16_bf16 v[8:23], a[240:243], v[112:115], v[8:23]
 v_rcp_f32_e64 v58, v58
 v_exp_f32 v74, v74
 s_waitcnt vmcnt(6)
 v_mfma_f32_32x32x16_bf16 v[8:23], a[244:247], v[116:119], v[8:23]
 v_rcp_f32 v59, v59
 v_exp_f32 v75, v75
 v_rcp_f32_e64 v60, v60
 v_mfma_f32_32x32x16_bf16 v[8:23], a[248:251], v[120:123], v[8:23]
 v_exp_f32 v76, v76
 v_rcp_f32 v61, v61
 v_mfma_f32_32x32x16_bf16 v[8:23], a[252:255], v[124:127], v[8:23]
 v_exp_f32_e64 v77, v77
 v_rcp_f32 v62, v62
 s_waitcnt vmcnt(3)
 v_mfma_f32_32x32x16_bf16 v[8:23], a[176:179], v[128:131], v[8:23]
 v_exp_f32 v78, v78
 v_rcp_f32 v63, v63
 v_mfma_f32_32x32x16_bf16 v[8:23], a[180:183], v[132:135], v[8:23]
 v_exp_f32 v79, v79
 v_rcp_f32 v64, v64
 v_exp_f32_e64 v80, v80
 v_mfma_f32_32x32x16_bf16 v[8:23], a[184:187], v[136:139], v[8:23]
 v_rcp_f32_e64 v65, v65
 v_exp_f32 v81, v81
 s_waitcnt vmcnt(0)
 v_mfma_f32_32x32x16_bf16 v[8:23], a[188:191], v[140:143], v[8:23]
 v_rcp_f32 v66, v66
 v_exp_f32 v82, v82
 v_mfma_f32_32x32x16_bf16 v[8:23], a[192:195], v[144:147], v[8:23]
 v_rcp_f32 v67, v67
 v_exp_f32 v83, v83
 v_mfma_f32_32x32x16_bf16 v[8:23], a[196:199], v[148:151], v[8:23]
 v_rcp_f32 v68, v68
 v_exp_f32 v84, v84
 v_rcp_f32 v69, v69
 v_exp_f32 v85, v85
 v_rcp_f32 v70, v70
 v_exp_f32 v86, v86
 v_rcp_f32 v71, v71
 v_exp_f32 v87, v87
 v_pk_mul_f32 v[56:57], v[24:25], v[56:57]
 v_pk_mul_f32 v[58:59], v[26:27], v[58:59]
 v_pk_mul_f32 v[60:61], v[28:29], v[60:61]
 v_pk_mul_f32 v[62:63], v[30:31], v[62:63]
 v_pk_mul_f32 v[64:65], v[32:33], v[64:65]
 v_pk_mul_f32 v[66:67], v[34:35], v[66:67]
 v_pk_mul_f32 v[68:69], v[36:37], v[68:69]
 v_pk_mul_f32 v[70:71], v[38:39], v[70:71]
 v_pk_add_f32 v[72:73], v[72:73], 1.0
 v_pk_add_f32 v[74:75], v[74:75], 1.0
 v_pk_add_f32 v[76:77], v[76:77], 1.0
 v_pk_add_f32 v[78:79], v[78:79], 1.0
 v_pk_add_f32 v[80:81], v[80:81], 1.0
 v_pk_add_f32 v[82:83], v[82:83], 1.0
 v_pk_add_f32 v[84:85], v[84:85], 1.0
 v_pk_add_f32 v[86:87], v[86:87], 1.0
 v_pk_fma_f32 v[88:89], v[56:57], v[56:57], v[88:89]
 v_pk_fma_f32 v[90:91], v[58:59], v[58:59], v[90:91]
 v_pk_fma_f32 v[92:93], v[60:61], v[60:61], v[92:93]
 v_pk_fma_f32 v[94:95], v[62:63], v[62:63], v[94:95]
 v_pk_fma_f32 v[96:97], v[64:65], v[64:65], v[96:97]
 v_pk_fma_f32 v[98:99], v[66:67], v[66:67], v[98:99]
 v_pk_fma_f32 v[100:101], v[68:69], v[68:69], v[100:101]
 v_pk_fma_f32 v[102:103], v[70:71], v[70:71], v[102:103]
 v_cvt_pk_bf16_f32 v56, v56, v57
 v_cvt_pk_bf16_f32 v58, v58, v59
 v_cvt_pk_bf16_f32 v60, v60, v61
 v_cvt_pk_bf16_f32 v62, v62, v63
 v_cvt_pk_bf16_f32 v64, v64, v65
 v_cvt_pk_bf16_f32 v66, v66, v67
 v_cvt_pk_bf16_f32 v68, v68, v69
 v_cvt_pk_bf16_f32 v70, v70, v71
 v_accvgpr_write_b32 a128, v56
 v_accvgpr_write_b32 a129, v58
 v_accvgpr_write_b32 a130, v60
 v_accvgpr_write_b32 a131, v62
 v_accvgpr_write_b32 a132, v64
 v_accvgpr_write_b32 a133, v66
 v_accvgpr_write_b32 a134, v68
 v_accvgpr_write_b32 a135, v70
 v_pk_fma_f32 v[56:57], v[8:9], v[8:9], s[50:51]
 v_pk_fma_f32 v[58:59], v[10:11], v[10:11], s[50:51]
 v_pk_fma_f32 v[60:61], v[12:13], v[12:13], s[50:51]
 v_pk_fma_f32 v[62:63], v[14:15], v[14:15], s[50:51]
 v_pk_fma_f32 v[64:65], v[16:17], v[16:17], s[50:51]
 v_pk_fma_f32 v[66:67], v[18:19], v[18:19], s[50:51]
 v_pk_fma_f32 v[68:69], v[20:21], v[20:21], s[50:51]
 v_pk_fma_f32 v[70:71], v[22:23], v[22:23], s[50:51]
 v_pk_mul_f32 v[56:57], v[56:57], v[8:9]
 v_pk_mul_f32 v[58:59], v[58:59], v[10:11]
 v_pk_mul_f32 v[60:61], v[60:61], v[12:13]
 v_pk_mul_f32 v[62:63], v[62:63], v[14:15]
 v_pk_mul_f32 v[64:65], v[64:65], v[16:17]
 v_pk_mul_f32 v[66:67], v[66:67], v[18:19]
 v_pk_mul_f32 v[68:69], v[68:69], v[20:21]
 v_pk_mul_f32 v[70:71], v[70:71], v[22:23]
 v_mfma_f32_32x32x16_bf16 v[24:39], a[232:235], v[152:155], 0
 ds_read_b128 a[224:227], v2 offset:24576
 v_rcp_f32 v72, v72
 v_exp_f32 v56, v56
 v_mfma_f32_32x32x16_bf16 v[24:39], a[236:239], v[156:159], v[24:39]
 ds_read_b128 a[228:231], v2 offset:25600
 v_rcp_f32 v73, v73
 v_exp_f32 v57, v57
 v_mfma_f32_32x32x16_bf16 v[24:39], a[240:243], v[160:163], v[24:39]
 ds_read_b128 a[200:203], v2 offset:26624
 v_rcp_f32 v74, v74
 v_exp_f32 v58, v58
 v_mfma_f32_32x32x16_bf16 v[24:39], a[244:247], v[164:167], v[24:39]
 ds_read_b128 a[204:207], v2 offset:27648
 v_rcp_f32 v75, v75
 v_exp_f32 v59, v59
 v_rcp_f32_e64 v76, v76
 v_mfma_f32_32x32x16_bf16 v[24:39], a[248:251], v[168:171], v[24:39]
 ds_read_b128 a[208:211], v2 offset:28672
 v_exp_f32 v60, v60
 v_rcp_f32 v77, v77
 v_mfma_f32_32x32x16_bf16 v[24:39], a[252:255], v[172:175], v[24:39]
 ds_read_b128 a[212:215], v2 offset:29696
 v_exp_f32 v61, v61
 v_rcp_f32 v78, v78
 v_mfma_f32_32x32x16_bf16 v[24:39], a[176:179], v[176:179], v[24:39]
 ds_read_b128 a[216:219], v2 offset:30720
 v_exp_f32 v62, v62
 v_rcp_f32 v79, v79
 v_mfma_f32_32x32x16_bf16 v[24:39], a[180:183], v[180:183], v[24:39]
 v_exp_f32 v63, v63
 v_rcp_f32 v80, v80
 v_exp_f32_e64 v64, v64
 v_mfma_f32_32x32x16_bf16 v[24:39], a[184:187], v[184:187], v[24:39]
 v_rcp_f32 v81, v81
 v_exp_f32 v65, v65
 v_mfma_f32_32x32x16_bf16 v[24:39], a[188:191], v[188:191], v[24:39]
 v_rcp_f32 v82, v82
 v_exp_f32 v66, v66
 v_mfma_f32_32x32x16_bf16 v[24:39], a[192:195], v[192:195], v[24:39]
 v_rcp_f32 v83, v83
 v_exp_f32 v67, v67
 v_mfma_f32_32x32x16_bf16 v[24:39], a[196:199], v[196:199], v[24:39]
 v_rcp_f32 v84, v84
 v_exp_f32 v68, v68
 v_rcp_f32 v85, v85
 v_exp_f32 v69, v69
 v_rcp_f32 v86, v86
 v_exp_f32 v70, v70
 v_rcp_f32 v87, v87
 v_exp_f32 v71, v71
 v_pk_mul_f32 v[72:73], v[40:41], v[72:73]
 v_pk_mul_f32 v[74:75], v[42:43], v[74:75]
 v_pk_mul_f32 v[76:77], v[44:45], v[76:77]
 v_pk_mul_f32 v[78:79], v[46:47], v[78:79]
 v_pk_mul_f32 v[80:81], v[48:49], v[80:81]
 v_pk_mul_f32 v[82:83], v[50:51], v[82:83]
 v_pk_mul_f32 v[84:85], v[52:53], v[84:85]
 v_pk_mul_f32 v[86:87], v[54:55], v[86:87]
 v_pk_add_f32 v[56:57], v[56:57], 1.0
 v_pk_add_f32 v[58:59], v[58:59], 1.0
 v_pk_add_f32 v[60:61], v[60:61], 1.0
 v_pk_add_f32 v[62:63], v[62:63], 1.0
 v_pk_add_f32 v[64:65], v[64:65], 1.0
 v_pk_add_f32 v[66:67], v[66:67], 1.0
 v_pk_add_f32 v[68:69], v[68:69], 1.0
 v_pk_add_f32 v[70:71], v[70:71], 1.0
 v_pk_fma_f32 v[88:89], v[72:73], v[72:73], v[88:89]
 v_pk_fma_f32 v[90:91], v[74:75], v[74:75], v[90:91]
 v_pk_fma_f32 v[92:93], v[76:77], v[76:77], v[92:93]
 v_pk_fma_f32 v[94:95], v[78:79], v[78:79], v[94:95]
 v_pk_fma_f32 v[96:97], v[80:81], v[80:81], v[96:97]
 v_pk_fma_f32 v[98:99], v[82:83], v[82:83], v[98:99]
 v_pk_fma_f32 v[100:101], v[84:85], v[84:85], v[100:101]
 v_pk_fma_f32 v[102:103], v[86:87], v[86:87], v[102:103]
 v_cvt_pk_bf16_f32 v72, v72, v73
 v_cvt_pk_bf16_f32 v74, v74, v75
 v_cvt_pk_bf16_f32 v76, v76, v77
 v_cvt_pk_bf16_f32 v78, v78, v79
 v_cvt_pk_bf16_f32 v80, v80, v81
 v_cvt_pk_bf16_f32 v82, v82, v83
 v_cvt_pk_bf16_f32 v84, v84, v85
 v_cvt_pk_bf16_f32 v86, v86, v87
 v_accvgpr_write_b32 a136, v72
 v_accvgpr_write_b32 a137, v74
 v_accvgpr_write_b32 a138, v76
 v_accvgpr_write_b32 a139, v78
 v_accvgpr_write_b32 a140, v80
 v_accvgpr_write_b32 a141, v82
 v_accvgpr_write_b32 a142, v84
 v_accvgpr_write_b32 a143, v86
 v_pk_fma_f32 v[72:73], v[24:25], v[24:25], s[50:51]
 v_pk_fma_f32 v[74:75], v[26:27], v[26:27], s[50:51]
 v_pk_fma_f32 v[76:77], v[28:29], v[28:29], s[50:51]
 v_pk_fma_f32 v[78:79], v[30:31], v[30:31], s[50:51]
 v_pk_fma_f32 v[80:81], v[32:33], v[32:33], s[50:51]
 v_pk_fma_f32 v[82:83], v[34:35], v[34:35], s[50:51]
 v_pk_fma_f32 v[84:85], v[36:37], v[36:37], s[50:51]
 v_pk_fma_f32 v[86:87], v[38:39], v[38:39], s[50:51]
 v_pk_mul_f32 v[72:73], v[72:73], v[24:25]
 v_pk_mul_f32 v[74:75], v[74:75], v[26:27]
 v_pk_mul_f32 v[76:77], v[76:77], v[28:29]
 v_pk_mul_f32 v[78:79], v[78:79], v[30:31]
 v_pk_mul_f32 v[80:81], v[80:81], v[32:33]
 v_pk_mul_f32 v[82:83], v[82:83], v[34:35]
 v_pk_mul_f32 v[84:85], v[84:85], v[36:37]
 v_pk_mul_f32 v[86:87], v[86:87], v[38:39]
 s_waitcnt lgkmcnt(4)
 v_mfma_f32_32x32x16_bf16 v[40:55], a[232:235], a[224:227], 0
 ds_read_b128 a[220:223], v2 offset:31744
 v_add_f32_dpp v88, v88, v88 row_ror:8 row_mask:0xf bank_mask:0x3
 v_rcp_f32 v56, v56
 v_add_f32_dpp v90, v90, v90 row_ror:8 row_mask:0xf bank_mask:0x3
 v_exp_f32_e64 v72, v72
 v_add_f32_dpp v92, v92, v92 row_ror:8 row_mask:0xf bank_mask:0x3
 v_add_f32_dpp v94, v94, v94 row_ror:8 row_mask:0xf bank_mask:0x3
 v_mfma_f32_32x32x16_bf16 v[40:55], a[236:239], a[228:231], v[40:55]
 ds_read_b128 a[224:227], v2 offset:32768
 s_mul_i32 s62, s60, 24576
 s_add_u32 s62, s62, s54
 s_add_u32 s63, s62, 4096
 s_add_u32 s55, s62, 8192
 v_add_f32_dpp v96, v96, v96 row_ror:8 row_mask:0xf bank_mask:0x3
 v_rcp_f32 v57, v57
 v_add_f32_dpp v98, v98, v98 row_ror:8 row_mask:0xf bank_mask:0x3
 v_exp_f32_e64 v73, v73
 v_add_f32_dpp v100, v100, v100 row_ror:8 row_mask:0xf bank_mask:0x3
 v_add_f32_dpp v102, v102, v102 row_ror:8 row_mask:0xf bank_mask:0x3
 v_mfma_f32_32x32x16_bf16 v[40:55], a[240:243], a[200:203], v[40:55]
 ds_read_b128 a[228:231], v2 offset:33792
 v_add_f32_dpp v88, v89, v89 row_ror:8 row_mask:0xf bank_mask:0xc
 v_rcp_f32_e64 v58, v58
 v_add_f32_dpp v90, v91, v91 row_ror:8 row_mask:0xf bank_mask:0xc
 v_exp_f32 v74, v74
 v_add_f32_dpp v92, v93, v93 row_ror:8 row_mask:0xf bank_mask:0xc
 v_add_f32_dpp v94, v95, v95 row_ror:8 row_mask:0xf bank_mask:0xc
 s_waitcnt lgkmcnt(4)
 v_mfma_f32_32x32x16_bf16 v[40:55], a[244:247], a[204:207], v[40:55]
 ds_read_b128 a[200:203], v2 offset:34816
 buffer_load_dwordx4 a[152:155], v5, s[24:27], s62 offen offset:0 sc1
 v_add_f32_dpp v96, v97, v97 row_ror:8 row_mask:0xf bank_mask:0xc
 v_rcp_f32_e64 v59, v59
 v_add_f32_dpp v98, v99, v99 row_ror:8 row_mask:0xf bank_mask:0xc
 v_exp_f32_e64 v75, v75
 v_add_f32_dpp v100, v101, v101 row_ror:8 row_mask:0xf bank_mask:0xc
 v_rcp_f32_e64 v60, v60
 v_add_f32_dpp v102, v103, v103 row_ror:8 row_mask:0xf bank_mask:0xc
 v_mfma_f32_32x32x16_bf16 v[40:55], a[248:251], a[208:211], v[40:55]
 ds_read_b128 a[204:207], v2 offset:35840
 v_add_f32_dpp v88, v88, v88 row_shl:4 row_mask:0xf bank_mask:0x5
 v_exp_f32_e64 v76, v76
 v_add_f32_dpp v92, v92, v92 row_shl:4 row_mask:0xf bank_mask:0x5
 v_rcp_f32_e64 v61, v61
 v_add_f32_dpp v96, v96, v96 row_shl:4 row_mask:0xf bank_mask:0x5
 v_add_f32_dpp v100, v100, v100 row_shl:4 row_mask:0xf bank_mask:0x5
 v_mfma_f32_32x32x16_bf16 v[40:55], a[252:255], a[212:215], v[40:55]
 v_add_f32_dpp v88, v90, v90 row_shr:4 row_mask:0xf bank_mask:0xa
 v_exp_f32_e64 v77, v77
 v_add_f32_dpp v92, v94, v94 row_shr:4 row_mask:0xf bank_mask:0xa
 v_rcp_f32_e64 v62, v62
 v_add_f32_dpp v96, v98, v98 row_shr:4 row_mask:0xf bank_mask:0xa
 v_add_f32_dpp v100, v102, v102 row_shr:4 row_mask:0xf bank_mask:0xa
 s_waitcnt lgkmcnt(3)
 v_mfma_f32_32x32x16_bf16 v[40:55], a[176:179], a[216:219], v[40:55]
 s_lshl_b32 s6, s58, 8
 v_exp_f32 v78, v78
 v_add_u32 v7, s6, v6
 v_rcp_f32 v63, v63
 v_permlane16_swap_b32 v88, v92
 v_mfma_f32_32x32x16_bf16 v[40:55], a[180:183], a[220:223], v[40:55]
 v_permlane16_swap_b32 v96, v100
 v_exp_f32 v79, v79
 v_add_f32 v88, v88, v92
 v_rcp_f32 v64, v64
 v_add_f32 v96, v96, v100
 v_exp_f32 v80, v80
 v_mfma_f32_32x32x16_bf16 v[40:55], a[184:187], a[224:227], v[40:55]
 buffer_load_dwordx4 a[156:159], v5, s[24:27], s62 offen offset:1024 sc1
 v_add_f32_dpp v88, v88, v88 quad_perm:[2,3,0,1] row_mask:0xf bank_mask:0xf
 v_rcp_f32_e64 v65, v65
 v_add_f32_dpp v96, v96, v96 quad_perm:[2,3,0,1] row_mask:0xf bank_mask:0xf
 v_exp_f32 v81, v81
 s_waitcnt lgkmcnt(0)
 v_mfma_f32_32x32x16_bf16 v[40:55], a[188:191], a[228:231], v[40:55]
 v_cndmask_b32 v88, v88, v96, s[52:53]
 v_rcp_f32 v66, v66
 s_nop 0
 v_add_f32_dpp v89, v88, v88 quad_perm:[1,0,3,2] row_mask:0xf bank_mask:0xf
 v_exp_f32_e64 v82, v82
 v_mfma_f32_32x32x16_bf16 v[40:55], a[192:195], a[200:203], v[40:55]
 ds_read_b128 a[208:211], v2 offset:47104
 ds_write_b32 v7, v89
 v_rcp_f32 v67, v67
 v_exp_f32 v83, v83
 v_mfma_f32_32x32x16_bf16 v[40:55], a[196:199], a[204:207], v[40:55]
 ds_read_b128 a[212:215], v2 offset:48128
 v_rcp_f32 v68, v68
 v_exp_f32 v84, v84
 v_rcp_f32 v69, v69
 v_exp_f32 v85, v85
 v_rcp_f32 v70, v70
 v_exp_f32 v86, v86
 v_rcp_f32 v71, v71
 v_exp_f32 v87, v87
 v_pk_mul_f32 v[56:57], v[8:9], v[56:57]
 v_pk_mul_f32 v[58:59], v[10:11], v[58:59]
 v_pk_mul_f32 v[60:61], v[12:13], v[60:61]
 v_pk_mul_f32 v[62:63], v[14:15], v[62:63]
 v_pk_mul_f32 v[64:65], v[16:17], v[64:65]
 v_pk_mul_f32 v[66:67], v[18:19], v[66:67]
 v_pk_mul_f32 v[68:69], v[20:21], v[68:69]
 v_pk_mul_f32 v[70:71], v[22:23], v[70:71]
 v_pk_add_f32 v[72:73], v[72:73], 1.0
 v_pk_add_f32 v[74:75], v[74:75], 1.0
 v_pk_add_f32 v[76:77], v[76:77], 1.0
 v_pk_add_f32 v[78:79], v[78:79], 1.0
 v_pk_add_f32 v[80:81], v[80:81], 1.0
 v_pk_add_f32 v[82:83], v[82:83], 1.0
 v_pk_add_f32 v[84:85], v[84:85], 1.0
 v_pk_add_f32 v[86:87], v[86:87], 1.0
 v_pk_mul_f32 v[88:89], v[56:57], v[56:57]
 v_pk_mul_f32 v[90:91], v[58:59], v[58:59]
 v_pk_mul_f32 v[92:93], v[60:61], v[60:61]
 v_pk_mul_f32 v[94:95], v[62:63], v[62:63]
 v_pk_mul_f32 v[96:97], v[64:65], v[64:65]
 v_pk_mul_f32 v[98:99], v[66:67], v[66:67]
 v_pk_mul_f32 v[100:101], v[68:69], v[68:69]
 v_pk_mul_f32 v[102:103], v[70:71], v[70:71]
 v_cvt_pk_bf16_f32 v56, v56, v57
 v_cvt_pk_bf16_f32 v58, v58, v59
 v_cvt_pk_bf16_f32 v60, v60, v61
 v_cvt_pk_bf16_f32 v62, v62, v63
 v_cvt_pk_bf16_f32 v64, v64, v65
 v_cvt_pk_bf16_f32 v66, v66, v67
 v_cvt_pk_bf16_f32 v68, v68, v69
 v_cvt_pk_bf16_f32 v70, v70, v71
 v_accvgpr_write_b32 a144, v56
 v_accvgpr_write_b32 a145, v58
 v_accvgpr_write_b32 a146, v60
 v_accvgpr_write_b32 a147, v62
 v_accvgpr_write_b32 a148, v64
 v_accvgpr_write_b32 a149, v66
 v_accvgpr_write_b32 a150, v68
 v_accvgpr_write_b32 a151, v70
 v_pk_fma_f32 v[56:57], v[40:41], v[40:41], s[50:51]
 v_pk_fma_f32 v[58:59], v[42:43], v[42:43], s[50:51]
 v_pk_fma_f32 v[60:61], v[44:45], v[44:45], s[50:51]
 v_pk_fma_f32 v[62:63], v[46:47], v[46:47], s[50:51]
 v_pk_fma_f32 v[64:65], v[48:49], v[48:49], s[50:51]
 v_pk_fma_f32 v[66:67], v[50:51], v[50:51], s[50:51]
 v_pk_fma_f32 v[68:69], v[52:53], v[52:53], s[50:51]
 v_pk_fma_f32 v[70:71], v[54:55], v[54:55], s[50:51]
 v_pk_mul_f32 v[56:57], v[56:57], v[40:41]
 v_pk_mul_f32 v[58:59], v[58:59], v[42:43]
 v_pk_mul_f32 v[60:61], v[60:61], v[44:45]
 v_pk_mul_f32 v[62:63], v[62:63], v[46:47]
 v_pk_mul_f32 v[64:65], v[64:65], v[48:49]
 v_pk_mul_f32 v[66:67], v[66:67], v[50:51]
 v_pk_mul_f32 v[68:69], v[68:69], v[52:53]
 v_pk_mul_f32 v[70:71], v[70:71], v[54:55]
 v_mfma_f32_32x32x16_bf16 v[8:23], a[232:235], v[200:203], 0
 ds_read_b128 a[216:219], v2 offset:49152
 v_rcp_f32 v72, v72
 v_exp_f32 v56, v56
 v_mfma_f32_32x32x16_bf16 v[8:23], a[236:239], v[204:207], v[8:23]
 ds_read_b128 a[220:223], v2 offset:50176
 v_rcp_f32 v73, v73
 v_exp_f32 v57, v57
 v_mfma_f32_32x32x16_bf16 v[8:23], a[240:243], v[208:211], v[8:23]
 ds_read_b128 a[224:227], v2 offset:51200
 v_rcp_f32 v74, v74
 v_exp_f32 v58, v58
 v_mfma_f32_32x32x16_bf16 v[8:23], a[244:247], v[212:215], v[8:23]
 ds_read_b128 a[228:231], v2 offset:52224
 buffer_load_dwordx4 a[160:163], v5, s[24:27], s62 offen offset:2048 sc1
 v_rcp_f32 v75, v75
 v_exp_f32 v59, v59
 v_rcp_f32_e64 v76, v76
 v_mfma_f32_32x32x16_bf16 v[8:23], a[248:251], v[216:219], v[8:23]
 ds_read_b128 a[200:203], v2 offset:53248
 v_exp_f32 v60, v60
 v_rcp_f32 v77, v77
 v_mfma_f32_32x32x16_bf16 v[8:23], a[252:255], v[220:223], v[8:23]
 v_exp_f32 v61, v61
 v_rcp_f32 v78, v78
 v_mfma_f32_32x32x16_bf16 v[8:23], a[176:179], v[224:227], v[8:23]
 v_exp_f32 v62, v62
 v_rcp_f32 v79, v79
 v_mfma_f32_32x32x16_bf16 v[8:23], a[180:183], v[228:231], v[8:23]
 v_exp_f32 v63, v63
 v_rcp_f32 v80, v80
 v_exp_f32_e64 v64, v64
 v_mfma_f32_32x32x16_bf16 v[8:23], a[184:187], v[232:235], v[8:23]
 buffer_load_dwordx4 a[164:167], v5, s[24:27], s62 offen offset:3072 sc1
 v_rcp_f32_e64 v81, v81
 v_exp_f32 v65, v65
 s_waitcnt lgkmcnt(5)
 v_mfma_f32_32x32x16_bf16 v[8:23], a[188:191], v[236:239], v[8:23]
 v_rcp_f32 v82, v82
 v_exp_f32 v66, v66
 v_mfma_f32_32x32x16_bf16 v[8:23], a[192:195], a[208:211], v[8:23]
 ds_read_b128 a[204:207], v2 offset:54272
 v_rcp_f32 v83, v83
 v_exp_f32 v67, v67
 v_mfma_f32_32x32x16_bf16 v[8:23], a[196:199], a[212:215], v[8:23]
 ds_read_b128 a[208:211], v2 offset:55296
 v_rcp_f32 v84, v84
 v_exp_f32 v68, v68
 v_rcp_f32 v85, v85
 v_exp_f32 v69, v69
 v_rcp_f32 v86, v86
 v_exp_f32 v70, v70
 v_rcp_f32 v87, v87
 v_exp_f32 v71, v71
 v_pk_mul_f32 v[72:73], v[24:25], v[72:73]
 v_pk_mul_f32 v[74:75], v[26:27], v[74:75]
 v_pk_mul_f32 v[76:77], v[28:29], v[76:77]
 v_pk_mul_f32 v[78:79], v[30:31], v[78:79]
 v_pk_mul_f32 v[80:81], v[32:33], v[80:81]
 v_pk_mul_f32 v[82:83], v[34:35], v[82:83]
 v_pk_mul_f32 v[84:85], v[36:37], v[84:85]
 v_pk_mul_f32 v[86:87], v[38:39], v[86:87]
 v_pk_add_f32 v[56:57], v[56:57], 1.0
 v_pk_add_f32 v[58:59], v[58:59], 1.0
 v_pk_add_f32 v[60:61], v[60:61], 1.0
 v_pk_add_f32 v[62:63], v[62:63], 1.0
 v_pk_add_f32 v[64:65], v[64:65], 1.0
 v_pk_add_f32 v[66:67], v[66:67], 1.0
 v_pk_add_f32 v[68:69], v[68:69], 1.0
 v_pk_add_f32 v[70:71], v[70:71], 1.0
 v_pk_fma_f32 v[88:89], v[72:73], v[72:73], v[88:89]
 v_pk_fma_f32 v[90:91], v[74:75], v[74:75], v[90:91]
 v_pk_fma_f32 v[92:93], v[76:77], v[76:77], v[92:93]
 v_pk_fma_f32 v[94:95], v[78:79], v[78:79], v[94:95]
 v_pk_fma_f32 v[96:97], v[80:81], v[80:81], v[96:97]
 v_pk_fma_f32 v[98:99], v[82:83], v[82:83], v[98:99]
 v_pk_fma_f32 v[100:101], v[84:85], v[84:85], v[100:101]
 v_pk_fma_f32 v[102:103], v[86:87], v[86:87], v[102:103]
 v_cvt_pk_bf16_f32 v104, v72, v73
 v_cvt_pk_bf16_f32 v105, v74, v75
 v_cvt_pk_bf16_f32 v106, v76, v77
 v_cvt_pk_bf16_f32 v107, v78, v79
 v_cvt_pk_bf16_f32 v108, v80, v81
 v_cvt_pk_bf16_f32 v109, v82, v83
 v_cvt_pk_bf16_f32 v110, v84, v85
 v_cvt_pk_bf16_f32 v111, v86, v87
 v_pk_fma_f32 v[72:73], v[8:9], v[8:9], s[50:51]
 v_pk_fma_f32 v[74:75], v[10:11], v[10:11], s[50:51]
 v_pk_fma_f32 v[76:77], v[12:13], v[12:13], s[50:51]
 v_pk_fma_f32 v[78:79], v[14:15], v[14:15], s[50:51]
 v_pk_fma_f32 v[80:81], v[16:17], v[16:17], s[50:51]
 v_pk_fma_f32 v[82:83], v[18:19], v[18:19], s[50:51]
 v_pk_fma_f32 v[84:85], v[20:21], v[20:21], s[50:51]
 v_pk_fma_f32 v[86:87], v[22:23], v[22:23], s[50:51]
 v_pk_mul_f32 v[72:73], v[72:73], v[8:9]
 v_pk_mul_f32 v[74:75], v[74:75], v[10:11]
 v_pk_mul_f32 v[76:77], v[76:77], v[12:13]
 v_pk_mul_f32 v[78:79], v[78:79], v[14:15]
 v_pk_mul_f32 v[80:81], v[80:81], v[16:17]
 v_pk_mul_f32 v[82:83], v[82:83], v[18:19]
 v_pk_mul_f32 v[84:85], v[84:85], v[20:21]
 v_pk_mul_f32 v[86:87], v[86:87], v[22:23]
 s_waitcnt lgkmcnt(4)
 v_mfma_f32_32x32x16_bf16 v[24:39], a[232:235], a[216:219], 0
 ds_read_b128 a[212:215], v2 offset:56320
 v_rcp_f32 v56, v56
 v_exp_f32_e64 v72, v72
 v_mfma_f32_32x32x16_bf16 v[24:39], a[236:239], a[220:223], v[24:39]
 ds_read_b128 a[216:219], v2 offset:57344
 v_rcp_f32 v57, v57
 v_exp_f32 v73, v73
 v_mfma_f32_32x32x16_bf16 v[24:39], a[240:243], a[224:227], v[24:39]
 ds_read_b128 a[220:223], v2 offset:58368
 v_rcp_f32_e64 v58, v58
 v_exp_f32 v74, v74
 s_waitcnt lgkmcnt(4)
 v_mfma_f32_32x32x16_bf16 v[24:39], a[244:247], a[228:231], v[24:39]
 ds_read_b128 a[224:227], v2 offset:59392
 buffer_load_dwordx4 a[168:171], v5, s[24:27], s63 offen offset:0 sc1
 v_rcp_f32 v59, v59
 v_exp_f32 v75, v75
 v_rcp_f32_e64 v60, v60
 v_mfma_f32_32x32x16_bf16 v[24:39], a[248:251], a[200:203], v[24:39]
 ds_read_b128 a[228:231], v2 offset:60416
 v_exp_f32 v76, v76
 v_rcp_f32 v61, v61
 v_mfma_f32_32x32x16_bf16 v[24:39], a[252:255], a[204:207], v[24:39]
 ds_read_b128 a[200:203], v3 offset:36864
 v_exp_f32_e64 v77, v77
 v_rcp_f32 v62, v62
 s_waitcnt lgkmcnt(4)
 v_mfma_f32_32x32x16_bf16 v[24:39], a[176:179], a[208:211], v[24:39]
 ds_read_b128 a[204:207], v3 offset:37888
 v_exp_f32 v78, v78
 v_rcp_f32 v63, v63
 v_mfma_f32_32x32x16_bf16 v[24:39], a[180:183], a[212:215], v[24:39]
 ds_read_b128 a[208:211], v3 offset:38912
 v_exp_f32 v79, v79
 v_rcp_f32 v64, v64
 v_exp_f32_e64 v80, v80
 v_mfma_f32_32x32x16_bf16 v[24:39], a[184:187], a[216:219], v[24:39]
 ds_read_b128 a[212:215], v3 offset:39936
 buffer_load_dwordx4 a[172:175], v5, s[24:27], s63 offen offset:1024 sc1
 v_rcp_f32_e64 v65, v65
 v_exp_f32 v81, v81
 s_waitcnt lgkmcnt(4)
 v_mfma_f32_32x32x16_bf16 v[24:39], a[188:191], a[220:223], v[24:39]
 ds_read_b128 a[216:219], v3 offset:40960
 v_rcp_f32 v66, v66
 v_exp_f32 v82, v82
 v_mfma_f32_32x32x16_bf16 v[24:39], a[192:195], a[224:227], v[24:39]
 ds_read_b128 a[220:223], v3 offset:41984
 v_rcp_f32 v67, v67
 v_exp_f32 v83, v83
 v_mfma_f32_32x32x16_bf16 v[24:39], a[196:199], a[228:231], v[24:39]
 ds_read_b128 a[224:227], v3 offset:43008
 v_rcp_f32 v68, v68
 v_exp_f32 v84, v84
 v_rcp_f32 v69, v69
 v_exp_f32 v85, v85
 v_rcp_f32 v70, v70
 v_exp_f32 v86, v86
 v_rcp_f32 v71, v71
 v_exp_f32 v87, v87
 v_pk_mul_f32 v[56:57], v[40:41], v[56:57]
 v_pk_mul_f32 v[58:59], v[42:43], v[58:59]
 v_pk_mul_f32 v[60:61], v[44:45], v[60:61]
 v_pk_mul_f32 v[62:63], v[46:47], v[62:63]
 v_pk_mul_f32 v[64:65], v[48:49], v[64:65]
 v_pk_mul_f32 v[66:67], v[50:51], v[66:67]
 v_pk_mul_f32 v[68:69], v[52:53], v[68:69]
 v_pk_mul_f32 v[70:71], v[54:55], v[70:71]
 v_pk_add_f32 v[72:73], v[72:73], 1.0
 v_pk_add_f32 v[74:75], v[74:75], 1.0
 v_pk_add_f32 v[76:77], v[76:77], 1.0
 v_pk_add_f32 v[78:79], v[78:79], 1.0
 v_pk_add_f32 v[80:81], v[80:81], 1.0
 v_pk_add_f32 v[82:83], v[82:83], 1.0
 v_pk_add_f32 v[84:85], v[84:85], 1.0
 v_pk_add_f32 v[86:87], v[86:87], 1.0
 v_pk_fma_f32 v[88:89], v[56:57], v[56:57], v[88:89]
 v_pk_fma_f32 v[90:91], v[58:59], v[58:59], v[90:91]
 v_pk_fma_f32 v[92:93], v[60:61], v[60:61], v[92:93]
 v_pk_fma_f32 v[94:95], v[62:63], v[62:63], v[94:95]
 v_pk_fma_f32 v[96:97], v[64:65], v[64:65], v[96:97]
 v_pk_fma_f32 v[98:99], v[66:67], v[66:67], v[98:99]
 v_pk_fma_f32 v[100:101], v[68:69], v[68:69], v[100:101]
 v_pk_fma_f32 v[102:103], v[70:71], v[70:71], v[102:103]
 v_cvt_pk_bf16_f32 v112, v56, v57
 v_cvt_pk_bf16_f32 v113, v58, v59
 v_cvt_pk_bf16_f32 v114, v60, v61
 v_cvt_pk_bf16_f32 v115, v62, v63
 v_cvt_pk_bf16_f32 v116, v64, v65
 v_cvt_pk_bf16_f32 v117, v66, v67
 v_cvt_pk_bf16_f32 v118, v68, v69
 v_cvt_pk_bf16_f32 v119, v70, v71
 v_pk_fma_f32 v[56:57], v[24:25], v[24:25], s[50:51]
 v_pk_fma_f32 v[58:59], v[26:27], v[26:27], s[50:51]
 v_pk_fma_f32 v[60:61], v[28:29], v[28:29], s[50:51]
 v_pk_fma_f32 v[62:63], v[30:31], v[30:31], s[50:51]
 v_pk_fma_f32 v[64:65], v[32:33], v[32:33], s[50:51]
 v_pk_fma_f32 v[66:67], v[34:35], v[34:35], s[50:51]
 v_pk_fma_f32 v[68:69], v[36:37], v[36:37], s[50:51]
 v_pk_fma_f32 v[70:71], v[38:39], v[38:39], s[50:51]
 v_pk_mul_f32 v[56:57], v[56:57], v[24:25]
 v_pk_mul_f32 v[58:59], v[58:59], v[26:27]
 v_pk_mul_f32 v[60:61], v[60:61], v[28:29]
 v_pk_mul_f32 v[62:63], v[62:63], v[30:31]
 v_pk_mul_f32 v[64:65], v[64:65], v[32:33]
 v_pk_mul_f32 v[66:67], v[66:67], v[34:35]
 v_pk_mul_f32 v[68:69], v[68:69], v[36:37]
 v_pk_mul_f32 v[70:71], v[70:71], v[38:39]
 s_waitcnt lgkmcnt(4)
 v_mfma_f32_32x32x16_bf16 v[40:55], a[232:235], a[200:203], 0
 ds_read_b128 a[228:231], v3 offset:44032
 v_rcp_f32 v72, v72
 v_exp_f32_e64 v56, v56
 v_mfma_f32_32x32x16_bf16 v[40:55], a[236:239], a[204:207], v[40:55]
 ds_read_b128 a[200:203], v3 offset:45056
 v_rcp_f32 v73, v73
 v_exp_f32 v57, v57
 v_mfma_f32_32x32x16_bf16 v[40:55], a[240:243], a[208:211], v[40:55]
 ds_read_b128 a[204:207], v3 offset:46080
 v_rcp_f32_e64 v74, v74
 v_exp_f32 v58, v58
 s_waitcnt lgkmcnt(4)
 v_mfma_f32_32x32x16_bf16 v[40:55], a[244:247], a[212:215], v[40:55]
 ds_read_b128 a[208:211], v3 offset:47104
 v_rcp_f32 v75, v75
 v_exp_f32 v59, v59
 v_rcp_f32_e64 v76, v76
 v_mfma_f32_32x32x16_bf16 v[40:55], a[248:251], a[216:219], v[40:55]
 ds_read_b128 a[212:215], v3 offset:48128
 v_exp_f32 v60, v60
 v_rcp_f32 v77, v77
 v_mfma_f32_32x32x16_bf16 v[40:55], a[252:255], a[220:223], v[40:55]
 ds_read_b128 a[216:219], v2 offset:0
 v_exp_f32_e64 v61, v61
 v_rcp_f32 v78, v78
 s_waitcnt lgkmcnt(4)
 v_mfma_f32_32x32x16_bf16 v[40:55], a[176:179], a[224:227], v[40:55]
 ds_read_b128 a[220:223], v2 offset:1024
 buffer_load_dwordx4 a[176:179], v5, s[24:27], s63 offen offset:2048 sc1
 v_exp_f32 v62, v62
 v_rcp_f32 v79, v79
 v_mfma_f32_32x32x16_bf16 v[40:55], a[180:183], a[228:231], v[40:55]
 ds_read_b128 a[224:227], v2 offset:2048
 buffer_load_dwordx4 a[180:183], v5, s[24:27], s63 offen offset:3072 sc1
 v_exp_f32 v63, v63
 v_rcp_f32 v80, v80
 v_exp_f32_e64 v64, v64
 v_mfma_f32_32x32x16_bf16 v[40:55], a[184:187], a[200:203], v[40:55]
 ds_read_b128 a[228:231], v2 offset:3072
 buffer_load_dwordx4 a[184:187], v5, s[24:27], s55 offen offset:0 sc1
 v_rcp_f32_e64 v81, v81
 v_exp_f32 v65, v65
 s_waitcnt lgkmcnt(4)
 v_mfma_f32_32x32x16_bf16 v[40:55], a[188:191], a[204:207], v[40:55]
 ds_read_b128 a[200:203], v2 offset:4096
 buffer_load_dwordx4 a[188:191], v5, s[24:27], s55 offen offset:1024 sc1
 v_rcp_f32 v82, v82
 v_exp_f32 v66, v66
 v_mfma_f32_32x32x16_bf16 v[40:55], a[192:195], a[208:211], v[40:55]
 ds_read_b128 a[204:207], v2 offset:5120
 buffer_load_dwordx4 a[192:195], v5, s[24:27], s55 offen offset:2048 sc1
 v_rcp_f32 v83, v83
 v_exp_f32 v67, v67
 v_mfma_f32_32x32x16_bf16 v[40:55], a[196:199], a[212:215], v[40:55]
 ds_read_b128 a[208:211], v2 offset:6144
 buffer_load_dwordx4 a[196:199], v5, s[24:27], s55 offen offset:3072 sc1
 v_rcp_f32 v84, v84
 v_exp_f32 v68, v68
 v_rcp_f32 v85, v85
 v_exp_f32 v69, v69
 v_rcp_f32 v86, v86
 v_exp_f32 v70, v70
 v_rcp_f32 v87, v87
 v_exp_f32 v71, v71
 v_pk_mul_f32 v[72:73], v[8:9], v[72:73]
 v_pk_mul_f32 v[74:75], v[10:11], v[74:75]
 v_pk_mul_f32 v[76:77], v[12:13], v[76:77]
 v_pk_mul_f32 v[78:79], v[14:15], v[78:79]
 v_pk_mul_f32 v[80:81], v[16:17], v[80:81]
 v_pk_mul_f32 v[82:83], v[18:19], v[82:83]
 v_pk_mul_f32 v[84:85], v[20:21], v[84:85]
 v_pk_mul_f32 v[86:87], v[22:23], v[86:87]
 v_pk_add_f32 v[56:57], v[56:57], 1.0
 v_pk_add_f32 v[58:59], v[58:59], 1.0
 v_pk_add_f32 v[60:61], v[60:61], 1.0
 v_pk_add_f32 v[62:63], v[62:63], 1.0
 v_pk_add_f32 v[64:65], v[64:65], 1.0
 v_pk_add_f32 v[66:67], v[66:67], 1.0
 v_pk_add_f32 v[68:69], v[68:69], 1.0
 v_pk_add_f32 v[70:71], v[70:71], 1.0
 v_pk_fma_f32 v[88:89], v[72:73], v[72:73], v[88:89]
 v_pk_fma_f32 v[90:91], v[74:75], v[74:75], v[90:91]
 v_pk_fma_f32 v[92:93], v[76:77], v[76:77], v[92:93]
 v_pk_fma_f32 v[94:95], v[78:79], v[78:79], v[94:95]
 v_pk_fma_f32 v[96:97], v[80:81], v[80:81], v[96:97]
 v_pk_fma_f32 v[98:99], v[82:83], v[82:83], v[98:99]
 v_pk_fma_f32 v[100:101], v[84:85], v[84:85], v[100:101]
 v_pk_fma_f32 v[102:103], v[86:87], v[86:87], v[102:103]
 v_cvt_pk_bf16_f32 v120, v72, v73
 v_cvt_pk_bf16_f32 v121, v74, v75
 v_cvt_pk_bf16_f32 v122, v76, v77
 v_cvt_pk_bf16_f32 v123, v78, v79
 v_cvt_pk_bf16_f32 v124, v80, v81
 v_cvt_pk_bf16_f32 v125, v82, v83
 v_cvt_pk_bf16_f32 v126, v84, v85
 v_cvt_pk_bf16_f32 v127, v86, v87
 v_pk_fma_f32 v[72:73], v[40:41], v[40:41], s[50:51]
 v_pk_fma_f32 v[74:75], v[42:43], v[42:43], s[50:51]
 v_pk_fma_f32 v[76:77], v[44:45], v[44:45], s[50:51]
 v_pk_fma_f32 v[78:79], v[46:47], v[46:47], s[50:51]
 v_pk_fma_f32 v[80:81], v[48:49], v[48:49], s[50:51]
 v_pk_fma_f32 v[82:83], v[50:51], v[50:51], s[50:51]
 v_pk_fma_f32 v[84:85], v[52:53], v[52:53], s[50:51]
 v_pk_fma_f32 v[86:87], v[54:55], v[54:55], s[50:51]
 v_pk_mul_f32 v[72:73], v[72:73], v[40:41]
 v_pk_mul_f32 v[74:75], v[74:75], v[42:43]
 v_pk_mul_f32 v[76:77], v[76:77], v[44:45]
 v_pk_mul_f32 v[78:79], v[78:79], v[46:47]
 v_pk_mul_f32 v[80:81], v[80:81], v[48:49]
 v_pk_mul_f32 v[82:83], v[82:83], v[50:51]
 v_pk_mul_f32 v[84:85], v[84:85], v[52:53]
 v_pk_mul_f32 v[86:87], v[86:87], v[54:55]
 s_mul_i32 s6, s5, 12288
 s_mul_i32 s7, s3, 3072
 s_add_u32 s6, s6, s7
 s_add_u32 s6, s6, 0x101000
 s_cmp_lt_u32 s4, 6
 s_cselect_b32 s87, s6, 0x40000000
 buffer_load_dwordx4 v[204:207], v5, s[24:27], s87 offen offset:0 sc1
 buffer_load_dwordx4 v[208:211], v5, s[24:27], s87 offen offset:1024 sc1
 buffer_load_dwordx4 v[212:215], v5, s[24:27], s87 offen offset:2048 sc1
 s_waitcnt lgkmcnt(4)
 s_waitcnt vmcnt(12)
 v_mfma_f32_32x32x16_bf16 v[8:23], a[152:155], a[216:219], 0
 ds_read_b128 a[212:215], v2 offset:7168
 v_rcp_f32 v56, v56
 v_exp_f32_e64 v72, v72
 v_mfma_f32_32x32x16_bf16 v[8:23], a[156:159], a[220:223], v[8:23]
 ds_read_b128 a[216:219], v2 offset:8192
 v_rcp_f32 v57, v57
 v_exp_f32 v73, v73
 v_mfma_f32_32x32x16_bf16 v[8:23], a[160:163], a[224:227], v[8:23]
 ds_read_b128 a[220:223], v2 offset:9216
 v_rcp_f32 v58, v58
 v_exp_f32 v74, v74
 s_waitcnt lgkmcnt(4)
 s_waitcnt vmcnt(9)
 v_mfma_f32_32x32x16_bf16 v[8:23], a[164:167], a[228:231], v[8:23]
 ds_read_b128 a[224:227], v2 offset:10240
 v_rcp_f32 v59, v59
 v_exp_f32 v75, v75
 v_rcp_f32_e64 v60, v60
 v_mfma_f32_32x32x16_bf16 v[8:23], a[168:171], a[200:203], v[8:23]
 ds_read_b128 a[228:231], v2 offset:11264
 v_exp_f32 v76, v76
 v_rcp_f32 v61, v61
 v_mfma_f32_32x32x16_bf16 v[8:23], a[172:175], a[204:207], v[8:23]
 v_exp_f32 v77, v77
 v_rcp_f32 v62, v62
 s_waitcnt lgkmcnt(3)
 s_waitcnt vmcnt(6)
 v_mfma_f32_32x32x16_bf16 v[8:23], a[176:179], a[208:211], v[8:23]
 v_exp_f32 v78, v78
 v_rcp_f32 v63, v63
 v_mfma_f32_32x32x16_bf16 v[8:23], a[180:183], a[212:215], v[8:23]
 v_exp_f32 v79, v79
 v_rcp_f32 v64, v64
 v_exp_f32_e64 v80, v80
 v_mfma_f32_32x32x16_bf16 v[8:23], a[184:187], a[216:219], v[8:23]
 v_rcp_f32 v65, v65
 v_exp_f32 v81, v81
 s_waitcnt lgkmcnt(0)
 s_waitcnt vmcnt(3)
 v_mfma_f32_32x32x16_bf16 v[8:23], a[188:191], a[220:223], v[8:23]
 v_rcp_f32 v66, v66
 v_exp_f32 v82, v82
 v_mfma_f32_32x32x16_bf16 v[8:23], a[192:195], a[224:227], v[8:23]
 v_rcp_f32 v67, v67
 v_exp_f32 v83, v83
 v_mfma_f32_32x32x16_bf16 v[8:23], a[196:199], a[228:231], v[8:23]
 v_rcp_f32 v68, v68
 v_exp_f32 v84, v84
 v_rcp_f32 v69, v69
 v_exp_f32 v85, v85
 v_rcp_f32 v70, v70
 v_exp_f32 v86, v86
 v_rcp_f32 v71, v71
 v_exp_f32 v87, v87
 v_pk_mul_f32 v[56:57], v[24:25], v[56:57]
 v_pk_mul_f32 v[58:59], v[26:27], v[58:59]
 v_pk_mul_f32 v[60:61], v[28:29], v[60:61]
 v_pk_mul_f32 v[62:63], v[30:31], v[62:63]
 v_pk_mul_f32 v[64:65], v[32:33], v[64:65]
 v_pk_mul_f32 v[66:67], v[34:35], v[66:67]
 v_pk_mul_f32 v[68:69], v[36:37], v[68:69]
 v_pk_mul_f32 v[70:71], v[38:39], v[70:71]
 v_pk_add_f32 v[72:73], v[72:73], 1.0
 v_pk_add_f32 v[74:75], v[74:75], 1.0
 v_pk_add_f32 v[76:77], v[76:77], 1.0
 v_pk_add_f32 v[78:79], v[78:79], 1.0
 v_pk_add_f32 v[80:81], v[80:81], 1.0
 v_pk_add_f32 v[82:83], v[82:83], 1.0
 v_pk_add_f32 v[84:85], v[84:85], 1.0
 v_pk_add_f32 v[86:87], v[86:87], 1.0
 v_pk_fma_f32 v[88:89], v[56:57], v[56:57], v[88:89]
 v_pk_fma_f32 v[90:91], v[58:59], v[58:59], v[90:91]
 v_pk_fma_f32 v[92:93], v[60:61], v[60:61], v[92:93]
 v_pk_fma_f32 v[94:95], v[62:63], v[62:63], v[94:95]
 v_pk_fma_f32 v[96:97], v[64:65], v[64:65], v[96:97]
 v_pk_fma_f32 v[98:99], v[66:67], v[66:67], v[98:99]
 v_pk_fma_f32 v[100:101], v[68:69], v[68:69], v[100:101]
 v_pk_fma_f32 v[102:103], v[70:71], v[70:71], v[102:103]
 v_cvt_pk_bf16_f32 v128, v56, v57
 v_cvt_pk_bf16_f32 v129, v58, v59
 v_cvt_pk_bf16_f32 v130, v60, v61
 v_cvt_pk_bf16_f32 v131, v62, v63
 v_cvt_pk_bf16_f32 v132, v64, v65
 v_cvt_pk_bf16_f32 v133, v66, v67
 v_cvt_pk_bf16_f32 v134, v68, v69
 v_cvt_pk_bf16_f32 v135, v70, v71
 v_pk_fma_f32 v[56:57], v[8:9], v[8:9], s[50:51]
 v_pk_fma_f32 v[58:59], v[10:11], v[10:11], s[50:51]
 v_pk_fma_f32 v[60:61], v[12:13], v[12:13], s[50:51]
 v_pk_fma_f32 v[62:63], v[14:15], v[14:15], s[50:51]
 v_pk_fma_f32 v[64:65], v[16:17], v[16:17], s[50:51]
 v_pk_fma_f32 v[66:67], v[18:19], v[18:19], s[50:51]
 v_pk_fma_f32 v[68:69], v[20:21], v[20:21], s[50:51]
 v_pk_fma_f32 v[70:71], v[22:23], v[22:23], s[50:51]
 v_pk_mul_f32 v[56:57], v[56:57], v[8:9]
 v_pk_mul_f32 v[58:59], v[58:59], v[10:11]
 v_pk_mul_f32 v[60:61], v[60:61], v[12:13]
 v_pk_mul_f32 v[62:63], v[62:63], v[14:15]
 v_pk_mul_f32 v[64:65], v[64:65], v[16:17]
 v_pk_mul_f32 v[66:67], v[66:67], v[18:19]
 v_pk_mul_f32 v[68:69], v[68:69], v[20:21]
 v_pk_mul_f32 v[70:71], v[70:71], v[22:23]
 v_mfma_f32_32x32x16_bf16 v[24:39], a[152:155], v[152:155], 0
 ds_read_b128 a[200:203], v2 offset:24576
 v_rcp_f32 v72, v72
 v_exp_f32 v56, v56
 v_mfma_f32_32x32x16_bf16 v[24:39], a[156:159], v[156:159], v[24:39]
 ds_read_b128 a[204:207], v2 offset:25600
 v_rcp_f32 v73, v73
 v_exp_f32 v57, v57
 v_mfma_f32_32x32x16_bf16 v[24:39], a[160:163], v[160:163], v[24:39]
 ds_read_b128 a[208:211], v2 offset:26624
 v_rcp_f32 v74, v74
 v_exp_f32 v58, v58
 v_mfma_f32_32x32x16_bf16 v[24:39], a[164:167], v[164:167], v[24:39]
 ds_read_b128 a[212:215], v2 offset:27648
 v_rcp_f32 v75, v75
 v_exp_f32 v59, v59
 v_rcp_f32_e64 v76, v76
 v_mfma_f32_32x32x16_bf16 v[24:39], a[168:171], v[168:171], v[24:39]
 ds_read_b128 a[216:219], v2 offset:28672
 v_exp_f32 v60, v60
 v_rcp_f32 v77, v77
 v_mfma_f32_32x32x16_bf16 v[24:39], a[172:175], v[172:175], v[24:39]
 ds_read_b128 a[220:223], v2 offset:29696
 v_exp_f32 v61, v61
 v_rcp_f32 v78, v78
 v_mfma_f32_32x32x16_bf16 v[24:39], a[176:179], v[176:179], v[24:39]
 ds_read_b128 a[224:227], v2 offset:30720
 v_exp_f32 v62, v62
 v_rcp_f32 v79, v79
 v_mfma_f32_32x32x16_bf16 v[24:39], a[180:183], v[180:183], v[24:39]
 v_exp_f32 v63, v63
 v_rcp_f32 v80, v80
 v_exp_f32_e64 v64, v64
 v_mfma_f32_32x32x16_bf16 v[24:39], a[184:187], v[184:187], v[24:39]
 v_rcp_f32 v81, v81
 v_exp_f32 v65, v65
 v_mfma_f32_32x32x16_bf16 v[24:39], a[188:191], v[188:191], v[24:39]
 v_rcp_f32 v82, v82
 v_exp_f32 v66, v66
 v_mfma_f32_32x32x16_bf16 v[24:39], a[192:195], v[192:195], v[24:39]
 v_rcp_f32 v83, v83
 v_exp_f32 v67, v67
 v_mfma_f32_32x32x16_bf16 v[24:39], a[196:199], v[196:199], v[24:39]
 v_rcp_f32 v84, v84
 v_exp_f32 v68, v68
 v_rcp_f32 v85, v85
 v_exp_f32 v69, v69
 v_rcp_f32 v86, v86
 v_exp_f32 v70, v70
 v_rcp_f32 v87, v87
 v_exp_f32 v71, v71
 v_pk_mul_f32 v[72:73], v[40:41], v[72:73]
 v_pk_mul_f32 v[74:75], v[42:43], v[74:75]
 v_pk_mul_f32 v[76:77], v[44:45], v[76:77]
 v_pk_mul_f32 v[78:79], v[46:47], v[78:79]
 v_pk_mul_f32 v[80:81], v[48:49], v[80:81]
 v_pk_mul_f32 v[82:83], v[50:51], v[82:83]
 v_pk_mul_f32 v[84:85], v[52:53], v[84:85]
 v_pk_mul_f32 v[86:87], v[54:55], v[86:87]
 v_pk_add_f32 v[56:57], v[56:57], 1.0
 v_pk_add_f32 v[58:59], v[58:59], 1.0
 v_pk_add_f32 v[60:61], v[60:61], 1.0
 v_pk_add_f32 v[62:63], v[62:63], 1.0
 v_pk_add_f32 v[64:65], v[64:65], 1.0
 v_pk_add_f32 v[66:67], v[66:67], 1.0
 v_pk_add_f32 v[68:69], v[68:69], 1.0
 v_pk_add_f32 v[70:71], v[70:71], 1.0
 v_pk_fma_f32 v[88:89], v[72:73], v[72:73], v[88:89]
 v_pk_fma_f32 v[90:91], v[74:75], v[74:75], v[90:91]
 v_pk_fma_f32 v[92:93], v[76:77], v[76:77], v[92:93]
 v_pk_fma_f32 v[94:95], v[78:79], v[78:79], v[94:95]
 v_pk_fma_f32 v[96:97], v[80:81], v[80:81], v[96:97]
 v_pk_fma_f32 v[98:99], v[82:83], v[82:83], v[98:99]
 v_pk_fma_f32 v[100:101], v[84:85], v[84:85], v[100:101]
 v_pk_fma_f32 v[102:103], v[86:87], v[86:87], v[102:103]
 v_cvt_pk_bf16_f32 v136, v72, v73
 v_cvt_pk_bf16_f32 v137, v74, v75
 v_cvt_pk_bf16_f32 v138, v76, v77
 v_cvt_pk_bf16_f32 v139, v78, v79
 v_cvt_pk_bf16_f32 v140, v80, v81
 v_cvt_pk_bf16_f32 v141, v82, v83
 v_cvt_pk_bf16_f32 v142, v84, v85
 v_cvt_pk_bf16_f32 v143, v86, v87
 v_pk_fma_f32 v[72:73], v[24:25], v[24:25], s[50:51]
 v_pk_fma_f32 v[74:75], v[26:27], v[26:27], s[50:51]
 v_pk_fma_f32 v[76:77], v[28:29], v[28:29], s[50:51]
 v_pk_fma_f32 v[78:79], v[30:31], v[30:31], s[50:51]
 v_pk_fma_f32 v[80:81], v[32:33], v[32:33], s[50:51]
 v_pk_fma_f32 v[82:83], v[34:35], v[34:35], s[50:51]
 v_pk_fma_f32 v[84:85], v[36:37], v[36:37], s[50:51]
 v_pk_fma_f32 v[86:87], v[38:39], v[38:39], s[50:51]
 v_pk_mul_f32 v[72:73], v[72:73], v[24:25]
 v_pk_mul_f32 v[74:75], v[74:75], v[26:27]
 v_pk_mul_f32 v[76:77], v[76:77], v[28:29]
 v_pk_mul_f32 v[78:79], v[78:79], v[30:31]
 v_pk_mul_f32 v[80:81], v[80:81], v[32:33]
 v_pk_mul_f32 v[82:83], v[82:83], v[34:35]
 v_pk_mul_f32 v[84:85], v[84:85], v[36:37]
 v_pk_mul_f32 v[86:87], v[86:87], v[38:39]
 s_waitcnt vmcnt(0) lgkmcnt(0)
 v_max3_u32 v201, v204, v205, v206
 v_max3_u32 v201, v201, v207, v208
 v_max3_u32 v201, v201, v209, v210
 v_max3_u32 v201, v201, v211, v212
 v_max3_u32 v201, v201, v213, v214
 v_max_u32 v201, v201, v215
 v_cmp_eq_u32 vcc, -1, v201
 s_nop 4
 s_cmp_eq_u64 vcc, 0
 s_cbranch_scc1 L_ge_done2
 s_mov_b32 s84, 0
L_ge_loop:
 buffer_load_dwordx4 v[204:207], v5, s[24:27], s87 offen offset:0 sc1
 buffer_load_dwordx4 v[208:211], v5, s[24:27], s87 offen offset:1024 sc1
 buffer_load_dwordx4 v[212:215], v5, s[24:27], s87 offen offset:2048 sc1
 s_waitcnt vmcnt(0)
 v_max3_u32 v201, v204, v205, v206
 v_max3_u32 v201, v201, v207, v208
 v_max3_u32 v201, v201, v209, v210
 v_max3_u32 v201, v201, v211, v212
 v_max3_u32 v201, v201, v213, v214
 v_max_u32_e64 v201, v201, v215
 v_cmp_eq_u32 vcc, -1, v201
 s_nop 4
 s_cmp_eq_u64 vcc, 0
 s_cbranch_scc1 L_ge_done
 s_add_u32 s84, s84, 1
 s_cmp_lt_u32 s84, 0x40000
 s_cbranch_scc1 L_ge_loop
L_ge_done:
L_ge_done2:
 s_mul_i32 s7, s3, 3072
 s_add_u32 s7, s7, 61440
 v_add_u32_e64 v200, s7, v5
 ds_write_b128 v200, v[204:207] offset:0
 ds_write_b128 v200, v[208:211] offset:1024
 ds_write_b128 v200, v[212:215] offset:2048
 v_mfma_f32_32x32x16_bf16 v[40:55], a[152:155], a[200:203], 0
 ds_read_b128 a[228:231], v2 offset:31744
 v_add_f32_dpp v88, v88, v88 row_ror:8 row_mask:0xf bank_mask:0x3
 v_rcp_f32_e64 v56, v56
 v_add_f32_dpp v90, v90, v90 row_ror:8 row_mask:0xf bank_mask:0x3
 v_exp_f32_e64 v72, v72
 v_add_f32_dpp v92, v92, v92 row_ror:8 row_mask:0xf bank_mask:0x3
 v_add_f32_dpp v94, v94, v94 row_ror:8 row_mask:0xf bank_mask:0x3
 v_mfma_f32_32x32x16_bf16 v[40:55], a[156:159], a[204:207], v[40:55]
 ds_read_b128 a[200:203], v2 offset:32768
 s_mul_i32 s62, s61, 24576
 s_add_u32 s62, s62, s54
 s_add_u32 s63, s62, 4096
 s_add_u32 s55, s62, 8192
 v_add_f32_dpp v96, v96, v96 row_ror:8 row_mask:0xf bank_mask:0x3
 v_rcp_f32 v57, v57
 v_add_f32_dpp v98, v98, v98 row_ror:8 row_mask:0xf bank_mask:0x3
 v_exp_f32_e64 v73, v73
 v_add_f32_dpp v100, v100, v100 row_ror:8 row_mask:0xf bank_mask:0x3
 v_add_f32_dpp v102, v102, v102 row_ror:8 row_mask:0xf bank_mask:0x3
 v_mfma_f32_32x32x16_bf16 v[40:55], a[160:163], a[208:211], v[40:55]
 ds_read_b128 a[204:207], v2 offset:33792
 v_add_f32_dpp v88, v89, v89 row_ror:8 row_mask:0xf bank_mask:0xc
 v_rcp_f32_e64 v58, v58
 v_add_f32_dpp v90, v91, v91 row_ror:8 row_mask:0xf bank_mask:0xc
 v_exp_f32_e64 v74, v74
 v_add_f32_dpp v92, v93, v93 row_ror:8 row_mask:0xf bank_mask:0xc
 v_add_f32_dpp v94, v95, v95 row_ror:8 row_mask:0xf bank_mask:0xc
 v_mfma_f32_32x32x16_bf16 v[40:55], a[164:167], a[212:215], v[40:55]
 ds_read_b128 a[208:211], v2 offset:34816
 buffer_load_dwordx4 a[232:235], v5, s[24:27], s62 offen offset:0 sc1
 v_add_f32_dpp v96, v97, v97 row_ror:8 row_mask:0xf bank_mask:0xc
 v_rcp_f32_e64 v59, v59
 v_add_f32_dpp v98, v99, v99 row_ror:8 row_mask:0xf bank_mask:0xc
 v_exp_f32_e64 v75, v75
 v_add_f32_dpp v100, v101, v101 row_ror:8 row_mask:0xf bank_mask:0xc
 v_rcp_f32_e64 v60, v60
 v_add_f32_dpp v102, v103, v103 row_ror:8 row_mask:0xf bank_mask:0xc
 v_mfma_f32_32x32x16_bf16 v[40:55], a[168:171], a[216:219], v[40:55]
 ds_read_b128 a[212:215], v2 offset:35840
 v_add_f32_dpp v88, v88, v88 row_shl:4 row_mask:0xf bank_mask:0x5
 v_exp_f32_e64 v76, v76
 v_add_f32_dpp v92, v92, v92 row_shl:4 row_mask:0xf bank_mask:0x5
 v_rcp_f32_e64 v61, v61
 v_add_f32_dpp v96, v96, v96 row_shl:4 row_mask:0xf bank_mask:0x5
 v_add_f32_dpp v100, v100, v100 row_shl:4 row_mask:0xf bank_mask:0x5
 v_mfma_f32_32x32x16_bf16 v[40:55], a[172:175], a[220:223], v[40:55]
 ds_read_b128 a[216:219], v2 offset:36864
 v_add_f32_dpp v88, v90, v90 row_shr:4 row_mask:0xf bank_mask:0xa
 v_exp_f32_e64 v77, v77
 v_add_f32_dpp v92, v94, v94 row_shr:4 row_mask:0xf bank_mask:0xa
 v_rcp_f32 v62, v62
 v_add_f32_dpp v96, v98, v98 row_shr:4 row_mask:0xf bank_mask:0xa
 v_add_f32_dpp v100, v102, v102 row_shr:4 row_mask:0xf bank_mask:0xa
 s_waitcnt lgkmcnt(4)
 v_mfma_f32_32x32x16_bf16 v[40:55], a[176:179], a[224:227], v[40:55]
 ds_read_b128 a[220:223], v2 offset:37888
 s_lshl_b32 s6, s59, 8
 v_exp_f32 v78, v78
 v_add_u32_e64 v7, s6, v6
 v_rcp_f32 v63, v63
 v_permlane16_swap_b32 v88, v92
 v_mfma_f32_32x32x16_bf16 v[40:55], a[180:183], a[228:231], v[40:55]
 ds_read_b128 a[224:227], v2 offset:38912
 v_permlane16_swap_b32 v96, v100
 v_exp_f32 v79, v79
 v_add_f32 v88, v88, v92
 v_rcp_f32 v64, v64
 v_add_f32 v96, v96, v100
 v_exp_f32 v80, v80
 v_mfma_f32_32x32x16_bf16 v[40:55], a[184:187], a[200:203], v[40:55]
 ds_read_b128 a[228:231], v2 offset:39936
 buffer_load_dwordx4 a[236:239], v5, s[24:27], s62 offen offset:1024 sc1
 v_add_f32_dpp v88, v88, v88 quad_perm:[2,3,0,1] row_mask:0xf bank_mask:0xf
 v_rcp_f32_e64 v65, v65
 v_add_f32_dpp v96, v96, v96 quad_perm:[2,3,0,1] row_mask:0xf bank_mask:0xf
 v_exp_f32 v81, v81
 s_waitcnt lgkmcnt(4)
 v_mfma_f32_32x32x16_bf16 v[40:55], a[188:191], a[204:207], v[40:55]
 ds_read_b128 a[200:203], v2 offset:40960
 v_cndmask_b32 v88, v88, v96, s[52:53]
 v_rcp_f32 v66, v66
 s_nop 0
 v_add_f32_dpp v89, v88, v88 quad_perm:[1,0,3,2] row_mask:0xf bank_mask:0xf
 v_exp_f32_e64 v82, v82
 v_mfma_f32_32x32x16_bf16 v[40:55], a[192:195], a[208:211], v[40:55]
 ds_read_b128 a[204:207], v2 offset:41984
 ds_write_b32 v7, v89
 v_rcp_f32 v67, v67
 v_exp_f32 v83, v83
 v_mfma_f32_32x32x16_bf16 v[40:55], a[196:199], a[212:215], v[40:55]
 ds_read_b128 a[208:211], v2 offset:43008
 v_rcp_f32 v68, v68
 v_exp_f32 v84, v84
 v_rcp_f32 v69, v69
 v_exp_f32 v85, v85
 v_rcp_f32 v70, v70
 v_exp_f32 v86, v86
 v_rcp_f32 v71, v71
 v_exp_f32 v87, v87
 v_pk_mul_f32 v[56:57], v[8:9], v[56:57]
 v_pk_mul_f32 v[58:59], v[10:11], v[58:59]
 v_pk_mul_f32 v[60:61], v[12:13], v[60:61]
 v_pk_mul_f32 v[62:63], v[14:15], v[62:63]
 v_pk_mul_f32 v[64:65], v[16:17], v[64:65]
 v_pk_mul_f32 v[66:67], v[18:19], v[66:67]
 v_pk_mul_f32 v[68:69], v[20:21], v[68:69]
 v_pk_mul_f32 v[70:71], v[22:23], v[70:71]
 v_pk_add_f32 v[72:73], v[72:73], 1.0
 v_pk_add_f32 v[74:75], v[74:75], 1.0
 v_pk_add_f32 v[76:77], v[76:77], 1.0
 v_pk_add_f32 v[78:79], v[78:79], 1.0
 v_pk_add_f32 v[80:81], v[80:81], 1.0
 v_pk_add_f32 v[82:83], v[82:83], 1.0
 v_pk_add_f32 v[84:85], v[84:85], 1.0
 v_pk_add_f32 v[86:87], v[86:87], 1.0
 v_pk_mul_f32 v[88:89], v[56:57], v[56:57]
 v_pk_mul_f32 v[90:91], v[58:59], v[58:59]
 v_pk_mul_f32 v[92:93], v[60:61], v[60:61]
 v_pk_mul_f32 v[94:95], v[62:63], v[62:63]
 v_pk_mul_f32 v[96:97], v[64:65], v[64:65]
 v_pk_mul_f32 v[98:99], v[66:67], v[66:67]
 v_pk_mul_f32 v[100:101], v[68:69], v[68:69]
 v_pk_mul_f32 v[102:103], v[70:71], v[70:71]
 v_cvt_pk_bf16_f32 v144, v56, v57
 v_cvt_pk_bf16_f32 v145, v58, v59
 v_cvt_pk_bf16_f32 v146, v60, v61
 v_cvt_pk_bf16_f32 v147, v62, v63
 v_cvt_pk_bf16_f32 v148, v64, v65
 v_cvt_pk_bf16_f32 v149, v66, v67
 v_cvt_pk_bf16_f32 v150, v68, v69
 v_cvt_pk_bf16_f32 v151, v70, v71
 v_pk_fma_f32 v[56:57], v[40:41], v[40:41], s[50:51]
 v_pk_fma_f32 v[58:59], v[42:43], v[42:43], s[50:51]
 v_pk_fma_f32 v[60:61], v[44:45], v[44:45], s[50:51]
 v_pk_fma_f32 v[62:63], v[46:47], v[46:47], s[50:51]
 v_pk_fma_f32 v[64:65], v[48:49], v[48:49], s[50:51]
 v_pk_fma_f32 v[66:67], v[50:51], v[50:51], s[50:51]
 v_pk_fma_f32 v[68:69], v[52:53], v[52:53], s[50:51]
 v_pk_fma_f32 v[70:71], v[54:55], v[54:55], s[50:51]
 v_pk_mul_f32 v[56:57], v[56:57], v[40:41]
 v_pk_mul_f32 v[58:59], v[58:59], v[42:43]
 v_pk_mul_f32 v[60:61], v[60:61], v[44:45]
 v_pk_mul_f32 v[62:63], v[62:63], v[46:47]
 v_pk_mul_f32 v[64:65], v[64:65], v[48:49]
 v_pk_mul_f32 v[66:67], v[66:67], v[50:51]
 v_pk_mul_f32 v[68:69], v[68:69], v[52:53]
 v_pk_mul_f32 v[70:71], v[70:71], v[54:55]
 s_waitcnt lgkmcnt(5)
 v_mfma_f32_32x32x16_bf16 v[8:23], a[152:155], a[216:219], 0
 ds_read_b128 a[212:215], v2 offset:44032
 v_rcp_f32 v72, v72
 v_exp_f32_e64 v56, v56
 v_mfma_f32_32x32x16_bf16 v[8:23], a[156:159], a[220:223], v[8:23]
 ds_read_b128 a[216:219], v2 offset:45056
 v_rcp_f32 v73, v73
 v_exp_f32 v57, v57
 v_mfma_f32_32x32x16_bf16 v[8:23], a[160:163], a[224:227], v[8:23]
 ds_read_b128 a[220:223], v2 offset:46080
 v_rcp_f32_e64 v74, v74
 v_exp_f32 v58, v58
 s_waitcnt lgkmcnt(5)
 v_mfma_f32_32x32x16_bf16 v[8:23], a[164:167], a[228:231], v[8:23]
 ds_read_b128 a[224:227], v2 offset:47104
 buffer_load_dwordx4 a[240:243], v5, s[24:27], s62 offen offset:2048 sc1
 v_rcp_f32 v75, v75
 v_exp_f32 v59, v59
 v_rcp_f32_e64 v76, v76
 v_mfma_f32_32x32x16_bf16 v[8:23], a[168:171], a[200:203], v[8:23]
 ds_read_b128 a[228:231], v2 offset:48128
 v_exp_f32 v60, v60
 v_rcp_f32 v77, v77
 v_mfma_f32_32x32x16_bf16 v[8:23], a[172:175], a[204:207], v[8:23]
 ds_read_b128 a[200:203], v2 offset:49152
 v_exp_f32_e64 v61, v61
 v_rcp_f32 v78, v78
 s_waitcnt lgkmcnt(4)
 v_mfma_f32_32x32x16_bf16 v[8:23], a[176:179], a[208:211], v[8:23]
 ds_read_b128 a[204:207], v2 offset:50176
 v_exp_f32 v62, v62
 v_rcp_f32 v79, v79
 v_mfma_f32_32x32x16_bf16 v[8:23], a[180:183], a[212:215], v[8:23]
 ds_read_b128 a[208:211], v2 offset:51200
 v_exp_f32 v63, v63
 v_rcp_f32 v80, v80
 v_exp_f32_e64 v64, v64
 v_mfma_f32_32x32x16_bf16 v[8:23], a[184:187], a[216:219], v[8:23]
 ds_read_b128 a[212:215], v2 offset:52224
 buffer_load_dwordx4 a[244:247], v5, s[24:27], s62 offen offset:3072 sc1
 v_rcp_f32_e64 v81, v81
 v_exp_f32 v65, v65
 s_waitcnt lgkmcnt(4)
 v_mfma_f32_32x32x16_bf16 v[8:23], a[188:191], a[220:223], v[8:23]
 ds_read_b128 a[216:219], v2 offset:53248
 v_rcp_f32 v82, v82
 v_exp_f32 v66, v66
 v_mfma_f32_32x32x16_bf16 v[8:23], a[192:195], a[224:227], v[8:23]
 ds_read_b128 a[220:223], v2 offset:54272
 v_rcp_f32 v83, v83
 v_exp_f32 v67, v67
 v_mfma_f32_32x32x16_bf16 v[8:23], a[196:199], a[228:231], v[8:23]
 ds_read_b128 a[224:227], v2 offset:55296
 v_rcp_f32 v84, v84
 v_exp_f32 v68, v68
 v_rcp_f32 v85, v85
 v_exp_f32 v69, v69
 v_rcp_f32 v86, v86
 v_exp_f32 v70, v70
 v_rcp_f32 v87, v87
 v_exp_f32 v71, v71
 v_pk_mul_f32 v[72:73], v[24:25], v[72:73]
 v_pk_mul_f32 v[74:75], v[26:27], v[74:75]
 v_pk_mul_f32 v[76:77], v[28:29], v[76:77]
 v_pk_mul_f32 v[78:79], v[30:31], v[78:79]
 v_pk_mul_f32 v[80:81], v[32:33], v[80:81]
 v_pk_mul_f32 v[82:83], v[34:35], v[82:83]
 v_pk_mul_f32 v[84:85], v[36:37], v[84:85]
 v_pk_mul_f32 v[86:87], v[38:39], v[86:87]
 v_pk_add_f32 v[56:57], v[56:57], 1.0
 v_pk_add_f32 v[58:59], v[58:59], 1.0
 v_pk_add_f32 v[60:61], v[60:61], 1.0
 v_pk_add_f32 v[62:63], v[62:63], 1.0
 v_pk_add_f32 v[64:65], v[64:65], 1.0
 v_pk_add_f32 v[66:67], v[66:67], 1.0
 v_pk_add_f32 v[68:69], v[68:69], 1.0
 v_pk_add_f32 v[70:71], v[70:71], 1.0
 v_pk_fma_f32 v[88:89], v[72:73], v[72:73], v[88:89]
 v_pk_fma_f32 v[90:91], v[74:75], v[74:75], v[90:91]
 v_pk_fma_f32 v[92:93], v[76:77], v[76:77], v[92:93]
 v_pk_fma_f32 v[94:95], v[78:79], v[78:79], v[94:95]
 v_pk_fma_f32 v[96:97], v[80:81], v[80:81], v[96:97]
 v_pk_fma_f32 v[98:99], v[82:83], v[82:83], v[98:99]
 v_pk_fma_f32 v[100:101], v[84:85], v[84:85], v[100:101]
 v_pk_fma_f32 v[102:103], v[86:87], v[86:87], v[102:103]
 v_cvt_pk_bf16_f32 v152, v72, v73
 v_cvt_pk_bf16_f32 v153, v74, v75
 v_cvt_pk_bf16_f32 v154, v76, v77
 v_cvt_pk_bf16_f32 v155, v78, v79
 v_cvt_pk_bf16_f32 v156, v80, v81
 v_cvt_pk_bf16_f32 v157, v82, v83
 v_cvt_pk_bf16_f32 v158, v84, v85
 v_cvt_pk_bf16_f32 v159, v86, v87
 v_pk_fma_f32 v[72:73], v[8:9], v[8:9], s[50:51]
 v_pk_fma_f32 v[74:75], v[10:11], v[10:11], s[50:51]
 v_pk_fma_f32 v[76:77], v[12:13], v[12:13], s[50:51]
 v_pk_fma_f32 v[78:79], v[14:15], v[14:15], s[50:51]
 v_pk_fma_f32 v[80:81], v[16:17], v[16:17], s[50:51]
 v_pk_fma_f32 v[82:83], v[18:19], v[18:19], s[50:51]
 v_pk_fma_f32 v[84:85], v[20:21], v[20:21], s[50:51]
 v_pk_fma_f32 v[86:87], v[22:23], v[22:23], s[50:51]
 v_pk_mul_f32 v[72:73], v[72:73], v[8:9]
 v_pk_mul_f32 v[74:75], v[74:75], v[10:11]
 v_pk_mul_f32 v[76:77], v[76:77], v[12:13]
 v_pk_mul_f32 v[78:79], v[78:79], v[14:15]
 v_pk_mul_f32 v[80:81], v[80:81], v[16:17]
 v_pk_mul_f32 v[82:83], v[82:83], v[18:19]
 v_pk_mul_f32 v[84:85], v[84:85], v[20:21]
 v_pk_mul_f32 v[86:87], v[86:87], v[22:23]
 s_waitcnt lgkmcnt(4)
 v_mfma_f32_32x32x16_bf16 v[24:39], a[152:155], a[200:203], 0
 ds_read_b128 a[228:231], v2 offset:56320
 v_rcp_f32 v56, v56
 v_exp_f32_e64 v72, v72
 v_mfma_f32_32x32x16_bf16 v[24:39], a[156:159], a[204:207], v[24:39]
 ds_read_b128 a[200:203], v2 offset:57344
 v_rcp_f32 v57, v57
 v_exp_f32 v73, v73
 v_mfma_f32_32x32x16_bf16 v[24:39], a[160:163], a[208:211], v[24:39]
 ds_read_b128 a[204:207], v2 offset:58368
 v_rcp_f32_e64 v58, v58
 v_exp_f32 v74, v74
 s_waitcnt lgkmcnt(4)
 v_mfma_f32_32x32x16_bf16 v[24:39], a[164:167], a[212:215], v[24:39]
 ds_read_b128 a[208:211], v2 offset:59392
 buffer_load_dwordx4 a[248:251], v5, s[24:27], s63 offen offset:0 sc1
 v_rcp_f32 v59, v59
 v_exp_f32 v75, v75
 v_rcp_f32_e64 v60, v60
 v_mfma_f32_32x32x16_bf16 v[24:39], a[168:171], a[216:219], v[24:39]
 ds_read_b128 a[212:215], v2 offset:60416
 v_exp_f32 v76, v76
 v_rcp_f32 v61, v61
 v_mfma_f32_32x32x16_bf16 v[24:39], a[172:175], a[220:223], v[24:39]
 ds_read_b128 a[216:219], v3 offset:36864
 v_exp_f32_e64 v77, v77
 v_rcp_f32 v62, v62
 s_waitcnt lgkmcnt(4)
 v_mfma_f32_32x32x16_bf16 v[24:39], a[176:179], a[224:227], v[24:39]
 ds_read_b128 a[220:223], v3 offset:37888
 v_exp_f32 v78, v78
 v_rcp_f32 v63, v63
 v_mfma_f32_32x32x16_bf16 v[24:39], a[180:183], a[228:231], v[24:39]
 ds_read_b128 a[224:227], v3 offset:38912
 v_exp_f32 v79, v79
 v_rcp_f32 v64, v64
 v_exp_f32_e64 v80, v80
 v_mfma_f32_32x32x16_bf16 v[24:39], a[184:187], a[200:203], v[24:39]
 ds_read_b128 a[228:231], v3 offset:39936
 buffer_load_dwordx4 a[252:255], v5, s[24:27], s63 offen offset:1024 sc1
 v_rcp_f32_e64 v65, v65
 v_exp_f32 v81, v81
 s_waitcnt lgkmcnt(4)
 v_mfma_f32_32x32x16_bf16 v[24:39], a[188:191], a[204:207], v[24:39]
 ds_read_b128 a[200:203], v3 offset:40960
 v_rcp_f32 v66, v66
 v_exp_f32 v82, v82
 v_mfma_f32_32x32x16_bf16 v[24:39], a[192:195], a[208:211], v[24:39]
 ds_read_b128 a[204:207], v3 offset:41984
 v_rcp_f32 v67, v67
 v_exp_f32 v83, v83
 v_mfma_f32_32x32x16_bf16 v[24:39], a[196:199], a[212:215], v[24:39]
 ds_read_b128 a[208:211], v3 offset:43008
 v_rcp_f32 v68, v68
 v_exp_f32 v84, v84
 v_rcp_f32 v69, v69
 v_exp_f32 v85, v85
 v_rcp_f32 v70, v70
 v_exp_f32 v86, v86
 v_rcp_f32 v71, v71
 v_exp_f32 v87, v87
 v_pk_mul_f32 v[56:57], v[40:41], v[56:57]
 v_pk_mul_f32 v[58:59], v[42:43], v[58:59]
 v_pk_mul_f32 v[60:61], v[44:45], v[60:61]
 v_pk_mul_f32 v[62:63], v[46:47], v[62:63]
 v_pk_mul_f32 v[64:65], v[48:49], v[64:65]
 v_pk_mul_f32 v[66:67], v[50:51], v[66:67]
 v_pk_mul_f32 v[68:69], v[52:53], v[68:69]
 v_pk_mul_f32 v[70:71], v[54:55], v[70:71]
 v_pk_add_f32 v[72:73], v[72:73], 1.0
 v_pk_add_f32 v[74:75], v[74:75], 1.0
 v_pk_add_f32 v[76:77], v[76:77], 1.0
 v_pk_add_f32 v[78:79], v[78:79], 1.0
 v_pk_add_f32 v[80:81], v[80:81], 1.0
 v_pk_add_f32 v[82:83], v[82:83], 1.0
 v_pk_add_f32 v[84:85], v[84:85], 1.0
 v_pk_add_f32 v[86:87], v[86:87], 1.0
 v_pk_fma_f32 v[88:89], v[56:57], v[56:57], v[88:89]
 v_pk_fma_f32 v[90:91], v[58:59], v[58:59], v[90:91]
 v_pk_fma_f32 v[92:93], v[60:61], v[60:61], v[92:93]
 v_pk_fma_f32 v[94:95], v[62:63], v[62:63], v[94:95]
 v_pk_fma_f32 v[96:97], v[64:65], v[64:65], v[96:97]
 v_pk_fma_f32 v[98:99], v[66:67], v[66:67], v[98:99]
 v_pk_fma_f32 v[100:101], v[68:69], v[68:69], v[100:101]
 v_pk_fma_f32 v[102:103], v[70:71], v[70:71], v[102:103]
 v_cvt_pk_bf16_f32 v160, v56, v57
 v_cvt_pk_bf16_f32 v161, v58, v59
 v_cvt_pk_bf16_f32 v162, v60, v61
 v_cvt_pk_bf16_f32 v163, v62, v63
 v_cvt_pk_bf16_f32 v164, v64, v65
 v_cvt_pk_bf16_f32 v165, v66, v67
 v_cvt_pk_bf16_f32 v166, v68, v69
 v_cvt_pk_bf16_f32 v167, v70, v71
 v_pk_fma_f32 v[56:57], v[24:25], v[24:25], s[50:51]
 v_pk_fma_f32 v[58:59], v[26:27], v[26:27], s[50:51]
 v_pk_fma_f32 v[60:61], v[28:29], v[28:29], s[50:51]
 v_pk_fma_f32 v[62:63], v[30:31], v[30:31], s[50:51]
 v_pk_fma_f32 v[64:65], v[32:33], v[32:33], s[50:51]
 v_pk_fma_f32 v[66:67], v[34:35], v[34:35], s[50:51]
 v_pk_fma_f32 v[68:69], v[36:37], v[36:37], s[50:51]
 v_pk_fma_f32 v[70:71], v[38:39], v[38:39], s[50:51]
 v_pk_mul_f32 v[56:57], v[56:57], v[24:25]
 v_pk_mul_f32 v[58:59], v[58:59], v[26:27]
 v_pk_mul_f32 v[60:61], v[60:61], v[28:29]
 v_pk_mul_f32 v[62:63], v[62:63], v[30:31]
 v_pk_mul_f32 v[64:65], v[64:65], v[32:33]
 v_pk_mul_f32 v[66:67], v[66:67], v[34:35]
 v_pk_mul_f32 v[68:69], v[68:69], v[36:37]
 v_pk_mul_f32 v[70:71], v[70:71], v[38:39]
 s_waitcnt lgkmcnt(4)
 s_barrier
 v_mfma_f32_32x32x16_bf16 v[40:55], a[152:155], a[216:219], 0
 ds_read_b128 a[212:215], v3 offset:44032
 v_rcp_f32 v72, v72
 v_exp_f32 v56, v56
 v_mfma_f32_32x32x16_bf16 v[40:55], a[156:159], a[220:223], v[40:55]
 ds_read_b128 a[216:219], v3 offset:45056
 v_rcp_f32 v73, v73
 v_exp_f32 v57, v57
 v_mfma_f32_32x32x16_bf16 v[40:55], a[160:163], a[224:227], v[40:55]
 ds_read_b128 a[220:223], v3 offset:46080
 v_rcp_f32_e64 v74, v74
 v_exp_f32 v58, v58
 s_waitcnt lgkmcnt(4)
 v_mfma_f32_32x32x16_bf16 v[40:55], a[164:167], a[228:231], v[40:55]
 ds_read_b128 a[224:227], v3 offset:47104
 v_rcp_f32 v75, v75
 v_exp_f32 v59, v59
 v_rcp_f32_e64 v76, v76
 v_mfma_f32_32x32x16_bf16 v[40:55], a[168:171], a[200:203], v[40:55]
 ds_read_b128 a[228:231], v3 offset:48128
 v_exp_f32 v60, v60
 v_rcp_f32 v77, v77
 v_mfma_f32_32x32x16_bf16 v[40:55], a[172:175], a[204:207], v[40:55]
 ds_read_b128 a[200:203], v3 offset:49152
 v_exp_f32_e64 v61, v61
 v_rcp_f32 v78, v78
 s_waitcnt lgkmcnt(4)
 v_mfma_f32_32x32x16_bf16 v[40:55], a[176:179], a[208:211], v[40:55]
 ds_read_b128 a[204:207], v3 offset:50176
 buffer_load_dwordx4 a[176:179], v5, s[24:27], s63 offen offset:2048 sc1
 v_exp_f32 v62, v62
 v_rcp_f32 v79, v79
 v_mfma_f32_32x32x16_bf16 v[40:55], a[180:183], a[212:215], v[40:55]
 ds_read_b128 a[208:211], v3 offset:51200
 buffer_load_dwordx4 a[180:183], v5, s[24:27], s63 offen offset:3072 sc1
 v_exp_f32 v63, v63
 v_rcp_f32 v80, v80
 v_exp_f32_e64 v64, v64
 v_mfma_f32_32x32x16_bf16 v[40:55], a[184:187], a[216:219], v[40:55]
 ds_read_b128 a[212:215], v3 offset:52224
 buffer_load_dwordx4 a[184:187], v5, s[24:27], s55 offen offset:0 sc1
 v_rcp_f32_e64 v81, v81
 v_exp_f32 v65, v65
 s_waitcnt lgkmcnt(4)
 v_mfma_f32_32x32x16_bf16 v[40:55], a[188:191], a[220:223], v[40:55]
 ds_read_b128 a[216:219], v3 offset:53248
 buffer_load_dwordx4 a[188:191], v5, s[24:27], s55 offen offset:1024 sc1
 v_rcp_f32 v82, v82
 v_exp_f32 v66, v66
 v_mfma_f32_32x32x16_bf16 v[40:55], a[192:195], a[224:227], v[40:55]
 ds_read_b128 a[220:223], v3 offset:54272
 buffer_load_dwordx4 a[192:195], v5, s[24:27], s55 offen offset:2048 sc1
 v_rcp_f32 v83, v83
 v_exp_f32 v67, v67
 v_mfma_f32_32x32x16_bf16 v[40:55], a[196:199], a[228:231], v[40:55]
 ds_read_b128 a[224:227], v3 offset:55296
 buffer_load_dwordx4 a[196:199], v5, s[24:27], s55 offen offset:3072 sc1
 v_rcp_f32 v84, v84
 v_exp_f32 v68, v68
 v_rcp_f32 v85, v85
 v_exp_f32 v69, v69
 v_rcp_f32 v86, v86
 v_exp_f32 v70, v70
 v_rcp_f32 v87, v87
 v_exp_f32 v71, v71
 v_pk_mul_f32 v[72:73], v[8:9], v[72:73]
 v_pk_mul_f32 v[74:75], v[10:11], v[74:75]
 v_pk_mul_f32 v[76:77], v[12:13], v[76:77]
 v_pk_mul_f32 v[78:79], v[14:15], v[78:79]
 v_pk_mul_f32 v[80:81], v[16:17], v[80:81]
 v_pk_mul_f32 v[82:83], v[18:19], v[82:83]
 v_pk_mul_f32 v[84:85], v[20:21], v[84:85]
 v_pk_mul_f32 v[86:87], v[22:23], v[86:87]
 v_pk_add_f32 v[56:57], v[56:57], 1.0
 v_pk_add_f32 v[58:59], v[58:59], 1.0
 v_pk_add_f32 v[60:61], v[60:61], 1.0
 v_pk_add_f32 v[62:63], v[62:63], 1.0
 v_pk_add_f32 v[64:65], v[64:65], 1.0
 v_pk_add_f32 v[66:67], v[66:67], 1.0
 v_pk_add_f32 v[68:69], v[68:69], 1.0
 v_pk_add_f32 v[70:71], v[70:71], 1.0
 v_pk_fma_f32 v[88:89], v[72:73], v[72:73], v[88:89]
 v_pk_fma_f32 v[90:91], v[74:75], v[74:75], v[90:91]
 v_pk_fma_f32 v[92:93], v[76:77], v[76:77], v[92:93]
 v_pk_fma_f32 v[94:95], v[78:79], v[78:79], v[94:95]
 v_pk_fma_f32 v[96:97], v[80:81], v[80:81], v[96:97]
 v_pk_fma_f32 v[98:99], v[82:83], v[82:83], v[98:99]
 v_pk_fma_f32 v[100:101], v[84:85], v[84:85], v[100:101]
 v_pk_fma_f32 v[102:103], v[86:87], v[86:87], v[102:103]
 v_cvt_pk_bf16_f32 v168, v72, v73
 v_cvt_pk_bf16_f32 v169, v74, v75
 v_cvt_pk_bf16_f32 v170, v76, v77
 v_cvt_pk_bf16_f32 v171, v78, v79
 v_cvt_pk_bf16_f32 v172, v80, v81
 v_cvt_pk_bf16_f32 v173, v82, v83
 v_cvt_pk_bf16_f32 v174, v84, v85
 v_cvt_pk_bf16_f32 v175, v86, v87
 v_pk_fma_f32 v[72:73], v[40:41], v[40:41], s[50:51]
 v_pk_fma_f32 v[74:75], v[42:43], v[42:43], s[50:51]
 v_pk_fma_f32 v[76:77], v[44:45], v[44:45], s[50:51]
 v_pk_fma_f32 v[78:79], v[46:47], v[46:47], s[50:51]
 v_pk_fma_f32 v[80:81], v[48:49], v[48:49], s[50:51]
 v_pk_fma_f32 v[82:83], v[50:51], v[50:51], s[50:51]
 v_pk_fma_f32 v[84:85], v[52:53], v[52:53], s[50:51]
 v_pk_fma_f32 v[86:87], v[54:55], v[54:55], s[50:51]
 v_pk_mul_f32 v[72:73], v[72:73], v[40:41]
 v_pk_mul_f32 v[74:75], v[74:75], v[42:43]
 v_pk_mul_f32 v[76:77], v[76:77], v[44:45]
 v_pk_mul_f32 v[78:79], v[78:79], v[46:47]
 v_pk_mul_f32 v[80:81], v[80:81], v[48:49]
 v_pk_mul_f32 v[82:83], v[82:83], v[50:51]
 v_pk_mul_f32 v[84:85], v[84:85], v[52:53]
 v_pk_mul_f32 v[86:87], v[86:87], v[54:55]
 s_cmp_ge_u32 s4, 6
 s_cbranch_scc1 L_noE
 s_waitcnt lgkmcnt(4)
 s_waitcnt vmcnt(9)
 v_mfma_f32_32x32x16_bf16 v[8:23], a[232:235], a[200:203], 0
 ds_read_b128 a[228:231], v3 offset:56320
 v_rcp_f32 v56, v56
 v_exp_f32 v72, v72
 v_mfma_f32_32x32x16_bf16 v[8:23], a[236:239], a[204:207], v[8:23]
 ds_read_b128 a[200:203], v3 offset:57344
 v_rcp_f32 v57, v57
 v_exp_f32 v73, v73
 v_mfma_f32_32x32x16_bf16 v[8:23], a[240:243], a[208:211], v[8:23]
 ds_read_b128 a[204:207], v3 offset:58368
 v_rcp_f32 v58, v58
 v_exp_f32 v74, v74
 s_waitcnt lgkmcnt(4)
 s_waitcnt vmcnt(6)
 v_mfma_f32_32x32x16_bf16 v[8:23], a[244:247], a[212:215], v[8:23]
 ds_read_b128 a[208:211], v3 offset:59392
 v_rcp_f32 v59, v59
 v_exp_f32 v75, v75
 v_rcp_f32_e64 v60, v60
 v_mfma_f32_32x32x16_bf16 v[8:23], a[248:251], a[216:219], v[8:23]
 ds_read_b128 a[212:215], v3 offset:60416
 v_exp_f32 v76, v76
 v_rcp_f32 v61, v61
 v_mfma_f32_32x32x16_bf16 v[8:23], a[252:255], a[220:223], v[8:23]
 ds_read_b128 a[216:219], v2 offset:0
 v_exp_f32 v77, v77
 v_rcp_f32 v62, v62
 s_waitcnt lgkmcnt(4)
 s_waitcnt vmcnt(3)
 v_mfma_f32_32x32x16_bf16 v[8:23], a[176:179], a[224:227], v[8:23]
 ds_read_b128 a[220:223], v2 offset:1024
 v_exp_f32 v78, v78
 v_rcp_f32 v63, v63
 v_mfma_f32_32x32x16_bf16 v[8:23], a[180:183], a[228:231], v[8:23]
 ds_read_b128 a[224:227], v2 offset:2048
 v_exp_f32 v79, v79
 v_rcp_f32 v64, v64
 v_exp_f32_e64 v80, v80
 v_mfma_f32_32x32x16_bf16 v[8:23], a[184:187], a[200:203], v[8:23]
 ds_read_b128 a[228:231], v2 offset:3072
 v_rcp_f32 v65, v65
 v_exp_f32 v81, v81
 s_waitcnt lgkmcnt(4)
 s_waitcnt vmcnt(0)
 v_mfma_f32_32x32x16_bf16 v[8:23], a[188:191], a[204:207], v[8:23]
 ds_read_b128 a[200:203], v2 offset:4096
 v_rcp_f32 v66, v66
 v_exp_f32 v82, v82
 v_mfma_f32_32x32x16_bf16 v[8:23], a[192:195], a[208:211], v[8:23]
 ds_read_b128 a[204:207], v2 offset:5120
 v_rcp_f32 v67, v67
 v_exp_f32 v83, v83
 v_mfma_f32_32x32x16_bf16 v[8:23], a[196:199], a[212:215], v[8:23]
 ds_read_b128 a[208:211], v2 offset:6144
 v_rcp_f32 v68, v68
 v_exp_f32 v84, v84
 v_rcp_f32 v69, v69
 v_exp_f32 v85, v85
 v_rcp_f32 v70, v70
 v_exp_f32 v86, v86
 v_rcp_f32 v71, v71
 v_exp_f32 v87, v87
 v_pk_mul_f32 v[56:57], v[24:25], v[56:57]
 v_pk_mul_f32 v[58:59], v[26:27], v[58:59]
 v_pk_mul_f32 v[60:61], v[28:29], v[60:61]
 v_pk_mul_f32 v[62:63], v[30:31], v[62:63]
 v_pk_mul_f32 v[64:65], v[32:33], v[64:65]
 v_pk_mul_f32 v[66:67], v[34:35], v[66:67]
 v_pk_mul_f32 v[68:69], v[36:37], v[68:69]
 v_pk_mul_f32 v[70:71], v[38:39], v[70:71]
 v_pk_add_f32 v[72:73], v[72:73], 1.0
 v_pk_add_f32 v[74:75], v[74:75], 1.0
 v_pk_add_f32 v[76:77], v[76:77], 1.0
 v_pk_add_f32 v[78:79], v[78:79], 1.0
 v_pk_add_f32 v[80:81], v[80:81], 1.0
 v_pk_add_f32 v[82:83], v[82:83], 1.0
 v_pk_add_f32 v[84:85], v[84:85], 1.0
 v_pk_add_f32 v[86:87], v[86:87], 1.0
 v_pk_fma_f32 v[88:89], v[56:57], v[56:57], v[88:89]
 v_pk_fma_f32 v[90:91], v[58:59], v[58:59], v[90:91]
 v_pk_fma_f32 v[92:93], v[60:61], v[60:61], v[92:93]
 v_pk_fma_f32 v[94:95], v[62:63], v[62:63], v[94:95]
 v_pk_fma_f32 v[96:97], v[64:65], v[64:65], v[96:97]
 v_pk_fma_f32 v[98:99], v[66:67], v[66:67], v[98:99]
 v_pk_fma_f32 v[100:101], v[68:69], v[68:69], v[100:101]
 v_pk_fma_f32 v[102:103], v[70:71], v[70:71], v[102:103]
 v_cvt_pk_bf16_f32 v176, v56, v57
 v_cvt_pk_bf16_f32 v177, v58, v59
 v_cvt_pk_bf16_f32 v178, v60, v61
 v_cvt_pk_bf16_f32 v179, v62, v63
 v_cvt_pk_bf16_f32 v180, v64, v65
 v_cvt_pk_bf16_f32 v181, v66, v67
 v_cvt_pk_bf16_f32 v182, v68, v69
 v_cvt_pk_bf16_f32 v183, v70, v71
 v_pk_fma_f32 v[56:57], v[8:9], v[8:9], s[50:51]
 v_pk_fma_f32 v[58:59], v[10:11], v[10:11], s[50:51]
 v_pk_fma_f32 v[60:61], v[12:13], v[12:13], s[50:51]
 v_pk_fma_f32 v[62:63], v[14:15], v[14:15], s[50:51]
 v_pk_fma_f32 v[64:65], v[16:17], v[16:17], s[50:51]
 v_pk_fma_f32 v[66:67], v[18:19], v[18:19], s[50:51]
 v_pk_fma_f32 v[68:69], v[20:21], v[20:21], s[50:51]
 v_pk_fma_f32 v[70:71], v[22:23], v[22:23], s[50:51]
 v_pk_mul_f32 v[56:57], v[56:57], v[8:9]
 v_pk_mul_f32 v[58:59], v[58:59], v[10:11]
 v_pk_mul_f32 v[60:61], v[60:61], v[12:13]
 v_pk_mul_f32 v[62:63], v[62:63], v[14:15]
 v_pk_mul_f32 v[64:65], v[64:65], v[16:17]
 v_pk_mul_f32 v[66:67], v[66:67], v[18:19]
 v_pk_mul_f32 v[68:69], v[68:69], v[20:21]
 v_pk_mul_f32 v[70:71], v[70:71], v[22:23]
 s_waitcnt lgkmcnt(4)
 v_mfma_f32_32x32x16_bf16 v[24:39], a[232:235], a[216:219], 0
 ds_read_b128 a[212:215], v2 offset:7168
 v_rcp_f32 v72, v72
 v_exp_f32_e64 v56, v56
 v_mfma_f32_32x32x16_bf16 v[24:39], a[236:239], a[220:223], v[24:39]
 ds_read_b128 a[216:219], v2 offset:8192
 v_rcp_f32 v73, v73
 v_exp_f32 v57, v57
 v_mfma_f32_32x32x16_bf16 v[24:39], a[240:243], a[224:227], v[24:39]
 ds_read_b128 a[220:223], v2 offset:9216
 v_rcp_f32_e64 v74, v74
 v_exp_f32 v58, v58
 s_waitcnt lgkmcnt(4)
 v_mfma_f32_32x32x16_bf16 v[24:39], a[244:247], a[228:231], v[24:39]
 ds_read_b128 a[224:227], v2 offset:10240
 v_rcp_f32 v75, v75
 v_exp_f32 v59, v59
 v_rcp_f32_e64 v76, v76
 v_mfma_f32_32x32x16_bf16 v[24:39], a[248:251], a[200:203], v[24:39]
 ds_read_b128 a[228:231], v2 offset:11264
 v_exp_f32 v60, v60
 v_rcp_f32 v77, v77
 v_mfma_f32_32x32x16_bf16 v[24:39], a[252:255], a[204:207], v[24:39]
 ds_read_b128 a[200:203], v2 offset:12288
 v_exp_f32_e64 v61, v61
 v_rcp_f32 v78, v78
 s_waitcnt lgkmcnt(4)
 v_mfma_f32_32x32x16_bf16 v[24:39], a[176:179], a[208:211], v[24:39]
 ds_read_b128 a[204:207], v2 offset:13312
 v_exp_f32 v62, v62
 v_rcp_f32 v79, v79
 v_mfma_f32_32x32x16_bf16 v[24:39], a[180:183], a[212:215], v[24:39]
 ds_read_b128 a[208:211], v2 offset:14336
 v_exp_f32 v63, v63
 v_rcp_f32 v80, v80
 v_exp_f32_e64 v64, v64
 v_mfma_f32_32x32x16_bf16 v[24:39], a[184:187], a[216:219], v[24:39]
 ds_read_b128 a[212:215], v2 offset:15360
 v_rcp_f32_e64 v81, v81
 v_exp_f32 v65, v65
 s_waitcnt lgkmcnt(4)
 v_mfma_f32_32x32x16_bf16 v[24:39], a[188:191], a[220:223], v[24:39]
 ds_read_b128 a[216:219], v2 offset:16384
 v_rcp_f32 v82, v82
 v_exp_f32 v66, v66
 v_mfma_f32_32x32x16_bf16 v[24:39], a[192:195], a[224:227], v[24:39]
 ds_read_b128 a[220:223], v2 offset:17408
 v_rcp_f32 v83, v83
 v_exp_f32 v67, v67
 v_mfma_f32_32x32x16_bf16 v[24:39], a[196:199], a[228:231], v[24:39]
 ds_read_b128 a[224:227], v2 offset:18432
 v_rcp_f32 v84, v84
 v_exp_f32 v68, v68
 v_rcp_f32 v85, v85
 v_exp_f32 v69, v69
 v_rcp_f32 v86, v86
 v_exp_f32 v70, v70
 v_rcp_f32 v87, v87
 v_exp_f32 v71, v71
 v_pk_mul_f32 v[72:73], v[40:41], v[72:73]
 v_pk_mul_f32 v[74:75], v[42:43], v[74:75]
 v_pk_mul_f32 v[76:77], v[44:45], v[76:77]
 v_pk_mul_f32 v[78:79], v[46:47], v[78:79]
 v_pk_mul_f32 v[80:81], v[48:49], v[80:81]
 v_pk_mul_f32 v[82:83], v[50:51], v[82:83]
 v_pk_mul_f32 v[84:85], v[52:53], v[84:85]
 v_pk_mul_f32 v[86:87], v[54:55], v[86:87]
 v_pk_add_f32 v[56:57], v[56:57], 1.0
 v_pk_add_f32 v[58:59], v[58:59], 1.0
 v_pk_add_f32 v[60:61], v[60:61], 1.0
 v_pk_add_f32 v[62:63], v[62:63], 1.0
 v_pk_add_f32 v[64:65], v[64:65], 1.0
 v_pk_add_f32 v[66:67], v[66:67], 1.0
 v_pk_add_f32 v[68:69], v[68:69], 1.0
 v_pk_add_f32 v[70:71], v[70:71], 1.0
 v_pk_fma_f32 v[88:89], v[72:73], v[72:73], v[88:89]
 v_pk_fma_f32 v[90:91], v[74:75], v[74:75], v[90:91]
 v_pk_fma_f32 v[92:93], v[76:77], v[76:77], v[92:93]
 v_pk_fma_f32 v[94:95], v[78:79], v[78:79], v[94:95]
 v_pk_fma_f32 v[96:97], v[80:81], v[80:81], v[96:97]
 v_pk_fma_f32 v[98:99], v[82:83], v[82:83], v[98:99]
 v_pk_fma_f32 v[100:101], v[84:85], v[84:85], v[100:101]
 v_pk_fma_f32 v[102:103], v[86:87], v[86:87], v[102:103]
 v_cvt_pk_bf16_f32 v184, v72, v73
 v_cvt_pk_bf16_f32 v185, v74, v75
 v_cvt_pk_bf16_f32 v186, v76, v77
 v_cvt_pk_bf16_f32 v187, v78, v79
 v_cvt_pk_bf16_f32 v188, v80, v81
 v_cvt_pk_bf16_f32 v189, v82, v83
 v_cvt_pk_bf16_f32 v190, v84, v85
 v_cvt_pk_bf16_f32 v191, v86, v87
 v_pk_fma_f32 v[72:73], v[24:25], v[24:25], s[50:51]
 v_pk_fma_f32 v[74:75], v[26:27], v[26:27], s[50:51]
 v_pk_fma_f32 v[76:77], v[28:29], v[28:29], s[50:51]
 v_pk_fma_f32 v[78:79], v[30:31], v[30:31], s[50:51]
 v_pk_fma_f32 v[80:81], v[32:33], v[32:33], s[50:51]
 v_pk_fma_f32 v[82:83], v[34:35], v[34:35], s[50:51]
 v_pk_fma_f32 v[84:85], v[36:37], v[36:37], s[50:51]
 v_pk_fma_f32 v[86:87], v[38:39], v[38:39], s[50:51]
 v_pk_mul_f32 v[72:73], v[72:73], v[24:25]
 v_pk_mul_f32 v[74:75], v[74:75], v[26:27]
 v_pk_mul_f32 v[76:77], v[76:77], v[28:29]
 v_pk_mul_f32 v[78:79], v[78:79], v[30:31]
 v_pk_mul_f32 v[80:81], v[80:81], v[32:33]
 v_pk_mul_f32 v[82:83], v[82:83], v[34:35]
 v_pk_mul_f32 v[84:85], v[84:85], v[36:37]
 v_pk_mul_f32 v[86:87], v[86:87], v[38:39]
 s_waitcnt lgkmcnt(4)
 v_mfma_f32_32x32x16_bf16 v[40:55], a[232:235], a[200:203], 0
 ds_read_b128 a[228:231], v2 offset:19456
 v_add_f32_dpp v88, v88, v88 row_ror:8 row_mask:0xf bank_mask:0x3
 v_rcp_f32 v56, v56
 v_add_f32_dpp v90, v90, v90 row_ror:8 row_mask:0xf bank_mask:0x3
 v_exp_f32_e64 v72, v72
 v_add_f32_dpp v92, v92, v92 row_ror:8 row_mask:0xf bank_mask:0x3
 v_add_f32_dpp v94, v94, v94 row_ror:8 row_mask:0xf bank_mask:0x3
 v_mfma_f32_32x32x16_bf16 v[40:55], a[236:239], a[204:207], v[40:55]
 ds_read_b128 a[200:203], v2 offset:20480
 v_add_f32_dpp v96, v96, v96 row_ror:8 row_mask:0xf bank_mask:0x3
 v_rcp_f32_e64 v57, v57
 v_add_f32_dpp v98, v98, v98 row_ror:8 row_mask:0xf bank_mask:0x3
 v_exp_f32_e64 v73, v73
 v_add_f32_dpp v100, v100, v100 row_ror:8 row_mask:0xf bank_mask:0x3
 v_add_f32_dpp v102, v102, v102 row_ror:8 row_mask:0xf bank_mask:0x3
 v_mfma_f32_32x32x16_bf16 v[40:55], a[240:243], a[208:211], v[40:55]
 ds_read_b128 a[204:207], v2 offset:21504
 v_add_f32_dpp v88, v89, v89 row_ror:8 row_mask:0xf bank_mask:0xc
 v_rcp_f32_e64 v58, v58
 v_add_f32_dpp v90, v91, v91 row_ror:8 row_mask:0xf bank_mask:0xc
 v_exp_f32 v74, v74
 v_add_f32_dpp v92, v93, v93 row_ror:8 row_mask:0xf bank_mask:0xc
 v_add_f32_dpp v94, v95, v95 row_ror:8 row_mask:0xf bank_mask:0xc
 s_waitcnt lgkmcnt(4)
 v_mfma_f32_32x32x16_bf16 v[40:55], a[244:247], a[212:215], v[40:55]
 ds_read_b128 a[208:211], v2 offset:22528
 v_add_f32_dpp v96, v97, v97 row_ror:8 row_mask:0xf bank_mask:0xc
 v_rcp_f32_e64 v59, v59
 v_add_f32_dpp v98, v99, v99 row_ror:8 row_mask:0xf bank_mask:0xc
 v_exp_f32_e64 v75, v75
 v_add_f32_dpp v100, v101, v101 row_ror:8 row_mask:0xf bank_mask:0xc
 v_rcp_f32_e64 v60, v60
 v_add_f32_dpp v102, v103, v103 row_ror:8 row_mask:0xf bank_mask:0xc
 v_mfma_f32_32x32x16_bf16 v[40:55], a[248:251], a[216:219], v[40:55]
 ds_read_b128 a[212:215], v2 offset:23552
 v_add_f32_dpp v88, v88, v88 row_shl:4 row_mask:0xf bank_mask:0x5
 v_exp_f32_e64 v76, v76
 v_add_f32_dpp v92, v92, v92 row_shl:4 row_mask:0xf bank_mask:0x5
 v_rcp_f32_e64 v61, v61
 v_add_f32_dpp v96, v96, v96 row_shl:4 row_mask:0xf bank_mask:0x5
 v_add_f32_dpp v100, v100, v100 row_shl:4 row_mask:0xf bank_mask:0x5
 v_mfma_f32_32x32x16_bf16 v[40:55], a[252:255], a[220:223], v[40:55]
 ds_read_b128 a[216:219], v2 offset:24576
 v_add_f32_dpp v88, v90, v90 row_shr:4 row_mask:0xf bank_mask:0xa
 v_exp_f32_e64 v77, v77
 v_add_f32_dpp v92, v94, v94 row_shr:4 row_mask:0xf bank_mask:0xa
 v_rcp_f32 v62, v62
 v_add_f32_dpp v96, v98, v98 row_shr:4 row_mask:0xf bank_mask:0xa
 v_add_f32_dpp v100, v102, v102 row_shr:4 row_mask:0xf bank_mask:0xa
 s_waitcnt lgkmcnt(4)
 v_mfma_f32_32x32x16_bf16 v[40:55], a[176:179], a[224:227], v[40:55]
 ds_read_b128 a[220:223], v2 offset:25600
 s_lshl_b32 s6, s60, 8
 v_exp_f32 v78, v78
 v_add_u32_e64 v7, s6, v6
 v_rcp_f32 v63, v63
 v_permlane16_swap_b32 v88, v92
 v_mfma_f32_32x32x16_bf16 v[40:55], a[180:183], a[228:231], v[40:55]
 ds_read_b128 a[224:227], v2 offset:26624
 v_permlane16_swap_b32 v96, v100
 v_exp_f32 v79, v79
 v_add_f32 v88, v88, v92
 v_rcp_f32 v64, v64
 v_add_f32 v96, v96, v100
 v_exp_f32 v80, v80
 v_mfma_f32_32x32x16_bf16 v[40:55], a[184:187], a[200:203], v[40:55]
 ds_read_b128 a[228:231], v2 offset:27648
 v_add_f32_dpp v88, v88, v88 quad_perm:[2,3,0,1] row_mask:0xf bank_mask:0xf
 v_rcp_f32_e64 v65, v65
 v_add_f32_dpp v96, v96, v96 quad_perm:[2,3,0,1] row_mask:0xf bank_mask:0xf
 v_exp_f32 v81, v81
 s_waitcnt lgkmcnt(4)
 v_mfma_f32_32x32x16_bf16 v[40:55], a[188:191], a[204:207], v[40:55]
 ds_read_b128 a[200:203], v2 offset:28672
 v_cndmask_b32 v88, v88, v96, s[52:53]
 v_rcp_f32 v66, v66
 s_nop 0
 v_add_f32_dpp v89, v88, v88 quad_perm:[1,0,3,2] row_mask:0xf bank_mask:0xf
 v_exp_f32_e64 v82, v82
 v_mfma_f32_32x32x16_bf16 v[40:55], a[192:195], a[208:211], v[40:55]
 ds_read_b128 a[204:207], v2 offset:29696
 ds_write_b32 v7, v89
 v_rcp_f32 v67, v67
 v_exp_f32 v83, v83
 v_mfma_f32_32x32x16_bf16 v[40:55], a[196:199], a[212:215], v[40:55]
 ds_read_b128 a[208:211], v2 offset:30720
 v_rcp_f32 v68, v68
 v_exp_f32 v84, v84
 v_rcp_f32 v69, v69
 v_exp_f32 v85, v85
 v_rcp_f32 v70, v70
 v_exp_f32 v86, v86
 v_rcp_f32 v71, v71
 v_exp_f32 v87, v87
 v_pk_mul_f32 v[56:57], v[8:9], v[56:57]
 v_pk_mul_f32 v[58:59], v[10:11], v[58:59]
 v_pk_mul_f32 v[60:61], v[12:13], v[60:61]
 v_pk_mul_f32 v[62:63], v[14:15], v[62:63]
 v_pk_mul_f32 v[64:65], v[16:17], v[64:65]
 v_pk_mul_f32 v[66:67], v[18:19], v[66:67]
 v_pk_mul_f32 v[68:69], v[20:21], v[68:69]
 v_pk_mul_f32 v[70:71], v[22:23], v[70:71]
 v_pk_add_f32 v[72:73], v[72:73], 1.0
 v_pk_add_f32 v[74:75], v[74:75], 1.0
 v_pk_add_f32 v[76:77], v[76:77], 1.0
 v_pk_add_f32 v[78:79], v[78:79], 1.0
 v_pk_add_f32 v[80:81], v[80:81], 1.0
 v_pk_add_f32 v[82:83], v[82:83], 1.0
 v_pk_add_f32 v[84:85], v[84:85], 1.0
 v_pk_add_f32 v[86:87], v[86:87], 1.0
 v_pk_mul_f32 v[88:89], v[56:57], v[56:57]
 v_pk_mul_f32 v[90:91], v[58:59], v[58:59]
 v_pk_mul_f32 v[92:93], v[60:61], v[60:61]
 v_pk_mul_f32 v[94:95], v[62:63], v[62:63]
 v_pk_mul_f32 v[96:97], v[64:65], v[64:65]
 v_pk_mul_f32 v[98:99], v[66:67], v[66:67]
 v_pk_mul_f32 v[100:101], v[68:69], v[68:69]
 v_pk_mul_f32 v[102:103], v[70:71], v[70:71]
 v_cvt_pk_bf16_f32 v232, v56, v57
 v_cvt_pk_bf16_f32 v233, v58, v59
 v_cvt_pk_bf16_f32 v234, v60, v61
 v_cvt_pk_bf16_f32 v235, v62, v63
 v_cvt_pk_bf16_f32 v236, v64, v65
 v_cvt_pk_bf16_f32 v237, v66, v67
 v_cvt_pk_bf16_f32 v238, v68, v69
 v_cvt_pk_bf16_f32 v239, v70, v71
 s_mul_i32 s6, s5, 49152
 s_mul_i32 s7, s3, 12288
 s_add_u32 s6, s6, s7
 s_lshl_b32 s7, s4, 11
 s_add_u32 s6, s6, s7
 s_add_u32 s6, s6, 0x180000
 s_cmp_lt_u32 s4, 6
 s_cselect_b32 s6, s6, 0x40000000
 v_lshlrev_b32 v7, 4, v1
 buffer_store_dwordx4 v[232:235], v7, s[24:27], s6 offen offset:0 sc1
 buffer_store_dwordx4 v[236:239], v7, s[24:27], s6 offen offset:1024 sc1
 v_pk_fma_f32 v[56:57], v[40:41], v[40:41], s[50:51]
 v_pk_fma_f32 v[58:59], v[42:43], v[42:43], s[50:51]
 v_pk_fma_f32 v[60:61], v[44:45], v[44:45], s[50:51]
 v_pk_fma_f32 v[62:63], v[46:47], v[46:47], s[50:51]
 v_pk_fma_f32 v[64:65], v[48:49], v[48:49], s[50:51]
 v_pk_fma_f32 v[66:67], v[50:51], v[50:51], s[50:51]
 v_pk_fma_f32 v[68:69], v[52:53], v[52:53], s[50:51]
 v_pk_fma_f32 v[70:71], v[54:55], v[54:55], s[50:51]
 v_pk_mul_f32 v[56:57], v[56:57], v[40:41]
 v_pk_mul_f32 v[58:59], v[58:59], v[42:43]
 v_pk_mul_f32 v[60:61], v[60:61], v[44:45]
 v_pk_mul_f32 v[62:63], v[62:63], v[46:47]
 v_pk_mul_f32 v[64:65], v[64:65], v[48:49]
 v_pk_mul_f32 v[66:67], v[66:67], v[50:51]
 v_pk_mul_f32 v[68:69], v[68:69], v[52:53]
 v_pk_mul_f32 v[70:71], v[70:71], v[54:55]
 s_branch L_joinE
L_noE:
 s_waitcnt lgkmcnt(2)
 ds_read_b128 a[216:219], v2 offset:0
 s_waitcnt lgkmcnt(2)
 ds_read_b128 a[220:223], v2 offset:1024
 s_waitcnt lgkmcnt(2)
 ds_read_b128 a[224:227], v2 offset:2048
 ds_read_b128 a[228:231], v2 offset:3072
 ds_read_b128 a[200:203], v2 offset:4096
 ds_read_b128 a[204:207], v2 offset:5120
 ds_read_b128 a[208:211], v2 offset:6144
 v_rcp_f32 v56, v56
 v_exp_f32 v72, v72
 v_rcp_f32 v57, v57
 v_exp_f32 v73, v73
 v_rcp_f32 v58, v58
 v_exp_f32 v74, v74
 v_rcp_f32 v59, v59
 v_exp_f32 v75, v75
 v_rcp_f32 v60, v60
 v_exp_f32 v76, v76
 v_rcp_f32 v61, v61
 v_exp_f32 v77, v77
 v_rcp_f32 v62, v62
 v_exp_f32 v78, v78
 v_rcp_f32 v63, v63
 v_exp_f32 v79, v79
 v_rcp_f32 v64, v64
 v_exp_f32 v80, v80
 v_rcp_f32 v65, v65
 v_exp_f32 v81, v81
 v_rcp_f32 v66, v66
 v_exp_f32 v82, v82
 v_rcp_f32 v67, v67
 v_exp_f32 v83, v83
 v_rcp_f32 v68, v68
 v_exp_f32 v84, v84
 v_rcp_f32 v69, v69
 v_exp_f32 v85, v85
 v_rcp_f32 v70, v70
 v_exp_f32 v86, v86
 v_rcp_f32 v71, v71
 v_exp_f32 v87, v87
 v_pk_mul_f32 v[56:57], v[24:25], v[56:57]
 v_pk_mul_f32 v[58:59], v[26:27], v[58:59]
 v_pk_mul_f32 v[60:61], v[28:29], v[60:61]
 v_pk_mul_f32 v[62:63], v[30:31], v[62:63]
 v_pk_mul_f32 v[64:65], v[32:33], v[64:65]
 v_pk_mul_f32 v[66:67], v[34:35], v[66:67]
 v_pk_mul_f32 v[68:69], v[36:37], v[68:69]
 v_pk_mul_f32 v[70:71], v[38:39], v[70:71]
 v_pk_add_f32 v[72:73], v[72:73], 1.0
 v_pk_add_f32 v[74:75], v[74:75], 1.0
 v_pk_add_f32 v[76:77], v[76:77], 1.0
 v_pk_add_f32 v[78:79], v[78:79], 1.0
 v_pk_add_f32 v[80:81], v[80:81], 1.0
 v_pk_add_f32 v[82:83], v[82:83], 1.0
 v_pk_add_f32 v[84:85], v[84:85], 1.0
 v_pk_add_f32 v[86:87], v[86:87], 1.0
 v_pk_fma_f32 v[88:89], v[56:57], v[56:57], v[88:89]
 v_pk_fma_f32 v[90:91], v[58:59], v[58:59], v[90:91]
 v_pk_fma_f32 v[92:93], v[60:61], v[60:61], v[92:93]
 v_pk_fma_f32 v[94:95], v[62:63], v[62:63], v[94:95]
 v_pk_fma_f32 v[96:97], v[64:65], v[64:65], v[96:97]
 v_pk_fma_f32 v[98:99], v[66:67], v[66:67], v[98:99]
 v_pk_fma_f32 v[100:101], v[68:69], v[68:69], v[100:101]
 v_pk_fma_f32 v[102:103], v[70:71], v[70:71], v[102:103]
 v_cvt_pk_bf16_f32 v176, v56, v57
 v_cvt_pk_bf16_f32 v177, v58, v59
 v_cvt_pk_bf16_f32 v178, v60, v61
 v_cvt_pk_bf16_f32 v179, v62, v63
 v_cvt_pk_bf16_f32 v180, v64, v65
 v_cvt_pk_bf16_f32 v181, v66, v67
 v_cvt_pk_bf16_f32 v182, v68, v69
 v_cvt_pk_bf16_f32 v183, v70, v71
 s_waitcnt lgkmcnt(4)
 s_waitcnt vmcnt(11)
 v_mfma_f32_32x32x16_bf16 v[24:39], a[232:235], a[216:219], 0
 ds_read_b128 a[212:215], v2 offset:7168
 s_waitcnt vmcnt(10)
 v_mfma_f32_32x32x16_bf16 v[24:39], a[236:239], a[220:223], v[24:39]
 ds_read_b128 a[216:219], v2 offset:8192
 v_rcp_f32_e64 v72, v72
 s_waitcnt vmcnt(9)
 v_mfma_f32_32x32x16_bf16 v[24:39], a[240:243], a[224:227], v[24:39]
 ds_read_b128 a[220:223], v2 offset:9216
 v_rcp_f32_e64 v73, v73
 s_waitcnt lgkmcnt(4)
 s_waitcnt vmcnt(8)
 v_mfma_f32_32x32x16_bf16 v[24:39], a[244:247], a[228:231], v[24:39]
 ds_read_b128 a[224:227], v2 offset:10240
 v_rcp_f32 v74, v74
 s_waitcnt vmcnt(7)
 v_mfma_f32_32x32x16_bf16 v[24:39], a[248:251], a[200:203], v[24:39]
 ds_read_b128 a[228:231], v2 offset:11264
 v_rcp_f32 v75, v75
 s_waitcnt vmcnt(6)
 v_mfma_f32_32x32x16_bf16 v[24:39], a[252:255], a[204:207], v[24:39]
 ds_read_b128 a[200:203], v2 offset:12288
 v_rcp_f32_e64 v76, v76
 s_waitcnt lgkmcnt(4)
 s_waitcnt vmcnt(5)
 v_mfma_f32_32x32x16_bf16 v[24:39], a[176:179], a[208:211], v[24:39]
 ds_read_b128 a[204:207], v2 offset:13312
 v_rcp_f32 v77, v77
 s_waitcnt vmcnt(4)
 v_mfma_f32_32x32x16_bf16 v[24:39], a[180:183], a[212:215], v[24:39]
 ds_read_b128 a[208:211], v2 offset:14336
 v_rcp_f32 v78, v78
 s_waitcnt vmcnt(3)
 v_mfma_f32_32x32x16_bf16 v[24:39], a[184:187], a[216:219], v[24:39]
 ds_read_b128 a[212:215], v2 offset:15360
 v_rcp_f32_e64 v79, v79
 s_waitcnt lgkmcnt(4)
 s_waitcnt vmcnt(2)
 v_mfma_f32_32x32x16_bf16 v[24:39], a[188:191], a[220:223], v[24:39]
 ds_read_b128 a[216:219], v2 offset:16384
 v_rcp_f32 v80, v80
 s_waitcnt vmcnt(1)
 v_mfma_f32_32x32x16_bf16 v[24:39], a[192:195], a[224:227], v[24:39]
 ds_read_b128 a[220:223], v2 offset:17408
 v_rcp_f32 v81, v81
 s_waitcnt vmcnt(0)
 v_mfma_f32_32x32x16_bf16 v[24:39], a[196:199], a[228:231], v[24:39]
 ds_read_b128 a[224:227], v2 offset:18432
 v_rcp_f32 v82, v82
 v_rcp_f32 v83, v83
 v_rcp_f32 v84, v84
 v_rcp_f32 v85, v85
 v_rcp_f32 v86, v86
 v_rcp_f32 v87, v87
 v_pk_mul_f32 v[72:73], v[40:41], v[72:73]
 v_pk_mul_f32 v[74:75], v[42:43], v[74:75]
 v_pk_mul_f32 v[76:77], v[44:45], v[76:77]
 v_pk_mul_f32 v[78:79], v[46:47], v[78:79]
 v_pk_mul_f32 v[80:81], v[48:49], v[80:81]
 v_pk_mul_f32 v[82:83], v[50:51], v[82:83]
 v_pk_mul_f32 v[84:85], v[52:53], v[84:85]
 v_pk_mul_f32 v[86:87], v[54:55], v[86:87]
 v_pk_fma_f32 v[88:89], v[72:73], v[72:73], v[88:89]
 v_pk_fma_f32 v[90:91], v[74:75], v[74:75], v[90:91]
 v_pk_fma_f32 v[92:93], v[76:77], v[76:77], v[92:93]
 v_pk_fma_f32 v[94:95], v[78:79], v[78:79], v[94:95]
 v_pk_fma_f32 v[96:97], v[80:81], v[80:81], v[96:97]
 v_pk_fma_f32 v[98:99], v[82:83], v[82:83], v[98:99]
 v_pk_fma_f32 v[100:101], v[84:85], v[84:85], v[100:101]
 v_pk_fma_f32 v[102:103], v[86:87], v[86:87], v[102:103]
 v_cvt_pk_bf16_f32 v184, v72, v73
 v_cvt_pk_bf16_f32 v185, v74, v75
 v_cvt_pk_bf16_f32 v186, v76, v77
 v_cvt_pk_bf16_f32 v187, v78, v79
 v_cvt_pk_bf16_f32 v188, v80, v81
 v_cvt_pk_bf16_f32 v189, v82, v83
 v_cvt_pk_bf16_f32 v190, v84, v85
 v_cvt_pk_bf16_f32 v191, v86, v87
 v_pk_fma_f32 v[72:73], v[24:25], v[24:25], s[50:51]
 v_pk_fma_f32 v[74:75], v[26:27], v[26:27], s[50:51]
 v_pk_fma_f32 v[76:77], v[28:29], v[28:29], s[50:51]
 v_pk_fma_f32 v[78:79], v[30:31], v[30:31], s[50:51]
 v_pk_fma_f32 v[80:81], v[32:33], v[32:33], s[50:51]
 v_pk_fma_f32 v[82:83], v[34:35], v[34:35], s[50:51]
 v_pk_fma_f32 v[84:85], v[36:37], v[36:37], s[50:51]
 v_pk_fma_f32 v[86:87], v[38:39], v[38:39], s[50:51]
 v_pk_mul_f32 v[72:73], v[72:73], v[24:25]
 v_pk_mul_f32 v[74:75], v[74:75], v[26:27]
 v_pk_mul_f32 v[76:77], v[76:77], v[28:29]
 v_pk_mul_f32 v[78:79], v[78:79], v[30:31]
 v_pk_mul_f32 v[80:81], v[80:81], v[32:33]
 v_pk_mul_f32 v[82:83], v[82:83], v[34:35]
 v_pk_mul_f32 v[84:85], v[84:85], v[36:37]
 v_pk_mul_f32 v[86:87], v[86:87], v[38:39]
 s_waitcnt lgkmcnt(4)
 v_mfma_f32_32x32x16_bf16 v[40:55], a[232:235], a[200:203], 0
 ds_read_b128 a[228:231], v2 offset:19456
 v_add_f32_dpp v88, v88, v88 row_ror:8 row_mask:0xf bank_mask:0x3
 v_add_f32_dpp v90, v90, v90 row_ror:8 row_mask:0xf bank_mask:0x3
 v_add_f32_dpp v92, v92, v92 row_ror:8 row_mask:0xf bank_mask:0x3
 v_add_f32_dpp v94, v94, v94 row_ror:8 row_mask:0xf bank_mask:0x3
 v_mfma_f32_32x32x16_bf16 v[40:55], a[236:239], a[204:207], v[40:55]
 ds_read_b128 a[200:203], v2 offset:20480
 v_add_f32_dpp v96, v96, v96 row_ror:8 row_mask:0xf bank_mask:0x3
 v_exp_f32 v72, v72
 v_add_f32_dpp v98, v98, v98 row_ror:8 row_mask:0xf bank_mask:0x3
 v_add_f32_dpp v100, v100, v100 row_ror:8 row_mask:0xf bank_mask:0x3
 v_add_f32_dpp v102, v102, v102 row_ror:8 row_mask:0xf bank_mask:0x3
 v_mfma_f32_32x32x16_bf16 v[40:55], a[240:243], a[208:211], v[40:55]
 ds_read_b128 a[204:207], v2 offset:21504
 v_add_f32_dpp v88, v89, v89 row_ror:8 row_mask:0xf bank_mask:0xc
 v_exp_f32 v73, v73
 v_add_f32_dpp v90, v91, v91 row_ror:8 row_mask:0xf bank_mask:0xc
 v_add_f32_dpp v92, v93, v93 row_ror:8 row_mask:0xf bank_mask:0xc
 v_add_f32_dpp v94, v95, v95 row_ror:8 row_mask:0xf bank_mask:0xc
 s_waitcnt lgkmcnt(4)
 v_mfma_f32_32x32x16_bf16 v[40:55], a[244:247], a[212:215], v[40:55]
 ds_read_b128 a[208:211], v2 offset:22528
 v_add_f32_dpp v96, v97, v97 row_ror:8 row_mask:0xf bank_mask:0xc
 v_exp_f32_e64 v74, v74
 v_add_f32_dpp v98, v99, v99 row_ror:8 row_mask:0xf bank_mask:0xc
 v_add_f32_dpp v100, v101, v101 row_ror:8 row_mask:0xf bank_mask:0xc
 v_add_f32_dpp v102, v103, v103 row_ror:8 row_mask:0xf bank_mask:0xc
 v_mfma_f32_32x32x16_bf16 v[40:55], a[248:251], a[216:219], v[40:55]
 ds_read_b128 a[212:215], v2 offset:23552
 v_add_f32_dpp v88, v88, v88 row_shl:4 row_mask:0xf bank_mask:0x5
 v_exp_f32_e64 v75, v75
 v_add_f32_dpp v92, v92, v92 row_shl:4 row_mask:0xf bank_mask:0x5
 v_add_f32_dpp v96, v96, v96 row_shl:4 row_mask:0xf bank_mask:0x5
 v_add_f32_dpp v100, v100, v100 row_shl:4 row_mask:0xf bank_mask:0x5
 v_mfma_f32_32x32x16_bf16 v[40:55], a[252:255], a[220:223], v[40:55]
 ds_read_b128 a[216:219], v2 offset:24576
 v_add_f32_dpp v88, v90, v90 row_shr:4 row_mask:0xf bank_mask:0xa
 v_exp_f32_e64 v76, v76
 v_add_f32_dpp v92, v94, v94 row_shr:4 row_mask:0xf bank_mask:0xa
 v_add_f32_dpp v96, v98, v98 row_shr:4 row_mask:0xf bank_mask:0xa
 v_add_f32_dpp v100, v102, v102 row_shr:4 row_mask:0xf bank_mask:0xa
 s_waitcnt lgkmcnt(4)
 v_mfma_f32_32x32x16_bf16 v[40:55], a[176:179], a[224:227], v[40:55]
 ds_read_b128 a[220:223], v2 offset:25600
 s_lshl_b32 s6, s60, 8
 v_exp_f32_e64 v77, v77
 v_add_u32 v7, s6, v6
 v_permlane16_swap_b32 v88, v92
 v_mfma_f32_32x32x16_bf16 v[40:55], a[180:183], a[228:231], v[40:55]
 ds_read_b128 a[224:227], v2 offset:26624
 v_permlane16_swap_b32 v96, v100
 v_exp_f32 v78, v78
 v_add_f32 v88, v88, v92
 v_add_f32 v96, v96, v100
 v_mfma_f32_32x32x16_bf16 v[40:55], a[184:187], a[200:203], v[40:55]
 ds_read_b128 a[228:231], v2 offset:27648
 v_add_f32_dpp v88, v88, v88 quad_perm:[2,3,0,1] row_mask:0xf bank_mask:0xf
 v_exp_f32 v79, v79
 v_add_f32_dpp v96, v96, v96 quad_perm:[2,3,0,1] row_mask:0xf bank_mask:0xf
 s_waitcnt lgkmcnt(4)
 v_mfma_f32_32x32x16_bf16 v[40:55], a[188:191], a[204:207], v[40:55]
 ds_read_b128 a[200:203], v2 offset:28672
 v_cndmask_b32 v88, v88, v96, s[52:53]
 v_exp_f32 v80, v80
 s_nop 0
 v_add_f32_dpp v89, v88, v88 quad_perm:[1,0,3,2] row_mask:0xf bank_mask:0xf
 v_mfma_f32_32x32x16_bf16 v[40:55], a[192:195], a[208:211], v[40:55]
 ds_read_b128 a[204:207], v2 offset:29696
 ds_write_b32 v7, v89
 v_exp_f32_e64 v81, v81
 v_mfma_f32_32x32x16_bf16 v[40:55], a[196:199], a[212:215], v[40:55]
 ds_read_b128 a[208:211], v2 offset:30720
 v_exp_f32 v82, v82
 v_exp_f32 v83, v83
 v_exp_f32 v84, v84
 v_exp_f32 v85, v85
 v_exp_f32 v86, v86
 v_exp_f32 v87, v87
 v_pk_add_f32 v[72:73], v[72:73], 1.0
 v_pk_add_f32 v[74:75], v[74:75], 1.0
 v_pk_add_f32 v[76:77], v[76:77], 1.0
 v_pk_add_f32 v[78:79], v[78:79], 1.0
 v_pk_add_f32 v[80:81], v[80:81], 1.0
 v_pk_add_f32 v[82:83], v[82:83], 1.0
 v_pk_add_f32 v[84:85], v[84:85], 1.0
 v_pk_add_f32 v[86:87], v[86:87], 1.0
 v_pk_add_f32 v[88:89], 0, 0
 v_pk_add_f32 v[90:91], 0, 0
 v_pk_add_f32 v[92:93], 0, 0
 v_pk_add_f32 v[94:95], 0, 0
 v_pk_add_f32 v[96:97], 0, 0
 v_pk_add_f32 v[98:99], 0, 0
 v_pk_add_f32 v[100:101], 0, 0
 v_pk_add_f32 v[102:103], 0, 0
 v_pk_fma_f32 v[56:57], v[40:41], v[40:41], s[50:51]
 v_pk_fma_f32 v[58:59], v[42:43], v[42:43], s[50:51]
 v_pk_fma_f32 v[60:61], v[44:45], v[44:45], s[50:51]
 v_pk_fma_f32 v[62:63], v[46:47], v[46:47], s[50:51]
 v_pk_fma_f32 v[64:65], v[48:49], v[48:49], s[50:51]
 v_pk_fma_f32 v[66:67], v[50:51], v[50:51], s[50:51]
 v_pk_fma_f32 v[68:69], v[52:53], v[52:53], s[50:51]
 v_pk_fma_f32 v[70:71], v[54:55], v[54:55], s[50:51]
 v_pk_mul_f32 v[56:57], v[56:57], v[40:41]
 v_pk_mul_f32 v[58:59], v[58:59], v[42:43]
 v_pk_mul_f32 v[60:61], v[60:61], v[44:45]
 v_pk_mul_f32 v[62:63], v[62:63], v[46:47]
 v_pk_mul_f32 v[64:65], v[64:65], v[48:49]
 v_pk_mul_f32 v[66:67], v[66:67], v[50:51]
 v_pk_mul_f32 v[68:69], v[68:69], v[52:53]
 v_pk_mul_f32 v[70:71], v[70:71], v[54:55]
L_joinE:
 s_waitcnt lgkmcnt(5)
 v_mfma_f32_32x32x16_bf16 v[8:23], a[232:235], a[216:219], 0
 ds_read_b128 a[212:215], v2 offset:31744
 v_rcp_f32 v72, v72
 v_exp_f32_e64 v56, v56
 v_mfma_f32_32x32x16_bf16 v[8:23], a[236:239], a[220:223], v[8:23]
 ds_read_b128 a[216:219], v2 offset:32768
 v_rcp_f32 v73, v73
 v_exp_f32 v57, v57
 v_mfma_f32_32x32x16_bf16 v[8:23], a[240:243], a[224:227], v[8:23]
 ds_read_b128 a[220:223], v2 offset:33792
 v_rcp_f32_e64 v74, v74
 v_exp_f32 v58, v58
 s_waitcnt lgkmcnt(5)
 v_mfma_f32_32x32x16_bf16 v[8:23], a[244:247], a[228:231], v[8:23]
 ds_read_b128 a[224:227], v2 offset:34816
 v_rcp_f32 v75, v75
 v_exp_f32 v59, v59
 v_rcp_f32_e64 v76, v76
 v_mfma_f32_32x32x16_bf16 v[8:23], a[248:251], a[200:203], v[8:23]
 ds_read_b128 a[228:231], v2 offset:35840
 v_exp_f32 v60, v60
 v_rcp_f32 v77, v77
 v_mfma_f32_32x32x16_bf16 v[8:23], a[252:255], a[204:207], v[8:23]
 ds_read_b128 a[200:203], v2 offset:36864
 v_exp_f32_e64 v61, v61
 v_rcp_f32 v78, v78
 s_waitcnt lgkmcnt(4)
 v_mfma_f32_32x32x16_bf16 v[8:23], a[176:179], a[208:211], v[8:23]
 ds_read_b128 a[204:207], v2 offset:37888
 v_exp_f32 v62, v62
 v_rcp_f32 v79, v79
 v_mfma_f32_32x32x16_bf16 v[8:23], a[180:183], a[212:215], v[8:23]
 ds_read_b128 a[208:211], v2 offset:38912
 v_exp_f32 v63, v63
 v_rcp_f32 v80, v80
 v_exp_f32_e64 v64, v64
 v_mfma_f32_32x32x16_bf16 v[8:23], a[184:187], a[216:219], v[8:23]
 ds_read_b128 a[212:215], v2 offset:39936
 v_rcp_f32_e64 v81, v81
 v_exp_f32 v65, v65
 s_waitcnt lgkmcnt(4)
 v_mfma_f32_32x32x16_bf16 v[8:23], a[188:191], a[220:223], v[8:23]
 ds_read_b128 a[216:219], v2 offset:40960
 v_rcp_f32 v82, v82
 v_exp_f32 v66, v66
 v_mfma_f32_32x32x16_bf16 v[8:23], a[192:195], a[224:227], v[8:23]
 ds_read_b128 a[220:223], v2 offset:41984
 v_rcp_f32 v83, v83
 v_exp_f32 v67, v67
 v_mfma_f32_32x32x16_bf16 v[8:23], a[196:199], a[228:231], v[8:23]
 ds_read_b128 a[224:227], v2 offset:43008
 v_rcp_f32 v84, v84
 v_exp_f32 v68, v68
 v_rcp_f32 v85, v85
 v_exp_f32 v69, v69
 v_rcp_f32 v86, v86
 v_exp_f32 v70, v70
 v_rcp_f32 v87, v87
 v_exp_f32 v71, v71
 v_pk_mul_f32 v[72:73], v[24:25], v[72:73]
 v_pk_mul_f32 v[74:75], v[26:27], v[74:75]
 v_pk_mul_f32 v[76:77], v[28:29], v[76:77]
 v_pk_mul_f32 v[78:79], v[30:31], v[78:79]
 v_pk_mul_f32 v[80:81], v[32:33], v[80:81]
 v_pk_mul_f32 v[82:83], v[34:35], v[82:83]
 v_pk_mul_f32 v[84:85], v[36:37], v[84:85]
 v_pk_mul_f32 v[86:87], v[38:39], v[86:87]
 v_pk_add_f32 v[56:57], v[56:57], 1.0
 v_pk_add_f32 v[58:59], v[58:59], 1.0
 v_pk_add_f32 v[60:61], v[60:61], 1.0
 v_pk_add_f32 v[62:63], v[62:63], 1.0
 v_pk_add_f32 v[64:65], v[64:65], 1.0
 v_pk_add_f32 v[66:67], v[66:67], 1.0
 v_pk_add_f32 v[68:69], v[68:69], 1.0
 v_pk_add_f32 v[70:71], v[70:71], 1.0
 v_pk_fma_f32 v[88:89], v[72:73], v[72:73], v[88:89]
 v_pk_fma_f32 v[90:91], v[74:75], v[74:75], v[90:91]
 v_pk_fma_f32 v[92:93], v[76:77], v[76:77], v[92:93]
 v_pk_fma_f32 v[94:95], v[78:79], v[78:79], v[94:95]
 v_pk_fma_f32 v[96:97], v[80:81], v[80:81], v[96:97]
 v_pk_fma_f32 v[98:99], v[82:83], v[82:83], v[98:99]
 v_pk_fma_f32 v[100:101], v[84:85], v[84:85], v[100:101]
 v_pk_fma_f32 v[102:103], v[86:87], v[86:87], v[102:103]
 v_cvt_pk_bf16_f32 v192, v72, v73
 v_cvt_pk_bf16_f32 v193, v74, v75
 v_cvt_pk_bf16_f32 v194, v76, v77
 v_cvt_pk_bf16_f32 v195, v78, v79
 v_cvt_pk_bf16_f32 v196, v80, v81
 v_cvt_pk_bf16_f32 v197, v82, v83
 v_cvt_pk_bf16_f32 v198, v84, v85
 v_cvt_pk_bf16_f32 v199, v86, v87
 v_pk_fma_f32 v[72:73], v[8:9], v[8:9], s[50:51]
 v_pk_fma_f32 v[74:75], v[10:11], v[10:11], s[50:51]
 v_pk_fma_f32 v[76:77], v[12:13], v[12:13], s[50:51]
 v_pk_fma_f32 v[78:79], v[14:15], v[14:15], s[50:51]
 v_pk_fma_f32 v[80:81], v[16:17], v[16:17], s[50:51]
 v_pk_fma_f32 v[82:83], v[18:19], v[18:19], s[50:51]
 v_pk_fma_f32 v[84:85], v[20:21], v[20:21], s[50:51]
 v_pk_fma_f32 v[86:87], v[22:23], v[22:23], s[50:51]
 v_pk_mul_f32 v[72:73], v[72:73], v[8:9]
 v_pk_mul_f32 v[74:75], v[74:75], v[10:11]
 v_pk_mul_f32 v[76:77], v[76:77], v[12:13]
 v_pk_mul_f32 v[78:79], v[78:79], v[14:15]
 v_pk_mul_f32 v[80:81], v[80:81], v[16:17]
 v_pk_mul_f32 v[82:83], v[82:83], v[18:19]
 v_pk_mul_f32 v[84:85], v[84:85], v[20:21]
 v_pk_mul_f32 v[86:87], v[86:87], v[22:23]
 s_waitcnt lgkmcnt(4)
 v_mfma_f32_32x32x16_bf16 v[24:39], a[232:235], a[200:203], 0
 ds_read_b128 a[228:231], v2 offset:44032
 v_rcp_f32 v56, v56
 v_exp_f32_e64 v72, v72
 v_mfma_f32_32x32x16_bf16 v[24:39], a[236:239], a[204:207], v[24:39]
 ds_read_b128 a[200:203], v2 offset:45056
 v_rcp_f32 v57, v57
 v_exp_f32 v73, v73
 v_mfma_f32_32x32x16_bf16 v[24:39], a[240:243], a[208:211], v[24:39]
 ds_read_b128 a[204:207], v2 offset:46080
 v_rcp_f32_e64 v58, v58
 v_exp_f32 v74, v74
 s_waitcnt lgkmcnt(4)
 v_mfma_f32_32x32x16_bf16 v[24:39], a[244:247], a[212:215], v[24:39]
 ds_read_b128 a[208:211], v2 offset:47104
 v_rcp_f32 v59, v59
 v_exp_f32 v75, v75
 v_rcp_f32_e64 v60, v60
 v_mfma_f32_32x32x16_bf16 v[24:39], a[248:251], a[216:219], v[24:39]
 ds_read_b128 a[212:215], v2 offset:48128
 v_exp_f32 v76, v76
 v_rcp_f32 v61, v61
 v_mfma_f32_32x32x16_bf16 v[24:39], a[252:255], a[220:223], v[24:39]
 ds_read_b128 a[216:219], v2 offset:49152
 v_exp_f32_e64 v77, v77
 v_rcp_f32 v62, v62
 s_waitcnt lgkmcnt(4)
 v_mfma_f32_32x32x16_bf16 v[24:39], a[176:179], a[224:227], v[24:39]
 ds_read_b128 a[220:223], v2 offset:50176
 v_exp_f32 v78, v78
 v_rcp_f32 v63, v63
 v_mfma_f32_32x32x16_bf16 v[24:39], a[180:183], a[228:231], v[24:39]
 ds_read_b128 a[224:227], v2 offset:51200
 v_exp_f32 v79, v79
 v_rcp_f32 v64, v64
 v_exp_f32_e64 v80, v80
 v_mfma_f32_32x32x16_bf16 v[24:39], a[184:187], a[200:203], v[24:39]
 ds_read_b128 a[228:231], v2 offset:52224
 v_rcp_f32_e64 v65, v65
 v_exp_f32 v81, v81
 s_waitcnt lgkmcnt(4)
 v_mfma_f32_32x32x16_bf16 v[24:39], a[188:191], a[204:207], v[24:39]
 ds_read_b128 a[200:203], v2 offset:53248
 v_rcp_f32 v66, v66
 v_exp_f32 v82, v82
 v_mfma_f32_32x32x16_bf16 v[24:39], a[192:195], a[208:211], v[24:39]
 ds_read_b128 a[204:207], v2 offset:54272
 v_rcp_f32 v67, v67
 v_exp_f32 v83, v83
 v_mfma_f32_32x32x16_bf16 v[24:39], a[196:199], a[212:215], v[24:39]
 ds_read_b128 a[208:211], v2 offset:55296
 v_rcp_f32 v68, v68
 v_exp_f32 v84, v84
 v_rcp_f32 v69, v69
 v_exp_f32 v85, v85
 v_rcp_f32 v70, v70
 v_exp_f32 v86, v86
 v_rcp_f32 v71, v71
 v_exp_f32 v87, v87
 v_pk_mul_f32 v[56:57], v[40:41], v[56:57]
 v_pk_mul_f32 v[58:59], v[42:43], v[58:59]
 v_pk_mul_f32 v[60:61], v[44:45], v[60:61]
 v_pk_mul_f32 v[62:63], v[46:47], v[62:63]
 v_pk_mul_f32 v[64:65], v[48:49], v[64:65]
 v_pk_mul_f32 v[66:67], v[50:51], v[66:67]
 v_pk_mul_f32 v[68:69], v[52:53], v[68:69]
 v_pk_mul_f32 v[70:71], v[54:55], v[70:71]
 v_pk_add_f32 v[72:73], v[72:73], 1.0
 v_pk_add_f32 v[74:75], v[74:75], 1.0
 v_pk_add_f32 v[76:77], v[76:77], 1.0
 v_pk_add_f32 v[78:79], v[78:79], 1.0
 v_pk_add_f32 v[80:81], v[80:81], 1.0
 v_pk_add_f32 v[82:83], v[82:83], 1.0
 v_pk_add_f32 v[84:85], v[84:85], 1.0
 v_pk_add_f32 v[86:87], v[86:87], 1.0
 v_pk_fma_f32 v[88:89], v[56:57], v[56:57], v[88:89]
 v_pk_fma_f32 v[90:91], v[58:59], v[58:59], v[90:91]
 v_pk_fma_f32 v[92:93], v[60:61], v[60:61], v[92:93]
 v_pk_fma_f32 v[94:95], v[62:63], v[62:63], v[94:95]
 v_pk_fma_f32 v[96:97], v[64:65], v[64:65], v[96:97]
 v_pk_fma_f32 v[98:99], v[66:67], v[66:67], v[98:99]
 v_pk_fma_f32 v[100:101], v[68:69], v[68:69], v[100:101]
 v_pk_fma_f32 v[102:103], v[70:71], v[70:71], v[102:103]
 v_cvt_pk_bf16_f32 v200, v56, v57
 v_cvt_pk_bf16_f32 v201, v58, v59
 v_cvt_pk_bf16_f32 v202, v60, v61
 v_cvt_pk_bf16_f32 v203, v62, v63
 v_cvt_pk_bf16_f32 v204, v64, v65
 v_cvt_pk_bf16_f32 v205, v66, v67
 v_cvt_pk_bf16_f32 v206, v68, v69
 v_cvt_pk_bf16_f32 v207, v70, v71
 v_pk_fma_f32 v[56:57], v[24:25], v[24:25], s[50:51]
 v_pk_fma_f32 v[58:59], v[26:27], v[26:27], s[50:51]
 v_pk_fma_f32 v[60:61], v[28:29], v[28:29], s[50:51]
 v_pk_fma_f32 v[62:63], v[30:31], v[30:31], s[50:51]
 v_pk_fma_f32 v[64:65], v[32:33], v[32:33], s[50:51]
 v_pk_fma_f32 v[66:67], v[34:35], v[34:35], s[50:51]
 v_pk_fma_f32 v[68:69], v[36:37], v[36:37], s[50:51]
 v_pk_fma_f32 v[70:71], v[38:39], v[38:39], s[50:51]
 v_pk_mul_f32 v[56:57], v[56:57], v[24:25]
 v_pk_mul_f32 v[58:59], v[58:59], v[26:27]
 v_pk_mul_f32 v[60:61], v[60:61], v[28:29]
 v_pk_mul_f32 v[62:63], v[62:63], v[30:31]
 v_pk_mul_f32 v[64:65], v[64:65], v[32:33]
 v_pk_mul_f32 v[66:67], v[66:67], v[34:35]
 v_pk_mul_f32 v[68:69], v[68:69], v[36:37]
 v_pk_mul_f32 v[70:71], v[70:71], v[38:39]
 s_waitcnt lgkmcnt(4)
 v_mfma_f32_32x32x16_bf16 v[40:55], a[232:235], a[216:219], 0
 ds_read_b128 a[212:215], v2 offset:56320
 v_rcp_f32 v72, v72
 v_exp_f32_e64 v56, v56
 v_mfma_f32_32x32x16_bf16 v[40:55], a[236:239], a[220:223], v[40:55]
 ds_read_b128 a[216:219], v2 offset:57344
 v_rcp_f32 v73, v73
 v_exp_f32 v57, v57
 v_mfma_f32_32x32x16_bf16 v[40:55], a[240:243], a[224:227], v[40:55]
 ds_read_b128 a[220:223], v2 offset:58368
 v_rcp_f32_e64 v74, v74
 v_exp_f32 v58, v58
 s_waitcnt lgkmcnt(4)
 v_mfma_f32_32x32x16_bf16 v[40:55], a[244:247], a[228:231], v[40:55]
 ds_read_b128 a[224:227], v2 offset:59392
 v_rcp_f32 v75, v75
 v_exp_f32 v59, v59
 v_rcp_f32_e64 v76, v76
 v_mfma_f32_32x32x16_bf16 v[40:55], a[248:251], a[200:203], v[40:55]
 ds_read_b128 a[228:231], v2 offset:60416
 v_exp_f32 v60, v60
 v_rcp_f32 v77, v77
 v_mfma_f32_32x32x16_bf16 v[40:55], a[252:255], a[204:207], v[40:55]
 ds_read_b128 a[200:203], v3 offset:36864
 v_exp_f32_e64 v61, v61
 v_rcp_f32 v78, v78
 s_waitcnt lgkmcnt(4)
 v_mfma_f32_32x32x16_bf16 v[40:55], a[176:179], a[208:211], v[40:55]
 ds_read_b128 a[204:207], v3 offset:37888
 v_exp_f32 v62, v62
 v_rcp_f32 v79, v79
 v_mfma_f32_32x32x16_bf16 v[40:55], a[180:183], a[212:215], v[40:55]
 ds_read_b128 a[208:211], v3 offset:38912
 v_exp_f32 v63, v63
 v_rcp_f32 v80, v80
 v_exp_f32_e64 v64, v64
 v_mfma_f32_32x32x16_bf16 v[40:55], a[184:187], a[216:219], v[40:55]
 ds_read_b128 a[212:215], v3 offset:39936
 v_rcp_f32_e64 v81, v81
 v_exp_f32 v65, v65
 s_waitcnt lgkmcnt(4)
 v_mfma_f32_32x32x16_bf16 v[40:55], a[188:191], a[220:223], v[40:55]
 ds_read_b128 a[216:219], v3 offset:40960
 v_rcp_f32 v82, v82
 v_exp_f32 v66, v66
 v_mfma_f32_32x32x16_bf16 v[40:55], a[192:195], a[224:227], v[40:55]
 ds_read_b128 a[220:223], v3 offset:41984
 v_rcp_f32 v83, v83
 v_exp_f32 v67, v67
 v_mfma_f32_32x32x16_bf16 v[40:55], a[196:199], a[228:231], v[40:55]
 ds_read_b128 a[224:227], v3 offset:43008
 v_rcp_f32 v84, v84
 v_exp_f32 v68, v68
 v_rcp_f32 v85, v85
 v_exp_f32 v69, v69
 v_rcp_f32 v86, v86
 v_exp_f32 v70, v70
 v_rcp_f32 v87, v87
 v_exp_f32 v71, v71
 v_pk_mul_f32 v[72:73], v[8:9], v[72:73]
 v_pk_mul_f32 v[74:75], v[10:11], v[74:75]
 v_pk_mul_f32 v[76:77], v[12:13], v[76:77]
 v_pk_mul_f32 v[78:79], v[14:15], v[78:79]
 v_pk_mul_f32 v[80:81], v[16:17], v[80:81]
 v_pk_mul_f32 v[82:83], v[18:19], v[82:83]
 v_pk_mul_f32 v[84:85], v[20:21], v[84:85]
 v_pk_mul_f32 v[86:87], v[22:23], v[86:87]
 v_pk_add_f32 v[56:57], v[56:57], 1.0
 v_pk_add_f32 v[58:59], v[58:59], 1.0
 v_pk_add_f32 v[60:61], v[60:61], 1.0
 v_pk_add_f32 v[62:63], v[62:63], 1.0
 v_pk_add_f32 v[64:65], v[64:65], 1.0
 v_pk_add_f32 v[66:67], v[66:67], 1.0
 v_pk_add_f32 v[68:69], v[68:69], 1.0
 v_pk_add_f32 v[70:71], v[70:71], 1.0
 v_pk_fma_f32 v[88:89], v[72:73], v[72:73], v[88:89]
 v_pk_fma_f32 v[90:91], v[74:75], v[74:75], v[90:91]
 v_pk_fma_f32 v[92:93], v[76:77], v[76:77], v[92:93]
 v_pk_fma_f32 v[94:95], v[78:79], v[78:79], v[94:95]
 v_pk_fma_f32 v[96:97], v[80:81], v[80:81], v[96:97]
 v_pk_fma_f32 v[98:99], v[82:83], v[82:83], v[98:99]
 v_pk_fma_f32 v[100:101], v[84:85], v[84:85], v[100:101]
 v_pk_fma_f32 v[102:103], v[86:87], v[86:87], v[102:103]
 v_cvt_pk_bf16_f32 v208, v72, v73
 v_cvt_pk_bf16_f32 v209, v74, v75
 v_cvt_pk_bf16_f32 v210, v76, v77
 v_cvt_pk_bf16_f32 v211, v78, v79
 v_cvt_pk_bf16_f32 v212, v80, v81
 v_cvt_pk_bf16_f32 v213, v82, v83
 v_cvt_pk_bf16_f32 v214, v84, v85
 v_cvt_pk_bf16_f32 v215, v86, v87
 v_pk_fma_f32 v[72:73], v[40:41], v[40:41], s[50:51]
 v_pk_fma_f32 v[74:75], v[42:43], v[42:43], s[50:51]
 v_pk_fma_f32 v[76:77], v[44:45], v[44:45], s[50:51]
 v_pk_fma_f32 v[78:79], v[46:47], v[46:47], s[50:51]
 v_pk_fma_f32 v[80:81], v[48:49], v[48:49], s[50:51]
 v_pk_fma_f32 v[82:83], v[50:51], v[50:51], s[50:51]
 v_pk_fma_f32 v[84:85], v[52:53], v[52:53], s[50:51]
 v_pk_fma_f32 v[86:87], v[54:55], v[54:55], s[50:51]
 v_pk_mul_f32 v[72:73], v[72:73], v[40:41]
 v_pk_mul_f32 v[74:75], v[74:75], v[42:43]
 v_pk_mul_f32 v[76:77], v[76:77], v[44:45]
 v_pk_mul_f32 v[78:79], v[78:79], v[46:47]
 v_pk_mul_f32 v[80:81], v[80:81], v[48:49]
 v_pk_mul_f32 v[82:83], v[82:83], v[50:51]
 v_pk_mul_f32 v[84:85], v[84:85], v[52:53]
 v_pk_mul_f32 v[86:87], v[86:87], v[54:55]
 s_waitcnt lgkmcnt(4)
 v_mfma_f32_32x32x16_bf16 v[8:23], a[232:235], a[200:203], 0
 ds_read_b128 a[228:231], v3 offset:44032
 v_rcp_f32 v56, v56
 v_exp_f32_e64 v72, v72
 v_mfma_f32_32x32x16_bf16 v[8:23], a[236:239], a[204:207], v[8:23]
 ds_read_b128 a[200:203], v3 offset:45056
 v_rcp_f32 v57, v57
 v_exp_f32 v73, v73
 v_mfma_f32_32x32x16_bf16 v[8:23], a[240:243], a[208:211], v[8:23]
 ds_read_b128 a[204:207], v3 offset:46080
 v_rcp_f32_e64 v58, v58
 v_exp_f32 v74, v74
 s_waitcnt lgkmcnt(4)
 v_mfma_f32_32x32x16_bf16 v[8:23], a[244:247], a[212:215], v[8:23]
 ds_read_b128 a[208:211], v3 offset:47104
 v_rcp_f32 v59, v59
 v_exp_f32 v75, v75
 v_rcp_f32_e64 v60, v60
 v_mfma_f32_32x32x16_bf16 v[8:23], a[248:251], a[216:219], v[8:23]
 ds_read_b128 a[212:215], v3 offset:48128
 v_exp_f32 v76, v76
 v_rcp_f32 v61, v61
 v_mfma_f32_32x32x16_bf16 v[8:23], a[252:255], a[220:223], v[8:23]
 v_exp_f32_e64 v77, v77
 v_rcp_f32 v62, v62
 s_waitcnt lgkmcnt(3)
 v_mfma_f32_32x32x16_bf16 v[8:23], a[176:179], a[224:227], v[8:23]
 v_exp_f32 v78, v78
 v_rcp_f32 v63, v63
 v_mfma_f32_32x32x16_bf16 v[8:23], a[180:183], a[228:231], v[8:23]
 v_exp_f32 v79, v79
 v_rcp_f32 v64, v64
 v_exp_f32_e64 v80, v80
 v_mfma_f32_32x32x16_bf16 v[8:23], a[184:187], a[200:203], v[8:23]
 v_rcp_f32_e64 v65, v65
 v_exp_f32 v81, v81
 s_waitcnt lgkmcnt(0)
 v_mfma_f32_32x32x16_bf16 v[8:23], a[188:191], a[204:207], v[8:23]
 v_rcp_f32 v66, v66
 v_exp_f32 v82, v82
 v_mfma_f32_32x32x16_bf16 v[8:23], a[192:195], a[208:211], v[8:23]
 v_rcp_f32 v67, v67
 v_exp_f32 v83, v83
 v_mfma_f32_32x32x16_bf16 v[8:23], a[196:199], a[212:215], v[8:23]
 v_rcp_f32 v68, v68
 v_exp_f32 v84, v84
 v_rcp_f32 v69, v69
 v_exp_f32 v85, v85
 v_rcp_f32 v70, v70
 v_exp_f32 v86, v86
 v_rcp_f32 v71, v71
 v_exp_f32 v87, v87
 v_pk_mul_f32 v[56:57], v[24:25], v[56:57]
 v_pk_mul_f32 v[58:59], v[26:27], v[58:59]
 v_pk_mul_f32 v[60:61], v[28:29], v[60:61]
 v_pk_mul_f32 v[62:63], v[30:31], v[62:63]
 v_pk_mul_f32 v[64:65], v[32:33], v[64:65]
 v_pk_mul_f32 v[66:67], v[34:35], v[66:67]
 v_pk_mul_f32 v[68:69], v[36:37], v[68:69]
 v_pk_mul_f32 v[70:71], v[38:39], v[70:71]
 v_pk_add_f32 v[72:73], v[72:73], 1.0
 v_pk_add_f32 v[74:75], v[74:75], 1.0
 v_pk_add_f32 v[76:77], v[76:77], 1.0
 v_pk_add_f32 v[78:79], v[78:79], 1.0
 v_pk_add_f32 v[80:81], v[80:81], 1.0
 v_pk_add_f32 v[82:83], v[82:83], 1.0
 v_pk_add_f32 v[84:85], v[84:85], 1.0
 v_pk_add_f32 v[86:87], v[86:87], 1.0
 v_pk_fma_f32 v[88:89], v[56:57], v[56:57], v[88:89]
 v_pk_fma_f32 v[90:91], v[58:59], v[58:59], v[90:91]
 v_pk_fma_f32 v[92:93], v[60:61], v[60:61], v[92:93]
 v_pk_fma_f32 v[94:95], v[62:63], v[62:63], v[94:95]
 v_pk_fma_f32 v[96:97], v[64:65], v[64:65], v[96:97]
 v_pk_fma_f32 v[98:99], v[66:67], v[66:67], v[98:99]
 v_pk_fma_f32 v[100:101], v[68:69], v[68:69], v[100:101]
 v_pk_fma_f32 v[102:103], v[70:71], v[70:71], v[102:103]
 v_cvt_pk_bf16_f32 v216, v56, v57
 v_cvt_pk_bf16_f32 v217, v58, v59
 v_cvt_pk_bf16_f32 v218, v60, v61
 v_cvt_pk_bf16_f32 v219, v62, v63
 v_cvt_pk_bf16_f32 v220, v64, v65
 v_cvt_pk_bf16_f32 v221, v66, v67
 v_cvt_pk_bf16_f32 v222, v68, v69
 v_cvt_pk_bf16_f32 v223, v70, v71
 v_pk_fma_f32 v[56:57], v[8:9], v[8:9], s[50:51]
 v_pk_fma_f32 v[58:59], v[10:11], v[10:11], s[50:51]
 v_pk_fma_f32 v[60:61], v[12:13], v[12:13], s[50:51]
 v_pk_fma_f32 v[62:63], v[14:15], v[14:15], s[50:51]
 v_pk_fma_f32 v[64:65], v[16:17], v[16:17], s[50:51]
 v_pk_fma_f32 v[66:67], v[18:19], v[18:19], s[50:51]
 v_pk_fma_f32 v[68:69], v[20:21], v[20:21], s[50:51]
 v_pk_fma_f32 v[70:71], v[22:23], v[22:23], s[50:51]
 v_pk_mul_f32 v[56:57], v[56:57], v[8:9]
 v_pk_mul_f32 v[58:59], v[58:59], v[10:11]
 v_pk_mul_f32 v[60:61], v[60:61], v[12:13]
 v_pk_mul_f32 v[62:63], v[62:63], v[14:15]
 v_pk_mul_f32 v[64:65], v[64:65], v[16:17]
 v_pk_mul_f32 v[66:67], v[66:67], v[18:19]
 v_pk_mul_f32 v[68:69], v[68:69], v[20:21]
 v_pk_mul_f32 v[70:71], v[70:71], v[22:23]
 v_rcp_f32 v72, v72
 v_exp_f32 v56, v56
 v_rcp_f32 v73, v73
 v_exp_f32 v57, v57
 v_rcp_f32 v74, v74
 v_exp_f32 v58, v58
 v_rcp_f32 v75, v75
 v_exp_f32 v59, v59
 v_rcp_f32 v76, v76
 v_exp_f32 v60, v60
 v_rcp_f32 v77, v77
 v_exp_f32 v61, v61
 v_rcp_f32 v78, v78
 v_exp_f32 v62, v62
 v_rcp_f32 v79, v79
 v_exp_f32 v63, v63
 v_rcp_f32 v80, v80
 v_exp_f32 v64, v64
 v_rcp_f32 v81, v81
 v_exp_f32 v65, v65
 v_rcp_f32 v82, v82
 v_exp_f32 v66, v66
 v_rcp_f32 v83, v83
 v_exp_f32 v67, v67
 v_rcp_f32 v84, v84
 v_exp_f32 v68, v68
 v_rcp_f32 v85, v85
 v_exp_f32 v69, v69
 v_rcp_f32 v86, v86
 v_exp_f32 v70, v70
 v_rcp_f32 v87, v87
 v_exp_f32 v71, v71
 v_pk_mul_f32 v[72:73], v[40:41], v[72:73]
 v_pk_mul_f32 v[74:75], v[42:43], v[74:75]
 v_pk_mul_f32 v[76:77], v[44:45], v[76:77]
 v_pk_mul_f32 v[78:79], v[46:47], v[78:79]
 v_pk_mul_f32 v[80:81], v[48:49], v[80:81]
 v_pk_mul_f32 v[82:83], v[50:51], v[82:83]
 v_pk_mul_f32 v[84:85], v[52:53], v[84:85]
 v_pk_mul_f32 v[86:87], v[54:55], v[86:87]
 v_pk_add_f32 v[56:57], v[56:57], 1.0
 v_pk_add_f32 v[58:59], v[58:59], 1.0
 v_pk_add_f32 v[60:61], v[60:61], 1.0
 v_pk_add_f32 v[62:63], v[62:63], 1.0
 v_pk_add_f32 v[64:65], v[64:65], 1.0
 v_pk_add_f32 v[66:67], v[66:67], 1.0
 v_pk_add_f32 v[68:69], v[68:69], 1.0
 v_pk_add_f32 v[70:71], v[70:71], 1.0
 v_pk_fma_f32 v[88:89], v[72:73], v[72:73], v[88:89]
 v_pk_fma_f32 v[90:91], v[74:75], v[74:75], v[90:91]
 v_pk_fma_f32 v[92:93], v[76:77], v[76:77], v[92:93]
 v_pk_fma_f32 v[94:95], v[78:79], v[78:79], v[94:95]
 v_pk_fma_f32 v[96:97], v[80:81], v[80:81], v[96:97]
 v_pk_fma_f32 v[98:99], v[82:83], v[82:83], v[98:99]
 v_pk_fma_f32 v[100:101], v[84:85], v[84:85], v[100:101]
 v_pk_fma_f32 v[102:103], v[86:87], v[86:87], v[102:103]
 v_cvt_pk_bf16_f32 v224, v72, v73
 v_cvt_pk_bf16_f32 v225, v74, v75
 v_cvt_pk_bf16_f32 v226, v76, v77
 v_cvt_pk_bf16_f32 v227, v78, v79
 v_cvt_pk_bf16_f32 v228, v80, v81
 v_cvt_pk_bf16_f32 v229, v82, v83
 v_cvt_pk_bf16_f32 v230, v84, v85
 v_cvt_pk_bf16_f32 v231, v86, v87
 v_rcp_f32 v56, v56
 v_rcp_f32 v57, v57
 v_rcp_f32 v58, v58
 v_rcp_f32 v59, v59
 v_rcp_f32 v60, v60
 v_rcp_f32 v61, v61
 v_rcp_f32 v62, v62
 v_rcp_f32 v63, v63
 v_rcp_f32 v64, v64
 v_rcp_f32 v65, v65
 v_rcp_f32 v66, v66
 v_rcp_f32 v67, v67
 v_rcp_f32 v68, v68
 v_rcp_f32 v69, v69
 v_rcp_f32 v70, v70
 v_rcp_f32 v71, v71
 v_pk_mul_f32 v[56:57], v[8:9], v[56:57]
 v_pk_mul_f32 v[58:59], v[10:11], v[58:59]
 v_pk_mul_f32 v[60:61], v[12:13], v[60:61]
 v_pk_mul_f32 v[62:63], v[14:15], v[62:63]
 v_pk_mul_f32 v[64:65], v[16:17], v[64:65]
 v_pk_mul_f32 v[66:67], v[18:19], v[66:67]
 v_pk_mul_f32 v[68:69], v[20:21], v[68:69]
 v_pk_mul_f32 v[70:71], v[22:23], v[70:71]
 v_pk_fma_f32 v[88:89], v[56:57], v[56:57], v[88:89]
 v_pk_fma_f32 v[90:91], v[58:59], v[58:59], v[90:91]
 v_pk_fma_f32 v[92:93], v[60:61], v[60:61], v[92:93]
 v_pk_fma_f32 v[94:95], v[62:63], v[62:63], v[94:95]
 v_pk_fma_f32 v[96:97], v[64:65], v[64:65], v[96:97]
 v_pk_fma_f32 v[98:99], v[66:67], v[66:67], v[98:99]
 v_pk_fma_f32 v[100:101], v[68:69], v[68:69], v[100:101]
 v_pk_fma_f32 v[102:103], v[70:71], v[70:71], v[102:103]
 v_add_f32_dpp v88, v88, v88 row_ror:8 row_mask:0xf bank_mask:0x3
 v_add_f32_dpp v90, v90, v90 row_ror:8 row_mask:0xf bank_mask:0x3
 v_add_f32_dpp v92, v92, v92 row_ror:8 row_mask:0xf bank_mask:0x3
 v_add_f32_dpp v94, v94, v94 row_ror:8 row_mask:0xf bank_mask:0x3
 v_add_f32_dpp v96, v96, v96 row_ror:8 row_mask:0xf bank_mask:0x3
 v_add_f32_dpp v98, v98, v98 row_ror:8 row_mask:0xf bank_mask:0x3
 v_add_f32_dpp v100, v100, v100 row_ror:8 row_mask:0xf bank_mask:0x3
 v_add_f32_dpp v102, v102, v102 row_ror:8 row_mask:0xf bank_mask:0x3
 v_add_f32_dpp v88, v89, v89 row_ror:8 row_mask:0xf bank_mask:0xc
 v_add_f32_dpp v90, v91, v91 row_ror:8 row_mask:0xf bank_mask:0xc
 v_add_f32_dpp v92, v93, v93 row_ror:8 row_mask:0xf bank_mask:0xc
 v_add_f32_dpp v94, v95, v95 row_ror:8 row_mask:0xf bank_mask:0xc
 v_add_f32_dpp v96, v97, v97 row_ror:8 row_mask:0xf bank_mask:0xc
 v_add_f32_dpp v98, v99, v99 row_ror:8 row_mask:0xf bank_mask:0xc
 v_add_f32_dpp v100, v101, v101 row_ror:8 row_mask:0xf bank_mask:0xc
 v_add_f32_dpp v102, v103, v103 row_ror:8 row_mask:0xf bank_mask:0xc
 v_add_f32_dpp v88, v88, v88 row_shl:4 row_mask:0xf bank_mask:0x5
 v_add_f32_dpp v92, v92, v92 row_shl:4 row_mask:0xf bank_mask:0x5
 v_add_f32_dpp v96, v96, v96 row_shl:4 row_mask:0xf bank_mask:0x5
 v_add_f32_dpp v100, v100, v100 row_shl:4 row_mask:0xf bank_mask:0x5
 v_add_f32_dpp v88, v90, v90 row_shr:4 row_mask:0xf bank_mask:0xa
 v_add_f32_dpp v92, v94, v94 row_shr:4 row_mask:0xf bank_mask:0xa
 v_add_f32_dpp v96, v98, v98 row_shr:4 row_mask:0xf bank_mask:0xa
 v_add_f32_dpp v100, v102, v102 row_shr:4 row_mask:0xf bank_mask:0xa
 s_lshl_b32 s6, s61, 8
 v_add_u32 v7, s6, v6
 v_permlane16_swap_b32 v88, v92
 v_permlane16_swap_b32 v96, v100
 v_add_f32 v88, v88, v92
 v_add_f32 v96, v96, v100
 s_nop 0
 v_add_f32_dpp v88, v88, v88 quad_perm:[2,3,0,1] row_mask:0xf bank_mask:0xf
 v_add_f32_dpp v96, v96, v96 quad_perm:[2,3,0,1] row_mask:0xf bank_mask:0xf
 v_cndmask_b32 v88, v88, v96, s[52:53]
 s_nop 1
 v_add_f32_dpp v89, v88, v88 quad_perm:[1,0,3,2] row_mask:0xf bank_mask:0xf
 ds_write_b32 v7, v89
 ds_read_b128 v[12:15], v240
 s_waitcnt vmcnt(0)
 s_waitcnt lgkmcnt(0)
 buffer_store_dwordx4 v[12:15], v241, s[24:27], 0 offen sc1
 v_cvt_pk_bf16_f32 v232, v56, v57
 v_cvt_pk_bf16_f32 v233, v58, v59
 v_cvt_pk_bf16_f32 v234, v60, v61
 v_cvt_pk_bf16_f32 v235, v62, v63
 v_cvt_pk_bf16_f32 v236, v64, v65
 v_cvt_pk_bf16_f32 v237, v66, v67
 v_cvt_pk_bf16_f32 v238, v68, v69
 v_cvt_pk_bf16_f32 v239, v70, v71
 v_and_b32 v96, 31, v1
 v_lshrrev_b32 v97, 5, v1
 v_lshlrev_b32 v97, 2, v97
 v_and_b32 v98, 7, v96
 v_xor_b32 v97, v97, v98
 v_lshlrev_b32 v97, 4, v97
 v_lshl_add_u32 v97, v96, 7, v97
 s_lshl_b32 s6, s3, 13
 s_add_u32 s6, s6, 98304
 v_add_u32 v97, s6, v97
 v_xor_b32 v248, 0, v97
 v_xor_b32 v249, 16, v97
 v_xor_b32 v250, 32, v97
 v_xor_b32 v251, 48, v97
 v_lshrrev_b32 v96, 2, v1
 s_and_b32 s6, s3, 1
 s_lshl_b32 s6, s6, 4
 v_add_u32 v96, s6, v96
 v_and_b32 v97, 3, v1
 v_and_b32 v98, 7, v96
 v_xor_b32 v97, v97, v98
 v_lshlrev_b32 v97, 4, v97
 v_lshl_add_u32 v97, v96, 7, v97
 s_lshr_b32 s6, s3, 1
 s_lshl_b32 s6, s6, 12
 s_add_u32 s6, s6, 98304
 v_add_u32 v252, s6, v97
 v_xor_b32 v253, 64, v252
 v_lshrrev_b32 v96, 2, v1
 s_lshl_b32 s6, s3, 4
 s_add_u32 s6, s6, 0
 v_add_u32 v96, s6, v96
 v_mul_u32_u24 v97, 4682, v96
 v_lshrrev_b32 v97, 16, v97
 v_mul_u32_u24 v98, 14, v97
 v_sub_u32 v98, v96, v98
 v_add_u32 v97, s44, v97
 v_mul_u32_u24 v97, 224, v97
 v_add3_u32 v97, v97, v98, s45
 v_mul_u32_u24 v97, 384, v97
 v_and_b32_e64 v98, 3, v1
 v_lshl_add_u32 v244, v98, 4, v97
 v_lshrrev_b32 v96, 2, v1
 s_lshl_b32 s6, s3, 4
 s_add_u32 s6, s6, 64
 v_add_u32 v96, s6, v96
 v_mul_u32_u24 v97, 4682, v96
 v_lshrrev_b32 v97, 16, v97
 v_mul_u32_u24 v98, 14, v97
 v_sub_u32 v98, v96, v98
 v_add_u32 v97, s44, v97
 v_mul_u32_u24 v97, 224, v97
 v_add3_u32 v97, v97, v98, s45
 v_mul_u32_u24 v97, 384, v97
 v_and_b32_e64 v98, 3, v1
 v_lshl_add_u32 v245, v98, 4, v97
 v_lshrrev_b32 v96, 2, v1
 s_lshl_b32 s6, s3, 4
 s_add_u32 s6, s6, 128
 v_add_u32_e64 v96, s6, v96
 v_mul_u32_u24 v97, 4682, v96
 v_lshrrev_b32 v97, 16, v97
 v_mul_u32_u24 v98, 14, v97
 v_sub_u32 v98, v96, v98
 v_add_u32 v97, s44, v97
 v_mul_u32_u24 v97, 224, v97
 v_add3_u32 v97, v97, v98, s45
 v_mul_u32_u24 v97, 384, v97
 v_and_b32 v98, 3, v1
 v_lshl_add_u32 v246, v98, 4, v97
 s_waitcnt lgkmcnt(0)
 s_cmp_ge_u32 s81, 30
 s_cbranch_scc1 L_red_skip
 s_lshl_b32 s87, s81, 15
 s_lshl_b32 s6, s3, 13
 s_add_u32 s87, s87, s6
 s_add_u32 s87, s87, 0x0
 s_add_u32 s85, s87, 4096
 v_lshlrev_b32_e64 v40, 4, v1
 s_mov_b32 s84, 0
L_red_loop:
 buffer_load_dwordx4 v[48:51], v40, s[24:27], s87 offen offset:0 sc1
 buffer_load_dwordx4 v[52:55], v40, s[24:27], s87 offen offset:1024 sc1
 buffer_load_dwordx4 v[56:59], v40, s[24:27], s87 offen offset:2048 sc1
 buffer_load_dwordx4 v[60:63], v40, s[24:27], s87 offen offset:3072 sc1
 buffer_load_dwordx4 v[64:67], v40, s[24:27], s85 offen offset:0 sc1
 buffer_load_dwordx4 v[68:71], v40, s[24:27], s85 offen offset:1024 sc1
 buffer_load_dwordx4 v[72:75], v40, s[24:27], s85 offen offset:2048 sc1
 buffer_load_dwordx4 v[76:79], v40, s[24:27], s85 offen offset:3072 sc1
 s_waitcnt vmcnt(0)
 v_max3_u32 v41, v48, v49, v50
 v_max3_u32 v41, v41, v51, v52
 v_max3_u32 v41, v41, v53, v54
 v_max3_u32 v41, v41, v55, v56
 v_max3_u32 v41, v41, v57, v58
 v_max3_u32 v41, v41, v59, v60
 v_max3_u32 v41, v41, v61, v62
 v_max3_u32 v41, v41, v63, v64
 v_max3_u32 v41, v41, v65, v66
 v_max3_u32 v41, v41, v67, v68
 v_max3_u32 v41, v41, v69, v70
 v_max3_u32 v41, v41, v71, v72
 v_max3_u32 v41, v41, v73, v74
 v_max3_u32 v41, v41, v75, v76
 v_max3_u32 v41, v41, v77, v78
 v_max_u32 v41, v41, v79
 v_cmp_eq_u32 vcc, -1, v41
 s_nop 4
 s_cmp_eq_u64 vcc, 0
 s_cbranch_scc1 L_red_done
 s_add_u32 s84, s84, 1
 s_cmp_lt_u32 s84, 0x40000
 s_cbranch_scc1 L_red_loop
L_red_done:
 v_add_f32 v48, v48, v64
 v_add_f32 v49, v49, v65
 v_add_f32 v50, v50, v66
 v_add_f32 v51, v51, v67
 v_add_f32 v52, v52, v68
 v_add_f32 v53, v53, v69
 v_add_f32 v54, v54, v70
 v_add_f32 v55, v55, v71
 v_add_f32 v56, v56, v72
 v_add_f32 v57, v57, v73
 v_add_f32 v58, v58, v74
 v_add_f32 v59, v59, v75
 v_add_f32 v60, v60, v76
 v_add_f32 v61, v61, v77
 v_add_f32 v62, v62, v78
 v_add_f32 v63, v63, v79
 v_add_f32 v48, v48, v56
 v_add_f32 v49, v49, v57
 v_add_f32 v50, v50, v58
 v_add_f32 v51, v51, v59
 v_add_f32 v52, v52, v60
 v_add_f32 v53, v53, v61
 v_add_f32 v54, v54, v62
 v_add_f32 v55, v55, v63
 v_add_f32 v48, v48, v52
 v_add_f32 v49, v49, v53
 v_add_f32 v50, v50, v54
 v_add_f32 v51, v51, v55
 s_nop 1
 v_add_f32_dpp v48, v48, v48 row_ror:8 row_mask:0xf bank_mask:0xf
 v_add_f32_dpp v49, v49, v49 row_ror:8 row_mask:0xf bank_mask:0xf
 v_add_f32_dpp v50, v50, v50 row_ror:8 row_mask:0xf bank_mask:0xf
 v_add_f32_dpp v51, v51, v51 row_ror:8 row_mask:0xf bank_mask:0xf
 v_permlane16_swap_b32 v48, v49
 s_nop 0
 v_permlane16_swap_b32 v50, v51
 v_add_f32 v48, v48, v49
 v_add_f32 v50, v50, v51
 s_nop 1
 v_permlane32_swap_b32 v48, v50
 v_add_f32 v48, v48, v50
 v_and_b32 v42, 7, v1
 v_lshlrev_b32 v42, 2, v42
 v_bfe_u32 v43, v1, 4, 1
 v_add_u32 v42, v42, v43
 v_lshrrev_b32 v43, 5, v1
 v_lshl_add_u32 v42, v43, 1, v42
 s_lshl_b32 s6, s3, 7
 s_add_u32 s6, s6, 77824
 v_lshlrev_b32 v42, 2, v42
 v_add_u32_e64 v42, s6, v42
 ds_write_b32 v42, v48
 v_and_b32 v43, 31, v1
 v_lshlrev_b32 v43, 2, v43
 v_add_u32 v44, 77824, v43
 s_waitcnt lgkmcnt(0)
 s_barrier
 ds_read_b32 v52, v44 offset:0
 ds_read_b32 v53, v44 offset:128
 ds_read_b32 v54, v44 offset:256
 ds_read_b32 v55, v44 offset:384
 s_waitcnt lgkmcnt(2)
 v_add_f32 v52, v52, v53
 s_waitcnt lgkmcnt(0)
 v_add_f32 v54, v54, v55
 v_add_f32_e64 v48, v52, v54
 v_mov_b32 v50, 0x358637bd
 v_fmac_f32 v50, 0x4091afa4, v48
 v_sqrt_f32 v50, v50
 s_cmp_lt_u32 s81, 24
 s_cselect_b32 s6, -1, 0
 s_mov_b32 s7, s6
 v_cndmask_b32 v48, v48, v50, s[6:7]
 s_lshl_b32 s6, s81, 7
 s_add_u32 s6, s6, 0x100000
 s_cmp_eq_u32 s3, 0
 s_cselect_b32 s6, s6, 0x40000000
 s_mov_b32 s88, -1
 s_mov_b32 s89, 0
 s_mov_b64 exec, s[88:89]
 buffer_store_dword v48, v43, s[24:27], s6 offen sc1
 s_mov_b64 exec, -1
 s_waitcnt lgkmcnt(0)
L_red_skip:
 s_lshr_b32 s6, s3, 1
 s_mul_i32 s6, s6, 384
 s_and_b32 s7, s3, 1
 s_lshl_b32 s7, s7, 5
 s_add_u32 s87, s6, s7
 s_lshl_b32 s6, s56, 6
 s_add_u32 s94, s6, s87
 s_lshl_b32 s94, s94, 6
 s_lshl_b32 s6, s57, 6
 s_add_u32 s95, s6, s87
 s_lshl_b32 s95, s95, 6
 s_lshl_b32 s6, s58, 6
 s_add_u32 s96, s6, s87
 s_lshl_b32 s96, s96, 6
 s_lshl_b32 s6, s59, 6
 s_add_u32 s97, s6, s87
 s_lshl_b32 s97, s97, 6
 s_lshl_b32 s6, s60, 6
 s_add_u32 s98, s6, s87
 s_lshl_b32 s98, s98, 6
 s_lshl_b32 s6, s61, 6
 s_add_u32 s99, s6, s87
 s_lshl_b32 s99, s99, 6
 v_lshlrev_b32_e64 v6, 4, v1
 s_mul_i32 s49, s56, 49152
 s_add_u32 s49, s49, 0x380000
 s_add_u32 s85, s49, s94
 buffer_load_dwordx4 a[200:203], v6, s[24:27], s85 offen offset:0 sc1
 buffer_load_dwordx4 a[204:207], v6, s[24:27], s85 offen offset:1024 sc1
 s_add_u32 s85, s49, s95
 buffer_load_dwordx4 a[208:211], v6, s[24:27], s85 offen offset:0 sc1
 buffer_load_dwordx4 a[212:215], v6, s[24:27], s85 offen offset:1024 sc1
 s_add_u32 s85, s49, s96
 buffer_load_dwordx4 a[216:219], v6, s[24:27], s85 offen offset:0 sc1
 buffer_load_dwordx4 a[220:223], v6, s[24:27], s85 offen offset:1024 sc1
 s_add_u32 s85, s49, s97
 buffer_load_dwordx4 a[224:227], v6, s[24:27], s85 offen offset:0 sc1
 buffer_load_dwordx4 a[228:231], v6, s[24:27], s85 offen offset:1024 sc1
 s_add_u32 s85, s49, s98
 buffer_load_dwordx4 a[232:235], v6, s[24:27], s85 offen offset:0 sc1
 buffer_load_dwordx4 a[236:239], v6, s[24:27], s85 offen offset:1024 sc1
 s_add_u32 s85, s49, s99
 buffer_load_dwordx4 a[240:243], v6, s[24:27], s85 offen offset:0 sc1
 buffer_load_dwordx4 a[244:247], v6, s[24:27], s85 offen offset:1024 sc1
 v_and_b32 v9, 31, v1
 s_mov_b32 s54, 0
 s_mov_b32 s55, -1
 v_mov_b32 v10, s94
 v_mov_b32_e64 v11, s95
 v_cndmask_b32 v10, v10, v11, s[54:55]
 v_lshrrev_b32 v10, 6, v10
 v_add_u32 v16, v10, v9
 v_lshlrev_b32_e64 v10, 1, v16
 buffer_load_ushort v20, v10, s[32:35], 0 offen
 v_lshlrev_b32_e64 v16, 2, v16
 v_add_u32 v16, 80896, v16
 v_mov_b32 v10, s96
 v_mov_b32 v11, s97
 v_cndmask_b32 v10, v10, v11, s[54:55]
 v_lshrrev_b32 v10, 6, v10
 v_add_u32 v17, v10, v9
 v_lshlrev_b32_e64 v10, 1, v17
 buffer_load_ushort v21, v10, s[32:35], 0 offen
 v_lshlrev_b32_e64 v17, 2, v17
 v_add_u32 v17, 80896, v17
 v_mov_b32 v10, s98
 v_mov_b32 v11, s99
 v_cndmask_b32 v10, v10, v11, s[54:55]
 v_lshrrev_b32 v10, 6, v10
 v_add_u32 v18, v10, v9
 v_lshlrev_b32_e64 v10, 1, v18
 buffer_load_ushort v22, v10, s[32:35], 0 offen
 v_lshlrev_b32_e64 v18, 2, v18
 v_add_u32 v18, 80896, v18
 v_and_b32 v10, 7, v1
 v_and_b32 v11, 1, v10
 v_lshlrev_b32 v11, 4, v11
 v_mov_b32 v12, 1
 v_lshlrev_b32 v11, v11, v12
 v_lshrrev_b32 v10, 1, v10
 v_cmp_eq_u32 vcc, 0, v10
 s_nop 1
 v_cndmask_b32 v24, 0, v11, vcc
 v_cmp_eq_u32 vcc, 1, v10
 s_nop 1
 v_cndmask_b32 v25, 0, v11, vcc
 v_cmp_eq_u32 vcc, 2, v10
 s_nop 1
 v_cndmask_b32 v26, 0, v11, vcc
 v_cmp_eq_u32 vcc, 3, v10
 s_nop 1
 v_cndmask_b32 v27, 0, v11, vcc
 s_mul_i32 s6, s3, 3328
 s_add_u32 s49, s6, 84992
 v_lshrrev_b32_e64 v10, 5, v1
 v_mul_u32_u24 v10, 544, v10
 v_bfe_u32 v11, v1, 4, 1
 v_mul_u32_u24 v11, 272, v11
 v_and_b32_e64 v12, 15, v1
 v_lshl_add_u32 v10, v12, 4, v10
 v_add3_u32 v10, v10, v11, s49
 v_add_u32_e64 v28, 0, v10
 v_add_u32 v29, 1088, v10
 v_add_u32 v30, 2176, v10
 v_mov_b32 v32, 0
 v_mov_b32 v33, 0
 v_mov_b32 v34, 0
 v_mov_b32 v35, 0
 v_mul_u32_u24 v10, 272, v1
 v_add_u32 v10, 256, v10
 v_add_u32_e64 v10, s49, v10
 s_mov_b64 exec, 0xfff
 ds_write_b128 v10, v[32:35]
 s_mov_b64 exec, -1
 v_lshlrev_b32 v10, 4, v1
 v_add_u32 v10, 76800, v10
 ds_write_b128 v10, v[32:35]
 v_and_b32 v10, 31, v1
 v_lshrrev_b32 v11, 5, v1
 v_bfe_u32 v12, v1, 3, 1
 v_cmp_eq_u32 s[54:55], v11, v12
 v_bfe_u32 v13, v1, 4, 1
 v_and_b32 v14, 15, v1
 v_lshlrev_b32 v14, 4, v14
 v_mov_b32 v15, 256
 v_cndmask_b32 v14, v15, v14, s[54:55]
 v_cmp_eq_u32 vcc, 0, v13
 s_nop 1
 v_cndmask_b32 v36, v15, v14, vcc
 v_cndmask_b32 v37, v14, v15, vcc
 v_add_u32_e64 v3, s49, v36
 s_add_u32 s6, s49, 272
 v_add_u32 v4, s6, v37
 v_lshrrev_b32 v10, 5, v1
 v_lshlrev_b32 v10, 4, v10
 s_cmp_eq_u32 s3, 0
 s_mov_b32 s6, 83968
 s_cselect_b32 s6, s6, 76800
 v_add_u32 v5, s6, v10
 s_waitcnt vmcnt(0) lgkmcnt(0)
 s_cmp_lg_u32 s3, 0
 s_cbranch_scc1 L_tot_skip
 v_lshlrev_b32_e64 v10, 4, v1
 v_add_u32 v11, 0x100000, v10
 v_add_u32 v13, 0xc00, v11
 v_mov_b32 v12, 0x40000000
 v_cmp_gt_u32 vcc, 48, v1
 s_nop 1
 v_cndmask_b32 v13, v12, v13, vcc
 v_add_u32 v10, 80896, v10
 s_mov_b32 s84, 0
L_tot_loop:
 buffer_load_dwordx4 v[40:43], v11, s[24:27], 0 offen offset:0 sc1
 buffer_load_dwordx4 v[44:47], v11, s[24:27], 0 offen offset:1024 sc1
 buffer_load_dwordx4 v[48:51], v11, s[24:27], 0 offen offset:2048 sc1
 buffer_load_dwordx4 v[52:55], v13, s[24:27], 0 offen sc1
 s_waitcnt vmcnt(0)
 v_max3_u32 v12, v40, v41, v42
 v_max3_u32 v12, v12, v43, v44
 v_max3_u32 v12, v12, v45, v46
 v_max3_u32 v12, v12, v47, v48
 v_max3_u32 v12, v12, v49, v50
 v_max3_u32 v12, v12, v51, v52
 v_max3_u32 v12, v12, v53, v54
 v_max_u32_e64 v12, v12, v55
 v_cmp_eq_u32 vcc, -1, v12
 s_nop 4
 s_cmp_eq_u64 vcc, 0
 s_cbranch_scc1 L_tot_done
 s_add_u32 s84, s84, 1
 s_cmp_lt_u32 s84, 0x40000
 s_cbranch_scc1 L_tot_loop
L_tot_done:
 ds_write_b128 v10, v[40:43] offset:0
 ds_write_b128 v10, v[44:47] offset:1024
 ds_write_b128 v10, v[48:51] offset:2048
 ds_write_b128 v10, v[52:55] offset:3072
 s_waitcnt lgkmcnt(0)
L_tot_skip:
 s_barrier
 v_lshlrev_b32_e64 v10, 4, v1
 v_add_u32 v10, 80896, v10
 ds_read_b128 v[40:43], v10 offset:0
 ds_read_b128 v[44:47], v10 offset:1024
 ds_read_b128 v[48:51], v10 offset:2048
 ds_read_b32 v56, v16
 ds_read_b32 v57, v17
 ds_read_b32 v58, v18
 v_lshlrev_b32 v20, 16, v20
 v_lshlrev_b32 v21, 16, v21
 v_lshlrev_b32 v22, 16, v22
 s_waitcnt lgkmcnt(4)
 v_add_f32 v40, v40, v44
 v_add_f32 v41, v41, v45
 v_add_f32 v42, v42, v46
 v_add_f32 v43, v43, v47
 s_waitcnt lgkmcnt(3)
 v_add_f32 v40, v40, v48
 v_add_f32 v41, v41, v49
 v_add_f32 v42, v42, v50
 v_add_f32 v43, v43, v51
 v_add_f32 v40, v40, v41
 v_add_f32 v42, v42, v43
 v_add_f32 v40, v40, v42
 s_nop 1
 v_add_f32_dpp v40, v40, v40 row_ror:8 row_mask:0xf bank_mask:0xf
 s_nop 1
 v_add_f32_dpp v40, v40, v40 row_ror:4 row_mask:0xf bank_mask:0xf
 s_nop 1
 v_add_f32_dpp v40, v40, v40 quad_perm:[2,3,0,1] row_mask:0xf bank_mask:0xf
 s_nop 1
 v_add_f32_dpp v40, v40, v40 quad_perm:[1,0,3,2] row_mask:0xf bank_mask:0xf
 v_mov_b32 v41, v40
 s_nop 1
 v_permlane16_swap_b32 v40, v41
 v_add_f32 v40, v40, v41
 v_mov_b32 v41, v40
 s_nop 1
 v_permlane32_swap_b32 v40, v41
 v_add_f32 v40, v40, v41
 v_mov_b32 v41, 0x358637bd
 v_fmac_f32 v41, 0x3aaaaaab, v40
 v_rcp_f32 v41, v41
 s_waitcnt lgkmcnt(2)
 v_mul_f32 v56, v56, v20
 s_waitcnt lgkmcnt(1)
 v_mul_f32 v57, v57, v21
 s_waitcnt lgkmcnt(0)
 v_mul_f32_e64 v58, v58, v22
 v_fma_f32 v56, v56, v41, 1.0
 v_fma_f32 v57, v57, v41, 1.0
 v_fma_f32 v58, v58, v41, 1.0
 v_mul_f32 v56, 0xc0088e99, v56
 v_mul_f32 v57, 0xc0088e99, v57
 v_mul_f32 v58, 0xc0088e99, v58
 v_cvt_pk_bf16_f32 v56, v56, v56
 v_cvt_pk_bf16_f32 v57, v57, v57
 v_cvt_pk_bf16_f32 v58, v58, v58
 v_and_b32 v56, 0xffff, v56
 v_and_b32 v57, 0xffff, v57
 v_and_b32 v58, 0xffff, v58
 v_mul_u32_u24 v60, v56, v24
 v_mul_u32_u24 v61, v56, v25
 v_mul_u32_u24 v62, v56, v26
 v_mul_u32_u24 v63, v56, v27
 ds_write_b128 v28, v[60:63]
 v_mul_u32_u24 v64, v57, v24
 v_mul_u32_u24 v65, v57, v25
 v_mul_u32_u24 v66, v57, v26
 v_mul_u32_u24 v67, v57, v27
 ds_write_b128 v29, v[64:67]
 v_mul_u32_u24 v68, v58, v24
 v_mul_u32_u24 v69, v58, v25
 v_mul_u32_u24_e64 v70, v58, v26
 v_mul_u32_u24 v71, v58, v27
 ds_write_b128 v30, v[68:71]
 s_lshl_b32 s86, s3, 10
 v_add_u32 v0, s86, v6
 s_lshl_b32 s6, s56, 7
 v_add_u32 v7, s6, v5
 ds_read_b128 a[184:187], v7 offset:0
 ds_read_b128 a[188:191], v7 offset:32
 ds_read_b128 a[192:195], v7 offset:64
 ds_read_b128 a[196:199], v7 offset:96
 ds_read_b128 a[248:251], v3 offset:0
 ds_read_b128 a[252:255], v4 offset:0
 s_add_u32 m0, s86, 0
 s_lshl_b32 s87, s56, 6
 buffer_load_dwordx4 v244, s[8:11], s87 offen lds
 s_add_u32 m0, s86, 4096
 s_lshl_b32 s87, s56, 6
 buffer_load_dwordx4 v245, s[8:11], s87 offen lds
 s_add_u32 m0, s86, 8192
 s_lshl_b32 s87, s56, 6
 buffer_load_dwordx4 v246, s[8:11], s87 offen lds
 ds_read_b128 a[168:171], v3 offset:544
 ds_read_b128 a[172:175], v4 offset:544
 s_waitcnt lgkmcnt(3)
 v_mfma_f32_32x32x16_bf16 v[56:71], a[248:251], a[200:203], 0
 ds_read_b128 a[248:251], v3 offset:1088
 s_waitcnt lgkmcnt(3)
 v_mfma_f32_32x32x16_bf16 v[56:71], a[252:255], a[204:207], v[56:71]
 ds_read_b128 a[252:255], v4 offset:1088
 s_mul_i32 s49, s57, 49152
 s_add_u32 s49, s49, 0x380000
 s_add_u32 s85, s49, s94
 buffer_load_dwordx4 a[200:203], v6, s[24:27], s85 offen offset:0 sc1
 s_waitcnt lgkmcnt(3)
 v_mfma_f32_32x32x16_bf16 v[72:87], a[168:171], a[208:211], 0
 s_waitcnt lgkmcnt(2)
 v_mfma_f32_32x32x16_bf16 v[72:87], a[172:175], a[212:215], v[72:87]
 s_nop 2
 v_cvt_pk_bf16_f32 v8, v56, v57
 v_cvt_pk_bf16_f32 v9, v58, v59
 v_cvt_pk_bf16_f32 v10, v60, v61
 v_cvt_pk_bf16_f32 v11, v62, v63
 s_nop 1
 v_mfma_f32_32x32x16_bf16 a[152:167], v[8:11], a[0:3], a[184:199]
 buffer_load_dwordx4 a[204:207], v6, s[24:27], s85 offen offset:1024 sc1
 v_cvt_pk_bf16_f32 v12, v64, v65
 v_cvt_pk_bf16_f32 v13, v66, v67
 v_cvt_pk_bf16_f32 v14, v68, v69
 v_cvt_pk_bf16_f32 v15, v70, v71
 s_nop 1
 v_mfma_f32_32x32x16_bf16 a[152:167], v[12:15], a[4:7], a[152:167]
 v_cvt_pk_bf16_f32 v16, v72, v73
 v_cvt_pk_bf16_f32 v17, v74, v75
 v_cvt_pk_bf16_f32 v18, v76, v77
 v_cvt_pk_bf16_f32 v19, v78, v79
 s_waitcnt lgkmcnt(1)
 v_mfma_f32_32x32x16_bf16 v[56:71], a[248:251], a[216:219], 0
 ds_read_b128 a[248:251], v3 offset:1632
 v_cvt_pk_bf16_f32 v20, v80, v81
 v_cvt_pk_bf16_f32 v21, v82, v83
 s_waitcnt lgkmcnt(1)
 v_mfma_f32_32x32x16_bf16 v[56:71], a[252:255], a[220:223], v[56:71]
 ds_read_b128 a[252:255], v4 offset:1632
 s_add_u32 s85, s49, s95
 buffer_load_dwordx4 a[208:211], v6, s[24:27], s85 offen offset:0 sc1
 v_cvt_pk_bf16_f32 v22, v84, v85
 v_cvt_pk_bf16_f32 v23, v86, v87
 v_mfma_f32_32x32x16_bf16 a[152:167], v[16:19], a[48:51], a[152:167]
 s_nop 0
 v_mfma_f32_32x32x16_bf16 a[152:167], v[20:23], a[52:55], a[152:167]
 s_nop 3
 v_cvt_pk_bf16_f32 v24, v56, v57
 v_cvt_pk_bf16_f32 v25, v58, v59
 s_waitcnt lgkmcnt(1)
 v_mfma_f32_32x32x16_bf16 v[72:87], a[248:251], a[224:227], 0
 ds_read_b128 a[248:251], v3 offset:2176
 buffer_load_dwordx4 a[212:215], v6, s[24:27], s85 offen offset:1024 sc1
 v_cvt_pk_bf16_f32 v26, v60, v61
 v_cvt_pk_bf16_f32 v27, v62, v63
 v_cvt_pk_bf16_f32 v28, v64, v65
 s_waitcnt lgkmcnt(1)
 v_mfma_f32_32x32x16_bf16 v[72:87], a[252:255], a[228:231], v[72:87]
 ds_read_b128 a[252:255], v4 offset:2176
 v_cvt_pk_bf16_f32 v29, v66, v67
 v_cvt_pk_bf16_f32 v30, v68, v69
 v_cvt_pk_bf16_f32 v31, v70, v71
 v_mfma_f32_32x32x16_bf16 a[152:167], v[24:27], a[96:99], a[152:167]
 s_nop 0
 v_mfma_f32_32x32x16_bf16 a[152:167], v[28:31], a[100:103], a[152:167]
 s_nop 4
 v_cvt_pk_bf16_f32 v32, v72, v73
 v_cvt_pk_bf16_f32 v33, v74, v75
 s_waitcnt lgkmcnt(1)
 v_mfma_f32_32x32x16_bf16 v[56:71], a[248:251], a[232:235], 0
 ds_read_b128 a[248:251], v3 offset:2720
 v_cvt_pk_bf16_f32 v34, v76, v77
 v_cvt_pk_bf16_f32 v35, v78, v79
 v_cvt_pk_bf16_f32 v36, v80, v81
 s_waitcnt lgkmcnt(1)
 v_mfma_f32_32x32x16_bf16 v[56:71], a[252:255], a[236:239], v[56:71]
 ds_read_b128 a[252:255], v4 offset:2720
 v_cvt_pk_bf16_f32 v37, v82, v83
 v_cvt_pk_bf16_f32 v38, v84, v85
 v_cvt_pk_bf16_f32 v39, v86, v87
 v_mfma_f32_32x32x16_bf16 a[152:167], v[32:35], a[144:147], a[152:167]
 s_nop 0
 v_mfma_f32_32x32x16_bf16 a[152:167], v[36:39], a[148:151], a[152:167]
 s_nop 4
 v_cvt_pk_bf16_f32 v40, v56, v57
 v_cvt_pk_bf16_f32 v41, v58, v59
 s_waitcnt lgkmcnt(1)
 v_mfma_f32_32x32x16_bf16 v[72:87], a[248:251], a[240:243], 0
 v_cvt_pk_bf16_f32 v42, v60, v61
 v_cvt_pk_bf16_f32 v43, v62, v63
 v_cvt_pk_bf16_f32 v44, v64, v65
 s_waitcnt lgkmcnt(0)
 v_mfma_f32_32x32x16_bf16 v[72:87], a[252:255], a[244:247], v[72:87]
 v_cvt_pk_bf16_f32 v45, v66, v67
 v_cvt_pk_bf16_f32 v46, v68, v69
 v_cvt_pk_bf16_f32 v47, v70, v71
 v_mfma_f32_32x32x16_bf16 a[152:167], v[40:43], v[144:147], a[152:167]
 s_nop 0
 v_mfma_f32_32x32x16_bf16 a[152:167], v[44:47], v[148:151], a[152:167]
 s_nop 5
 v_cvt_pk_bf16_f32 v48, v72, v73
 v_cvt_pk_bf16_f32 v49, v74, v75
 v_cvt_pk_bf16_f32 v50, v76, v77
 v_cvt_pk_bf16_f32 v51, v78, v79
 s_nop 1
 v_mfma_f32_32x32x16_bf16 a[152:167], v[48:51], v[192:195], a[152:167]
 v_cvt_pk_bf16_f32 v52, v80, v81
 v_cvt_pk_bf16_f32 v53, v82, v83
 v_cvt_pk_bf16_f32 v54, v84, v85
 v_cvt_pk_bf16_f32 v55, v86, v87
 s_nop 1
 v_mfma_f32_32x32x16_bf16 a[152:167], v[52:55], v[196:199], a[152:167]
 v_mfma_f32_32x32x16_bf16 a[168:183], v[8:11], a[8:11], a[184:199]
 v_mfma_f32_32x32x16_bf16 a[168:183], v[12:15], a[12:15], a[168:183]
 s_add_u32 s85, s49, s96
 buffer_load_dwordx4 a[216:219], v6, s[24:27], s85 offen offset:0 sc1
 s_add_u32 m0, s86, 12288
 s_lshl_b32 s87, s57, 6
 buffer_load_dwordx4 v244, s[8:11], s87 offen lds
 v_mfma_f32_32x32x16_bf16 a[168:183], v[16:19], a[56:59], a[168:183]
 s_nop 3
 ds_write_b128 v248, a[152:155] offset:0
 v_mfma_f32_32x32x16_bf16 a[168:183], v[20:23], a[60:63], a[168:183]
 v_mfma_f32_32x32x16_bf16 a[168:183], v[24:27], a[104:107], a[168:183]
 buffer_load_dwordx4 a[220:223], v6, s[24:27], s85 offen offset:1024 sc1
 v_mfma_f32_32x32x16_bf16 a[168:183], v[28:31], a[108:111], a[168:183]
 s_add_u32 m0, s86, 16384
 s_lshl_b32 s87, s57, 6
 buffer_load_dwordx4 v245, s[8:11], s87 offen lds
 v_mfma_f32_32x32x16_bf16 a[168:183], v[32:35], v[104:107], a[168:183]
 ds_write_b128 v249, a[156:159] offset:0
 v_mfma_f32_32x32x16_bf16 a[168:183], v[36:39], v[108:111], a[168:183]
 ds_write_b128 v250, a[160:163] offset:0
 s_add_u32 s85, s49, s97
 buffer_load_dwordx4 a[224:227], v6, s[24:27], s85 offen offset:0 sc1
 v_mfma_f32_32x32x16_bf16 a[168:183], v[40:43], v[152:155], a[168:183]
 v_mfma_f32_32x32x16_bf16 a[168:183], v[44:47], v[156:159], a[168:183]
 s_add_u32 m0, s86, 20480
 s_lshl_b32 s87, s57, 6
 buffer_load_dwordx4 v246, s[8:11], s87 offen lds
 v_mfma_f32_32x32x16_bf16 a[168:183], v[48:51], v[200:203], a[168:183]
 buffer_load_dwordx4 a[228:231], v6, s[24:27], s85 offen offset:1024 sc1
 v_mfma_f32_32x32x16_bf16 a[168:183], v[52:55], v[204:207], a[168:183]
 ds_write_b128 v251, a[164:167] offset:0
 v_mfma_f32_32x32x16_bf16 a[152:167], v[8:11], a[16:19], a[184:199]
 v_mfma_f32_32x32x16_bf16 a[152:167], v[12:15], a[20:23], a[152:167]
 s_add_u32 s85, s49, s98
 buffer_load_dwordx4 a[232:235], v6, s[24:27], s85 offen offset:0 sc1
 s_add_u32 m0, s86, 24576
 s_lshl_b32 s87, s58, 6
 buffer_load_dwordx4 v244, s[8:11], s87 offen lds
 v_mfma_f32_32x32x16_bf16 a[152:167], v[16:19], a[64:67], a[152:167]
 v_mfma_f32_32x32x16_bf16 a[152:167], v[20:23], a[68:71], a[152:167]
 s_nop 1
 ds_write_b128 v248, a[168:171] offset:4096
 v_mfma_f32_32x32x16_bf16 a[152:167], v[24:27], a[112:115], a[152:167]
 buffer_load_dwordx4 a[236:239], v6, s[24:27], s85 offen offset:1024 sc1
 v_mfma_f32_32x32x16_bf16 a[152:167], v[28:31], a[116:119], a[152:167]
 ds_write_b128 v249, a[172:175] offset:4096
 s_add_u32 m0, s86, 28672
 s_lshl_b32 s87, s58, 6
 buffer_load_dwordx4 v245, s[8:11], s87 offen lds
 v_mfma_f32_32x32x16_bf16 a[152:167], v[32:35], v[112:115], a[152:167]
 v_mfma_f32_32x32x16_bf16 a[152:167], v[36:39], v[116:119], a[152:167]
 ds_write_b128 v250, a[176:179] offset:4096
 s_add_u32 s85, s49, s99
 buffer_load_dwordx4 a[240:243], v6, s[24:27], s85 offen offset:0 sc1
 v_mfma_f32_32x32x16_bf16 a[152:167], v[40:43], v[160:163], a[152:167]
 v_mfma_f32_32x32x16_bf16 a[152:167], v[44:47], v[164:167], a[152:167]
 ds_write_b128 v251, a[180:183] offset:4096
 s_add_u32 m0, s86, 32768
 s_lshl_b32 s87, s58, 6
 buffer_load_dwordx4 v246, s[8:11], s87 offen lds
 v_mfma_f32_32x32x16_bf16 a[152:167], v[48:51], v[208:211], a[152:167]
 buffer_load_dwordx4 a[244:247], v6, s[24:27], s85 offen offset:1024 sc1
 v_mfma_f32_32x32x16_bf16 a[152:167], v[52:55], v[212:215], a[152:167]
 v_mfma_f32_32x32x16_bf16 a[168:183], v[8:11], a[24:27], a[184:199]
 s_waitcnt lgkmcnt(0)
 s_barrier
 ds_read_b128 v[88:91], v252 offset:0
 ds_read_b128 v[92:95], v253 offset:0
 ds_read_b128 v[96:99], v252 offset:8192
 ds_read_b128 v[100:103], v253 offset:8192
 v_mfma_f32_32x32x16_bf16 a[168:183], v[12:15], a[28:31], a[168:183]
 s_add_u32 m0, s86, 36864
 s_lshl_b32 s87, s59, 6
 buffer_load_dwordx4 v244, s[8:11], s87 offen lds
 v_mfma_f32_32x32x16_bf16 a[168:183], v[16:19], a[72:75], a[168:183]
 ds_write_b128 v248, a[152:155] offset:32768
 v_mfma_f32_32x32x16_bf16 a[168:183], v[20:23], a[76:79], a[168:183]
 s_waitcnt lgkmcnt(1)
 v_add_f32 v88, v88, v96
 v_add_f32 v89, v89, v97
 v_add_f32 v90, v90, v98
 v_add_f32 v91, v91, v99
 v_mfma_f32_32x32x16_bf16 a[168:183], v[24:27], a[120:123], a[168:183]
 v_add_f32 v92, v92, v100
 v_add_f32 v93, v93, v101
 v_add_f32_e64 v94, v94, v102
 v_add_f32 v95, v95, v103
 v_mfma_f32_32x32x16_bf16 a[168:183], v[28:31], a[124:127], a[168:183]
 ds_read_b128 v[96:99], v252 offset:16384
 ds_read_b128 v[100:103], v253 offset:16384
 s_add_u32 m0, s86, 40960
 s_lshl_b32 s87, s59, 6
 buffer_load_dwordx4 v245, s[8:11], s87 offen lds
 v_mfma_f32_32x32x16_bf16 a[168:183], v[32:35], v[120:123], a[168:183]
 ds_write_b128 v249, a[156:159] offset:32768
 v_mfma_f32_32x32x16_bf16 a[168:183], v[36:39], v[124:127], a[168:183]
 ds_write_b128 v250, a[160:163] offset:32768
 v_mfma_f32_32x32x16_bf16 a[168:183], v[40:43], v[168:171], a[168:183]
 s_waitcnt lgkmcnt(2)
 v_add_f32 v88, v88, v96
 v_add_f32 v89, v89, v97
 v_add_f32 v90, v90, v98
 v_add_f32_e64 v91, v91, v99
 v_mfma_f32_32x32x16_bf16 a[168:183], v[44:47], v[172:175], a[168:183]
 s_add_u32 m0, s86, 45056
 s_lshl_b32 s87, s59, 6
 buffer_load_dwordx4 v246, s[8:11], s87 offen lds
 v_add_f32 v92, v92, v100
 v_add_f32 v93, v93, v101
 v_add_f32 v94, v94, v102
 v_add_f32 v95, v95, v103
 v_mfma_f32_32x32x16_bf16 a[168:183], v[48:51], v[216:219], a[168:183]
 ds_read_b128 v[96:99], v252 offset:24576
 ds_read_b128 v[100:103], v253 offset:24576
 s_waitcnt vmcnt(23)
 ds_read_b128 v[240:243], v0 offset:0
 v_mfma_f32_32x32x16_bf16 a[168:183], v[52:55], v[220:223], a[168:183]
 ds_write_b128 v251, a[164:167] offset:32768
 v_mfma_f32_32x32x16_bf16 a[152:167], v[8:11], a[32:35], a[184:199]
 v_mfma_f32_32x32x16_bf16 a[152:167], v[12:15], a[36:39], a[152:167]
 s_add_u32 m0, s86, 49152
 s_lshl_b32 s87, s60, 6
 buffer_load_dwordx4 v244, s[8:11], s87 offen lds
 s_waitcnt lgkmcnt(1)
 v_add_f32 v88, v88, v96
 v_add_f32 v89, v89, v97
 v_add_f32 v90, v90, v98
 v_add_f32 v91, v91, v99
 v_mfma_f32_32x32x16_bf16 a[152:167], v[16:19], a[80:83], a[152:167]
 v_add_f32 v92, v92, v100
 v_add_f32 v93, v93, v101
 v_add_f32 v94, v94, v102
 v_add_f32 v95, v95, v103
 v_mfma_f32_32x32x16_bf16 a[152:167], v[20:23], a[84:87], a[152:167]
 ds_write_b128 v248, a[168:171] offset:36864
 v_mfma_f32_32x32x16_bf16 a[152:167], v[24:27], a[128:131], a[152:167]
 v_lshlrev_b32_e64 v96, 16, v240
 v_and_b32 v97, 0xffff0000, v240
 v_lshlrev_b32_e64 v98, 16, v241
 v_and_b32 v99, 0xffff0000, v241
 v_mfma_f32_32x32x16_bf16 a[152:167], v[28:31], a[132:135], a[152:167]
 ds_write_b128 v249, a[172:175] offset:36864
 s_add_u32 m0, s86, 53248
 s_lshl_b32 s87, s60, 6
 buffer_load_dwordx4 v245, s[8:11], s87 offen lds
 v_mfma_f32_32x32x16_bf16 a[152:167], v[32:35], v[128:131], a[152:167]
 v_lshlrev_b32 v100, 16, v242
 v_and_b32 v101, 0xffff0000, v242
 v_lshlrev_b32_e64 v102, 16, v243
 v_and_b32 v103, 0xffff0000, v243
 v_mfma_f32_32x32x16_bf16 a[152:167], v[36:39], v[132:135], a[152:167]
 ds_write_b128 v250, a[176:179] offset:36864
 ds_read_b128 a[248:251], v3 offset:0
 v_mfma_f32_32x32x16_bf16 a[152:167], v[40:43], v[176:179], a[152:167]
 v_add_f32 v88, v88, v96
 v_add_f32 v89, v89, v97
 v_add_f32 v90, v90, v98
 v_add_f32 v91, v91, v99
 v_mfma_f32_32x32x16_bf16 a[152:167], v[44:47], v[180:183], a[152:167]
 ds_write_b128 v251, a[180:183] offset:36864
 ds_read_b128 a[252:255], v4 offset:0
 s_add_u32 m0, s86, 57344
 s_lshl_b32 s87, s60, 6
 buffer_load_dwordx4 v246, s[8:11], s87 offen lds
 v_mfma_f32_32x32x16_bf16 a[152:167], v[48:51], v[224:227], a[152:167]
 v_add_f32 v92, v92, v100
 v_add_f32 v93, v93, v101
 v_add_f32 v94, v94, v102
 v_add_f32_e64 v95, v95, v103
 v_mfma_f32_32x32x16_bf16 a[152:167], v[52:55], v[228:231], a[152:167]
 v_cvt_pk_bf16_f32 v240, v88, v89
 v_cvt_pk_bf16_f32 v241, v90, v91
 v_cvt_pk_bf16_f32 v242, v92, v93
 v_cvt_pk_bf16_f32 v243, v94, v95
 v_mfma_f32_32x32x16_bf16 a[168:183], v[8:11], a[40:43], a[184:199]
 s_waitcnt lgkmcnt(1)
 s_barrier
 ds_read_b128 v[88:91], v252 offset:32768
 ds_read_b128 v[92:95], v253 offset:32768
 ds_read_b128 v[96:99], v252 offset:40960
 ds_read_b128 v[100:103], v253 offset:40960
 s_waitcnt vmcnt(23)
 v_mfma_f32_32x32x16_bf16 v[56:71], a[248:251], a[200:203], 0
 s_lshl_b32 s6, s56, 6
 buffer_store_dwordx4 v[240:243], v244, s[20:23], s6 offen sc1 nt
 ds_read_b128 a[248:251], v3 offset:544
 s_add_u32 m0, s86, 61440
 s_lshl_b32 s87, s61, 6
 buffer_load_dwordx4 v244, s[8:11], s87 offen lds
 v_mfma_f32_32x32x16_bf16 a[168:183], v[12:15], a[44:47], a[168:183]
 s_lshl_b32 s6, s57, 7
 v_add_u32_e64 v7, s6, v5
 ds_read_b128 a[184:187], v7 offset:0
 ds_read_b128 a[188:191], v7 offset:32
 ds_read_b128 a[192:195], v7 offset:64
 ds_read_b128 a[196:199], v7 offset:96
 s_waitcnt vmcnt(24) lgkmcnt(9)
 v_mfma_f32_32x32x16_bf16 v[56:71], a[252:255], a[204:207], v[56:71]
 ds_read_b128 a[252:255], v4 offset:544
 v_mfma_f32_32x32x16_bf16 a[168:183], v[16:19], a[88:91], a[168:183]
 ds_write_b128 v248, a[152:155] offset:0
 s_waitcnt vmcnt(23) lgkmcnt(6)
 v_mfma_f32_32x32x16_bf16 v[72:87], a[248:251], a[208:211], 0
 ds_read_b128 a[248:251], v3 offset:1088
 s_add_u32 m0, s86, 65536
 s_lshl_b32 s87, s61, 6
 buffer_load_dwordx4 v245, s[8:11], s87 offen lds
 v_mfma_f32_32x32x16_bf16 a[168:183], v[20:23], a[92:95], a[168:183]
 v_add_f32 v88, v88, v96
 v_add_f32 v89, v89, v97
 v_add_f32 v90, v90, v98
 v_add_f32 v91, v91, v99
 v_cvt_pk_bf16_f32 v8, v56, v57
 v_cvt_pk_bf16_f32 v9, v58, v59
 s_waitcnt vmcnt(23) lgkmcnt(2)
 v_mfma_f32_32x32x16_bf16 v[72:87], a[252:255], a[212:215], v[72:87]
 ds_read_b128 a[252:255], v4 offset:1088
 v_cvt_pk_bf16_f32 v10, v60, v61
 v_cvt_pk_bf16_f32 v11, v62, v63
 v_cvt_pk_bf16_f32 v12, v64, v65
 v_cvt_pk_bf16_f32 v13, v66, v67
 v_mfma_f32_32x32x16_bf16 a[168:183], v[24:27], a[136:139], a[168:183]
 v_add_f32 v92, v92, v100
 v_add_f32 v93, v93, v101
 v_add_f32_e64 v94, v94, v102
 v_add_f32 v95, v95, v103
 v_cvt_pk_bf16_f32 v14, v68, v69
 v_cvt_pk_bf16_f32 v15, v70, v71
 s_waitcnt vmcnt(22) lgkmcnt(1)
 v_mfma_f32_32x32x16_bf16 v[56:71], a[248:251], a[216:219], 0
 ds_read_b128 a[248:251], v3 offset:1632
 s_add_u32 m0, s86, 69632
 s_lshl_b32 s87, s61, 6
 buffer_load_dwordx4 v246, s[8:11], s87 offen lds
 v_mfma_f32_32x32x16_bf16 a[168:183], v[28:31], a[140:143], a[168:183]
 ds_read_b128 v[96:99], v252 offset:49152
 ds_read_b128 v[100:103], v253 offset:49152
 v_cvt_pk_bf16_f32 v16, v72, v73
 v_cvt_pk_bf16_f32 v17, v74, v75
 s_waitcnt vmcnt(21) lgkmcnt(3)
 v_mfma_f32_32x32x16_bf16 v[56:71], a[252:255], a[220:223], v[56:71]
 ds_read_b128 a[252:255], v4 offset:1632
 v_cvt_pk_bf16_f32 v18, v76, v77
 v_cvt_pk_bf16_f32 v19, v78, v79
 v_cvt_pk_bf16_f32 v20, v80, v81
 v_cvt_pk_bf16_f32 v21, v82, v83
 v_mfma_f32_32x32x16_bf16 a[168:183], v[32:35], v[136:139], a[168:183]
 ds_write_b128 v249, a[156:159] offset:0
 v_cvt_pk_bf16_f32 v22, v84, v85
 v_cvt_pk_bf16_f32 v23, v86, v87
 s_waitcnt vmcnt(19) lgkmcnt(4)
 v_mfma_f32_32x32x16_bf16 v[72:87], a[248:251], a[224:227], 0
 ds_read_b128 a[248:251], v3 offset:2176
 v_mfma_f32_32x32x16_bf16 a[168:183], v[36:39], v[140:143], a[168:183]
 ds_write_b128 v250, a[160:163] offset:0
 v_cvt_pk_bf16_f32 v24, v56, v57
 v_cvt_pk_bf16_f32 v25, v58, v59
 s_waitcnt vmcnt(17) lgkmcnt(3)
 v_mfma_f32_32x32x16_bf16 v[72:87], a[252:255], a[228:231], v[72:87]
 ds_read_b128 a[252:255], v4 offset:2176
 v_cvt_pk_bf16_f32 v26, v60, v61
 v_cvt_pk_bf16_f32 v27, v62, v63
 v_cvt_pk_bf16_f32 v28, v64, v65
 v_cvt_pk_bf16_f32 v29, v66, v67
 v_mfma_f32_32x32x16_bf16 a[168:183], v[40:43], v[184:187], a[168:183]
 v_add_f32 v88, v88, v96
 v_add_f32 v89, v89, v97
 v_add_f32_e64 v90, v90, v98
 v_add_f32 v91, v91, v99
 v_cvt_pk_bf16_f32 v30, v68, v69
 v_cvt_pk_bf16_f32 v31, v70, v71
 s_waitcnt vmcnt(16) lgkmcnt(2)
 v_mfma_f32_32x32x16_bf16 v[56:71], a[248:251], a[232:235], 0
 ds_read_b128 a[248:251], v3 offset:2720
 v_mfma_f32_32x32x16_bf16 a[168:183], v[44:47], v[188:191], a[168:183]
 v_add_f32 v92, v92, v100
 v_add_f32 v93, v93, v101
 v_add_f32_e64 v94, v94, v102
 v_add_f32 v95, v95, v103
 v_cvt_pk_bf16_f32 v32, v72, v73
 v_cvt_pk_bf16_f32 v33, v74, v75
 s_waitcnt vmcnt(14) lgkmcnt(1)
 v_mfma_f32_32x32x16_bf16 v[56:71], a[252:255], a[236:239], v[56:71]
 ds_read_b128 a[252:255], v4 offset:2720
 v_cvt_pk_bf16_f32 v34, v76, v77
 v_cvt_pk_bf16_f32 v35, v78, v79
 v_cvt_pk_bf16_f32 v36, v80, v81
 v_cvt_pk_bf16_f32 v37, v82, v83
 v_mfma_f32_32x32x16_bf16 a[168:183], v[48:51], v[232:235], a[168:183]
 ds_read_b128 v[96:99], v252 offset:57344
 ds_read_b128 v[100:103], v253 offset:57344
 ds_read_b128 v[240:243], v0 offset:4096
 v_cvt_pk_bf16_f32 v38, v84, v85
 v_cvt_pk_bf16_f32 v39, v86, v87
 s_waitcnt vmcnt(12) lgkmcnt(4)
 v_mfma_f32_32x32x16_bf16 v[72:87], a[248:251], a[240:243], 0
 v_mfma_f32_32x32x16_bf16 a[168:183], v[52:55], v[236:239], a[168:183]
 ds_write_b128 v251, a[164:167] offset:0
 v_cvt_pk_bf16_f32 v40, v56, v57
 v_cvt_pk_bf16_f32 v41, v58, v59
 s_waitcnt vmcnt(10) lgkmcnt(4)
 v_mfma_f32_32x32x16_bf16 v[72:87], a[252:255], a[244:247], v[72:87]
 v_cvt_pk_bf16_f32 v42, v60, v61
 v_cvt_pk_bf16_f32 v43, v62, v63
 v_cvt_pk_bf16_f32 v44, v64, v65
 v_cvt_pk_bf16_f32 v45, v66, v67
 v_mfma_f32_32x32x16_bf16 a[152:167], v[8:11], a[0:3], a[184:199]
 v_cvt_pk_bf16_f32 v46, v68, v69
 v_cvt_pk_bf16_f32 v47, v70, v71
 v_mfma_f32_32x32x16_bf16 a[152:167], v[12:15], a[4:7], a[152:167]
 s_mul_i32 s49, s58, 49152
 s_add_u32 s49, s49, 0x380000
 s_add_u32 s85, s49, s94
 buffer_load_dwordx4 a[200:203], v6, s[24:27], s85 offen offset:0 sc1
 s_waitcnt lgkmcnt(1)
 v_add_f32 v88, v88, v96
 v_add_f32 v89, v89, v97
 v_add_f32 v90, v90, v98
 v_add_f32 v91, v91, v99
 v_mfma_f32_32x32x16_bf16 a[152:167], v[16:19], a[48:51], a[152:167]
 v_add_f32 v92, v92, v100
 v_add_f32 v93, v93, v101
 v_add_f32 v94, v94, v102
 v_add_f32 v95, v95, v103
 v_cvt_pk_bf16_f32 v48, v72, v73
 v_cvt_pk_bf16_f32 v49, v74, v75
 v_mfma_f32_32x32x16_bf16 a[152:167], v[20:23], a[52:55], a[152:167]
 ds_write_b128 v248, a[168:171] offset:4096
 v_cvt_pk_bf16_f32 v50, v76, v77
 v_cvt_pk_bf16_f32 v51, v78, v79
 v_cvt_pk_bf16_f32 v52, v80, v81
 v_cvt_pk_bf16_f32 v53, v82, v83
 v_mfma_f32_32x32x16_bf16 a[152:167], v[24:27], a[96:99], a[152:167]
 buffer_load_dwordx4 a[204:207], v6, s[24:27], s85 offen offset:1024 sc1
 v_lshlrev_b32_e64 v96, 16, v240
 v_and_b32 v97, 0xffff0000, v240
 v_lshlrev_b32_e64 v98, 16, v241
 v_and_b32 v99, 0xffff0000, v241
 v_cvt_pk_bf16_f32 v54, v84, v85
 v_cvt_pk_bf16_f32 v55, v86, v87
 v_mfma_f32_32x32x16_bf16 a[152:167], v[28:31], a[100:103], a[152:167]
 ds_write_b128 v249, a[172:175] offset:4096
 v_mfma_f32_32x32x16_bf16 a[152:167], v[32:35], a[144:147], a[152:167]
 v_lshlrev_b32_e64 v100, 16, v242
 v_and_b32 v101, 0xffff0000, v242
 v_lshlrev_b32_e64 v102, 16, v243
 v_and_b32 v103, 0xffff0000, v243
 v_mfma_f32_32x32x16_bf16 a[152:167], v[36:39], a[148:151], a[152:167]
 ds_write_b128 v250, a[176:179] offset:4096
 s_add_u32 s85, s49, s95
 buffer_load_dwordx4 a[208:211], v6, s[24:27], s85 offen offset:0 sc1
 v_mfma_f32_32x32x16_bf16 a[152:167], v[40:43], v[144:147], a[152:167]
 v_add_f32 v88, v88, v96
 v_add_f32 v89, v89, v97
 v_add_f32 v90, v90, v98
 v_add_f32_e64 v91, v91, v99
 v_mfma_f32_32x32x16_bf16 a[152:167], v[44:47], v[148:151], a[152:167]
 ds_write_b128 v251, a[180:183] offset:4096
 v_mfma_f32_32x32x16_bf16 a[152:167], v[48:51], v[192:195], a[152:167]
 buffer_load_dwordx4 a[212:215], v6, s[24:27], s85 offen offset:1024 sc1
 v_add_f32 v92, v92, v100
 v_add_f32 v93, v93, v101
 v_add_f32 v94, v94, v102
 v_add_f32 v95, v95, v103
 v_mfma_f32_32x32x16_bf16 a[152:167], v[52:55], v[196:199], a[152:167]
 v_cvt_pk_bf16_f32 v240, v88, v89
 v_cvt_pk_bf16_f32 v241, v90, v91
 v_cvt_pk_bf16_f32 v242, v92, v93
 v_cvt_pk_bf16_f32 v243, v94, v95
 v_mfma_f32_32x32x16_bf16 a[168:183], v[8:11], a[8:11], a[184:199]
 s_waitcnt lgkmcnt(0)
 s_barrier
 ds_read_b128 v[88:91], v252 offset:0
 ds_read_b128 v[92:95], v253 offset:0
 ds_read_b128 v[96:99], v252 offset:8192
 ds_read_b128 v[100:103], v253 offset:8192
 v_mfma_f32_32x32x16_bf16 a[168:183], v[12:15], a[12:15], a[168:183]
 s_lshl_b32 s6, s56, 6
 buffer_store_dwordx4 v[240:243], v245, s[20:23], s6 offen sc1 nt
 s_add_u32 s85, s49, s96
 buffer_load_dwordx4 a[216:219], v6, s[24:27], s85 offen offset:0 sc1
 v_mfma_f32_32x32x16_bf16 a[168:183], v[16:19], a[56:59], a[168:183]
 ds_write_b128 v248, a[152:155] offset:32768
 v_mfma_f32_32x32x16_bf16 a[168:183], v[20:23], a[60:63], a[168:183]
 s_waitcnt lgkmcnt(1)
 v_add_f32 v88, v88, v96
 v_add_f32 v89, v89, v97
 v_add_f32 v90, v90, v98
 v_add_f32_e64 v91, v91, v99
 v_mfma_f32_32x32x16_bf16 a[168:183], v[24:27], a[104:107], a[168:183]
 buffer_load_dwordx4 a[220:223], v6, s[24:27], s85 offen offset:1024 sc1
 v_add_f32 v92, v92, v100
 v_add_f32 v93, v93, v101
 v_add_f32 v94, v94, v102
 v_add_f32 v95, v95, v103
 v_mfma_f32_32x32x16_bf16 a[168:183], v[28:31], a[108:111], a[168:183]
 ds_read_b128 v[96:99], v252 offset:16384
 ds_read_b128 v[100:103], v253 offset:16384
 v_mfma_f32_32x32x16_bf16 a[168:183], v[32:35], v[104:107], a[168:183]
 ds_write_b128 v249, a[156:159] offset:32768
 v_mfma_f32_32x32x16_bf16 a[168:183], v[36:39], v[108:111], a[168:183]
 ds_write_b128 v250, a[160:163] offset:32768
 s_add_u32 s85, s49, s97
 buffer_load_dwordx4 a[224:227], v6, s[24:27], s85 offen offset:0 sc1
 v_mfma_f32_32x32x16_bf16 a[168:183], v[40:43], v[152:155], a[168:183]
 s_waitcnt lgkmcnt(2)
 v_add_f32 v88, v88, v96
 v_add_f32 v89, v89, v97
 v_add_f32 v90, v90, v98
 v_add_f32 v91, v91, v99
 v_mfma_f32_32x32x16_bf16 a[168:183], v[44:47], v[156:159], a[168:183]
 v_add_f32 v92, v92, v100
 v_add_f32 v93, v93, v101
 v_add_f32 v94, v94, v102
 v_add_f32 v95, v95, v103
 v_mfma_f32_32x32x16_bf16 a[168:183], v[48:51], v[200:203], a[168:183]
 ds_read_b128 v[96:99], v252 offset:24576
 ds_read_b128 v[100:103], v253 offset:24576
 ds_read_b128 v[240:243], v0 offset:8192
 buffer_load_dwordx4 a[228:231], v6, s[24:27], s85 offen offset:1024 sc1
 v_mfma_f32_32x32x16_bf16 a[168:183], v[52:55], v[204:207], a[168:183]
 ds_write_b128 v251, a[164:167] offset:32768
 v_mfma_f32_32x32x16_bf16 a[152:167], v[8:11], a[16:19], a[184:199]
 v_mfma_f32_32x32x16_bf16 a[152:167], v[12:15], a[20:23], a[152:167]
 s_add_u32 s85, s49, s98
 buffer_load_dwordx4 a[232:235], v6, s[24:27], s85 offen offset:0 sc1
 s_waitcnt lgkmcnt(1)
 v_add_f32 v88, v88, v96
 v_add_f32 v89, v89, v97
 v_add_f32 v90, v90, v98
 v_add_f32 v91, v91, v99
 v_mfma_f32_32x32x16_bf16 a[152:167], v[16:19], a[64:67], a[152:167]
 v_add_f32 v92, v92, v100
 v_add_f32 v93, v93, v101
 v_add_f32 v94, v94, v102
 v_add_f32 v95, v95, v103
 v_mfma_f32_32x32x16_bf16 a[152:167], v[20:23], a[68:71], a[152:167]
 ds_write_b128 v248, a[168:171] offset:36864
 v_mfma_f32_32x32x16_bf16 a[152:167], v[24:27], a[112:115], a[152:167]
 buffer_load_dwordx4 a[236:239], v6, s[24:27], s85 offen offset:1024 sc1
 v_lshlrev_b32_e64 v96, 16, v240
 v_and_b32 v97, 0xffff0000, v240
 v_lshlrev_b32_e64 v98, 16, v241
 v_and_b32 v99, 0xffff0000, v241
 v_mfma_f32_32x32x16_bf16 a[152:167], v[28:31], a[116:119], a[152:167]
 ds_write_b128 v249, a[172:175] offset:36864
 v_mfma_f32_32x32x16_bf16 a[152:167], v[32:35], v[112:115], a[152:167]
 v_lshlrev_b32_e64 v100, 16, v242
 v_and_b32 v101, 0xffff0000, v242
 v_lshlrev_b32_e64 v102, 16, v243
 v_and_b32 v103, 0xffff0000, v243
 v_mfma_f32_32x32x16_bf16 a[152:167], v[36:39], v[116:119], a[152:167]
 ds_write_b128 v250, a[176:179] offset:36864
 s_add_u32 s85, s49, s99
 buffer_load_dwordx4 a[240:243], v6, s[24:27], s85 offen offset:0 sc1
 v_mfma_f32_32x32x16_bf16 a[152:167], v[40:43], v[160:163], a[152:167]
 v_add_f32 v88, v88, v96
 v_add_f32 v89, v89, v97
 v_add_f32 v90, v90, v98
 v_add_f32_e64 v91, v91, v99
 v_mfma_f32_32x32x16_bf16 a[152:167], v[44:47], v[164:167], a[152:167]
 ds_write_b128 v251, a[180:183] offset:36864
 v_mfma_f32_32x32x16_bf16 a[152:167], v[48:51], v[208:211], a[152:167]
 buffer_load_dwordx4 a[244:247], v6, s[24:27], s85 offen offset:1024 sc1
 v_add_f32 v92, v92, v100
 v_add_f32 v93, v93, v101
 v_add_f32 v94, v94, v102
 v_add_f32 v95, v95, v103
 v_mfma_f32_32x32x16_bf16 a[152:167], v[52:55], v[212:215], a[152:167]
 v_cvt_pk_bf16_f32 v240, v88, v89
 v_cvt_pk_bf16_f32 v241, v90, v91
 v_cvt_pk_bf16_f32 v242, v92, v93
 v_cvt_pk_bf16_f32 v243, v94, v95
 v_mfma_f32_32x32x16_bf16 a[168:183], v[8:11], a[24:27], a[184:199]
 s_waitcnt lgkmcnt(0)
 s_barrier
 ds_read_b128 v[88:91], v252 offset:32768
 ds_read_b128 v[92:95], v253 offset:32768
 ds_read_b128 v[96:99], v252 offset:40960
 ds_read_b128 v[100:103], v253 offset:40960
 v_mfma_f32_32x32x16_bf16 a[168:183], v[12:15], a[28:31], a[168:183]
 s_lshl_b32 s6, s56, 6
 buffer_store_dwordx4 v[240:243], v246, s[20:23], s6 offen sc1 nt
 v_mfma_f32_32x32x16_bf16 a[168:183], v[16:19], a[72:75], a[168:183]
 ds_write_b128 v248, a[152:155] offset:0
 v_mfma_f32_32x32x16_bf16 a[168:183], v[20:23], a[76:79], a[168:183]
 s_waitcnt lgkmcnt(1)
 v_add_f32 v88, v88, v96
 v_add_f32 v89, v89, v97
 v_add_f32 v90, v90, v98
 v_add_f32 v91, v91, v99
 v_mfma_f32_32x32x16_bf16 a[168:183], v[24:27], a[120:123], a[168:183]
 v_add_f32 v92, v92, v100
 v_add_f32 v93, v93, v101
 v_add_f32 v94, v94, v102
 v_add_f32 v95, v95, v103
 v_mfma_f32_32x32x16_bf16 a[168:183], v[28:31], a[124:127], a[168:183]
 ds_read_b128 v[96:99], v252 offset:49152
 ds_read_b128 v[100:103], v253 offset:49152
 v_mfma_f32_32x32x16_bf16 a[168:183], v[32:35], v[120:123], a[168:183]
 ds_write_b128 v249, a[156:159] offset:0
 v_mfma_f32_32x32x16_bf16 a[168:183], v[36:39], v[124:127], a[168:183]
 ds_write_b128 v250, a[160:163] offset:0
 v_mfma_f32_32x32x16_bf16 a[168:183], v[40:43], v[168:171], a[168:183]
 s_waitcnt lgkmcnt(2)
 v_add_f32 v88, v88, v96
 v_add_f32 v89, v89, v97
 v_add_f32 v90, v90, v98
 v_add_f32_e64 v91, v91, v99
 v_mfma_f32_32x32x16_bf16 a[168:183], v[44:47], v[172:175], a[168:183]
 v_add_f32 v92, v92, v100
 v_add_f32 v93, v93, v101
 v_add_f32 v94, v94, v102
 v_add_f32 v95, v95, v103
 v_mfma_f32_32x32x16_bf16 a[168:183], v[48:51], v[216:219], a[168:183]
 ds_read_b128 v[96:99], v252 offset:57344
 ds_read_b128 v[100:103], v253 offset:57344
 ds_read_b128 v[240:243], v0 offset:12288
 v_mfma_f32_32x32x16_bf16 a[168:183], v[52:55], v[220:223], a[168:183]
 ds_write_b128 v251, a[164:167] offset:0
 v_mfma_f32_32x32x16_bf16 a[152:167], v[8:11], a[32:35], a[184:199]
 v_mfma_f32_32x32x16_bf16 a[152:167], v[12:15], a[36:39], a[152:167]
 s_waitcnt lgkmcnt(1)
 v_add_f32 v88, v88, v96
 v_add_f32 v89, v89, v97
 v_add_f32 v90, v90, v98
 v_add_f32_e64 v91, v91, v99
 v_mfma_f32_32x32x16_bf16 a[152:167], v[16:19], a[80:83], a[152:167]
 v_add_f32 v92, v92, v100
 v_add_f32 v93, v93, v101
 v_add_f32 v94, v94, v102
 v_add_f32 v95, v95, v103
 v_mfma_f32_32x32x16_bf16 a[152:167], v[20:23], a[84:87], a[152:167]
 ds_write_b128 v248, a[168:171] offset:4096
 v_mfma_f32_32x32x16_bf16 a[152:167], v[24:27], a[128:131], a[152:167]
 v_lshlrev_b32_e64 v96, 16, v240
 v_and_b32 v97, 0xffff0000, v240
 v_lshlrev_b32_e64 v98, 16, v241
 v_and_b32 v99, 0xffff0000, v241
 v_mfma_f32_32x32x16_bf16 a[152:167], v[28:31], a[132:135], a[152:167]
 ds_write_b128 v249, a[172:175] offset:4096
 v_mfma_f32_32x32x16_bf16 a[152:167], v[32:35], v[128:131], a[152:167]
 v_lshlrev_b32_e64 v100, 16, v242
 v_and_b32 v101, 0xffff0000, v242
 v_lshlrev_b32_e64 v102, 16, v243
 v_and_b32 v103, 0xffff0000, v243
 v_mfma_f32_32x32x16_bf16 a[152:167], v[36:39], v[132:135], a[152:167]
 ds_write_b128 v250, a[176:179] offset:4096
 ds_read_b128 a[248:251], v3 offset:0
 v_mfma_f32_32x32x16_bf16 a[152:167], v[40:43], v[176:179], a[152:167]
 v_add_f32 v88, v88, v96
 v_add_f32 v89, v89, v97
 v_add_f32 v90, v90, v98
 v_add_f32 v91, v91, v99
 v_mfma_f32_32x32x16_bf16 a[152:167], v[44:47], v[180:183], a[152:167]
 ds_write_b128 v251, a[180:183] offset:4096
 ds_read_b128 a[252:255], v4 offset:0
 v_mfma_f32_32x32x16_bf16 a[152:167], v[48:51], v[224:227], a[152:167]
 v_add_f32 v92, v92, v100
 v_add_f32 v93, v93, v101
 v_add_f32 v94, v94, v102
 v_add_f32 v95, v95, v103
 v_mfma_f32_32x32x16_bf16 a[152:167], v[52:55], v[228:231], a[152:167]
 v_cvt_pk_bf16_f32 v240, v88, v89
 v_cvt_pk_bf16_f32 v241, v90, v91
 v_cvt_pk_bf16_f32 v242, v92, v93
 v_cvt_pk_bf16_f32 v243, v94, v95
 v_mfma_f32_32x32x16_bf16 a[168:183], v[8:11], a[40:43], a[184:199]
 s_waitcnt lgkmcnt(1)
 s_barrier
 ds_read_b128 v[88:91], v252 offset:0
 ds_read_b128 v[92:95], v253 offset:0
 ds_read_b128 v[96:99], v252 offset:8192
 ds_read_b128 v[100:103], v253 offset:8192
 s_waitcnt vmcnt(13)
 v_mfma_f32_32x32x16_bf16 v[56:71], a[248:251], a[200:203], 0
 s_lshl_b32 s6, s57, 6
 buffer_store_dwordx4 v[240:243], v244, s[20:23], s6 offen sc1 nt
 ds_read_b128 a[248:251], v3 offset:544
 v_mfma_f32_32x32x16_bf16 a[168:183], v[12:15], a[44:47], a[168:183]
 s_lshl_b32 s6, s58, 7
 v_add_u32 v7, s6, v5
 ds_read_b128 a[184:187], v7 offset:0
 ds_read_b128 a[188:191], v7 offset:32
 ds_read_b128 a[192:195], v7 offset:64
 ds_read_b128 a[196:199], v7 offset:96
 s_waitcnt vmcnt(13) lgkmcnt(9)
 v_mfma_f32_32x32x16_bf16 v[56:71], a[252:255], a[204:207], v[56:71]
 ds_read_b128 a[252:255], v4 offset:544
 v_mfma_f32_32x32x16_bf16 a[168:183], v[16:19], a[88:91], a[168:183]
 ds_write_b128 v248, a[152:155] offset:32768
 s_waitcnt vmcnt(12) lgkmcnt(6)
 v_mfma_f32_32x32x16_bf16 v[72:87], a[248:251], a[208:211], 0
 ds_read_b128 a[248:251], v3 offset:1088
 v_mfma_f32_32x32x16_bf16 a[168:183], v[20:23], a[92:95], a[168:183]
 v_add_f32 v88, v88, v96
 v_add_f32 v89, v89, v97
 v_add_f32 v90, v90, v98
 v_add_f32 v91, v91, v99
 s_nop 0
 v_cvt_pk_bf16_f32 v8, v56, v57
 v_cvt_pk_bf16_f32 v9, v58, v59
 s_waitcnt vmcnt(11) lgkmcnt(2)
 v_mfma_f32_32x32x16_bf16 v[72:87], a[252:255], a[212:215], v[72:87]
 ds_read_b128 a[252:255], v4 offset:1088
 v_cvt_pk_bf16_f32 v10, v60, v61
 v_cvt_pk_bf16_f32 v11, v62, v63
 v_cvt_pk_bf16_f32 v12, v64, v65
 v_cvt_pk_bf16_f32 v13, v66, v67
 v_mfma_f32_32x32x16_bf16 a[168:183], v[24:27], a[136:139], a[168:183]
 v_add_f32 v92, v92, v100
 v_add_f32 v93, v93, v101
 v_add_f32 v94, v94, v102
 v_add_f32 v95, v95, v103
 v_cvt_pk_bf16_f32 v14, v68, v69
 v_cvt_pk_bf16_f32 v15, v70, v71
 s_waitcnt vmcnt(9) lgkmcnt(1)
 v_mfma_f32_32x32x16_bf16 v[56:71], a[248:251], a[216:219], 0
 ds_read_b128 a[248:251], v3 offset:1632
 v_mfma_f32_32x32x16_bf16 a[168:183], v[28:31], a[140:143], a[168:183]
 ds_read_b128 v[96:99], v252 offset:16384
 ds_read_b128 v[100:103], v253 offset:16384
 v_cvt_pk_bf16_f32 v16, v72, v73
 v_cvt_pk_bf16_f32 v17, v74, v75
 s_waitcnt vmcnt(8) lgkmcnt(3)
 v_mfma_f32_32x32x16_bf16 v[56:71], a[252:255], a[220:223], v[56:71]
 ds_read_b128 a[252:255], v4 offset:1632
 v_cvt_pk_bf16_f32 v18, v76, v77
 v_cvt_pk_bf16_f32 v19, v78, v79
 v_cvt_pk_bf16_f32 v20, v80, v81
 v_cvt_pk_bf16_f32 v21, v82, v83
 v_mfma_f32_32x32x16_bf16 a[168:183], v[32:35], v[136:139], a[168:183]
 ds_write_b128 v249, a[156:159] offset:32768
 v_cvt_pk_bf16_f32 v22, v84, v85
 v_cvt_pk_bf16_f32 v23, v86, v87
 s_waitcnt vmcnt(7) lgkmcnt(4)
 v_mfma_f32_32x32x16_bf16 v[72:87], a[248:251], a[224:227], 0
 ds_read_b128 a[248:251], v3 offset:2176
 v_mfma_f32_32x32x16_bf16 a[168:183], v[36:39], v[140:143], a[168:183]
 ds_write_b128 v250, a[160:163] offset:32768
 v_cvt_pk_bf16_f32 v24, v56, v57
 v_cvt_pk_bf16_f32 v25, v58, v59
 s_waitcnt vmcnt(6) lgkmcnt(3)
 v_mfma_f32_32x32x16_bf16 v[72:87], a[252:255], a[228:231], v[72:87]
 ds_read_b128 a[252:255], v4 offset:2176
 v_cvt_pk_bf16_f32 v26, v60, v61
 v_cvt_pk_bf16_f32 v27, v62, v63
 v_cvt_pk_bf16_f32 v28, v64, v65
 v_cvt_pk_bf16_f32 v29, v66, v67
 v_mfma_f32_32x32x16_bf16 a[168:183], v[40:43], v[184:187], a[168:183]
 v_add_f32 v88, v88, v96
 v_add_f32 v89, v89, v97
 v_add_f32_e64 v90, v90, v98
 v_add_f32 v91, v91, v99
 v_cvt_pk_bf16_f32 v30, v68, v69
 v_cvt_pk_bf16_f32 v31, v70, v71
 s_waitcnt vmcnt(5) lgkmcnt(2)
 v_mfma_f32_32x32x16_bf16 v[56:71], a[248:251], a[232:235], 0
 ds_read_b128 a[248:251], v3 offset:2720
 v_mfma_f32_32x32x16_bf16 a[168:183], v[44:47], v[188:191], a[168:183]
 v_add_f32 v92, v92, v100
 v_add_f32 v93, v93, v101
 v_add_f32_e64 v94, v94, v102
 v_add_f32 v95, v95, v103
 v_cvt_pk_bf16_f32 v32, v72, v73
 v_cvt_pk_bf16_f32 v33, v74, v75
 s_waitcnt vmcnt(4) lgkmcnt(1)
 v_mfma_f32_32x32x16_bf16 v[56:71], a[252:255], a[236:239], v[56:71]
 ds_read_b128 a[252:255], v4 offset:2720
 v_cvt_pk_bf16_f32 v34, v76, v77
 v_cvt_pk_bf16_f32 v35, v78, v79
 v_cvt_pk_bf16_f32 v36, v80, v81
 v_cvt_pk_bf16_f32 v37, v82, v83
 v_mfma_f32_32x32x16_bf16 a[168:183], v[48:51], v[232:235], a[168:183]
 ds_read_b128 v[96:99], v252 offset:24576
 ds_read_b128 v[100:103], v253 offset:24576
 ds_read_b128 v[240:243], v0 offset:16384
 v_cvt_pk_bf16_f32 v38, v84, v85
 v_cvt_pk_bf16_f32 v39, v86, v87
 s_waitcnt vmcnt(3) lgkmcnt(4)
 v_mfma_f32_32x32x16_bf16 v[72:87], a[248:251], a[240:243], 0
 v_mfma_f32_32x32x16_bf16 a[168:183], v[52:55], v[236:239], a[168:183]
 ds_write_b128 v251, a[164:167] offset:32768
 v_cvt_pk_bf16_f32 v40, v56, v57
 v_cvt_pk_bf16_f32 v41, v58, v59
 s_waitcnt vmcnt(2) lgkmcnt(4)
 v_mfma_f32_32x32x16_bf16 v[72:87], a[252:255], a[244:247], v[72:87]
 v_cvt_pk_bf16_f32 v42, v60, v61
 v_cvt_pk_bf16_f32 v43, v62, v63
 v_cvt_pk_bf16_f32 v44, v64, v65
 v_cvt_pk_bf16_f32 v45, v66, v67
 v_mfma_f32_32x32x16_bf16 a[152:167], v[8:11], a[0:3], a[184:199]
 v_cvt_pk_bf16_f32 v46, v68, v69
 v_cvt_pk_bf16_f32 v47, v70, v71
 v_mfma_f32_32x32x16_bf16 a[152:167], v[12:15], a[4:7], a[152:167]
 s_mul_i32 s49, s59, 49152
 s_add_u32 s49, s49, 0x380000
 s_add_u32 s85, s49, s94
 buffer_load_dwordx4 a[200:203], v6, s[24:27], s85 offen offset:0 sc1
 s_waitcnt lgkmcnt(1)
 v_add_f32 v88, v88, v96
 v_add_f32 v89, v89, v97
 v_add_f32 v90, v90, v98
 v_add_f32 v91, v91, v99
 v_mfma_f32_32x32x16_bf16 a[152:167], v[16:19], a[48:51], a[152:167]
 v_add_f32 v92, v92, v100
 v_add_f32 v93, v93, v101
 v_add_f32 v94, v94, v102
 v_add_f32 v95, v95, v103
 v_cvt_pk_bf16_f32 v48, v72, v73
 v_cvt_pk_bf16_f32 v49, v74, v75
 v_mfma_f32_32x32x16_bf16 a[152:167], v[20:23], a[52:55], a[152:167]
 ds_write_b128 v248, a[168:171] offset:36864
 v_cvt_pk_bf16_f32 v50, v76, v77
 v_cvt_pk_bf16_f32 v51, v78, v79
 v_cvt_pk_bf16_f32 v52, v80, v81
 v_cvt_pk_bf16_f32 v53, v82, v83
 v_mfma_f32_32x32x16_bf16 a[152:167], v[24:27], a[96:99], a[152:167]
 buffer_load_dwordx4 a[204:207], v6, s[24:27], s85 offen offset:1024 sc1
 v_lshlrev_b32_e64 v96, 16, v240
 v_and_b32 v97, 0xffff0000, v240
 v_lshlrev_b32_e64 v98, 16, v241
 v_and_b32 v99, 0xffff0000, v241
 v_cvt_pk_bf16_f32 v54, v84, v85
 v_cvt_pk_bf16_f32 v55, v86, v87
 v_mfma_f32_32x32x16_bf16 a[152:167], v[28:31], a[100:103], a[152:167]
 ds_write_b128 v249, a[172:175] offset:36864
 v_mfma_f32_32x32x16_bf16 a[152:167], v[32:35], a[144:147], a[152:167]
 v_lshlrev_b32_e64 v100, 16, v242
 v_and_b32 v101, 0xffff0000, v242
 v_lshlrev_b32_e64 v102, 16, v243
 v_and_b32 v103, 0xffff0000, v243
 v_mfma_f32_32x32x16_bf16 a[152:167], v[36:39], a[148:151], a[152:167]
 ds_write_b128 v250, a[176:179] offset:36864
 s_add_u32 s85, s49, s95
 buffer_load_dwordx4 a[208:211], v6, s[24:27], s85 offen offset:0 sc1
 v_mfma_f32_32x32x16_bf16 a[152:167], v[40:43], v[144:147], a[152:167]
 v_add_f32 v88, v88, v96
 v_add_f32 v89, v89, v97
 v_add_f32 v90, v90, v98
 v_add_f32_e64 v91, v91, v99
 v_mfma_f32_32x32x16_bf16 a[152:167], v[44:47], v[148:151], a[152:167]
 ds_write_b128 v251, a[180:183] offset:36864
 v_mfma_f32_32x32x16_bf16 a[152:167], v[48:51], v[192:195], a[152:167]
 buffer_load_dwordx4 a[212:215], v6, s[24:27], s85 offen offset:1024 sc1
 v_add_f32 v92, v92, v100
 v_add_f32 v93, v93, v101
 v_add_f32 v94, v94, v102
 v_add_f32 v95, v95, v103
 v_mfma_f32_32x32x16_bf16 a[152:167], v[52:55], v[196:199], a[152:167]
 v_cvt_pk_bf16_f32 v240, v88, v89
 v_cvt_pk_bf16_f32 v241, v90, v91
 v_cvt_pk_bf16_f32 v242, v92, v93
 v_cvt_pk_bf16_f32 v243, v94, v95
 v_mfma_f32_32x32x16_bf16 a[168:183], v[8:11], a[8:11], a[184:199]
 s_waitcnt lgkmcnt(0)
 s_barrier
 ds_read_b128 v[88:91], v252 offset:32768
 ds_read_b128 v[92:95], v253 offset:32768
 ds_read_b128 v[96:99], v252 offset:40960
 ds_read_b128 v[100:103], v253 offset:40960
 v_mfma_f32_32x32x16_bf16 a[168:183], v[12:15], a[12:15], a[168:183]
 s_lshl_b32 s6, s57, 6
 buffer_store_dwordx4 v[240:243], v245, s[20:23], s6 offen sc1 nt
 s_add_u32 s85, s49, s96
 buffer_load_dwordx4 a[216:219], v6, s[24:27], s85 offen offset:0 sc1
 v_mfma_f32_32x32x16_bf16 a[168:183], v[16:19], a[56:59], a[168:183]
 ds_write_b128 v248, a[152:155] offset:0
 v_mfma_f32_32x32x16_bf16 a[168:183], v[20:23], a[60:63], a[168:183]
 s_waitcnt lgkmcnt(1)
 v_add_f32 v88, v88, v96
 v_add_f32 v89, v89, v97
 v_add_f32 v90, v90, v98
 v_add_f32_e64 v91, v91, v99
 v_mfma_f32_32x32x16_bf16 a[168:183], v[24:27], a[104:107], a[168:183]
 buffer_load_dwordx4 a[220:223], v6, s[24:27], s85 offen offset:1024 sc1
 v_add_f32 v92, v92, v100
 v_add_f32 v93, v93, v101
 v_add_f32 v94, v94, v102
 v_add_f32 v95, v95, v103
 v_mfma_f32_32x32x16_bf16 a[168:183], v[28:31], a[108:111], a[168:183]
 ds_read_b128 v[96:99], v252 offset:49152
 ds_read_b128 v[100:103], v253 offset:49152
 v_mfma_f32_32x32x16_bf16 a[168:183], v[32:35], v[104:107], a[168:183]
 ds_write_b128 v249, a[156:159] offset:0
 v_mfma_f32_32x32x16_bf16 a[168:183], v[36:39], v[108:111], a[168:183]
 ds_write_b128 v250, a[160:163] offset:0
 s_add_u32 s85, s49, s97
 buffer_load_dwordx4 a[224:227], v6, s[24:27], s85 offen offset:0 sc1
 v_mfma_f32_32x32x16_bf16 a[168:183], v[40:43], v[152:155], a[168:183]
 s_waitcnt lgkmcnt(2)
 v_add_f32 v88, v88, v96
 v_add_f32 v89, v89, v97
 v_add_f32 v90, v90, v98
 v_add_f32 v91, v91, v99
 v_mfma_f32_32x32x16_bf16 a[168:183], v[44:47], v[156:159], a[168:183]
 v_add_f32 v92, v92, v100
 v_add_f32 v93, v93, v101
 v_add_f32 v94, v94, v102
 v_add_f32 v95, v95, v103
 v_mfma_f32_32x32x16_bf16 a[168:183], v[48:51], v[200:203], a[168:183]
 ds_read_b128 v[96:99], v252 offset:57344
 ds_read_b128 v[100:103], v253 offset:57344
 ds_read_b128 v[240:243], v0 offset:20480
 buffer_load_dwordx4 a[228:231], v6, s[24:27], s85 offen offset:1024 sc1
 v_mfma_f32_32x32x16_bf16 a[168:183], v[52:55], v[204:207], a[168:183]
 ds_write_b128 v251, a[164:167] offset:0
 v_mfma_f32_32x32x16_bf16 a[152:167], v[8:11], a[16:19], a[184:199]
 v_mfma_f32_32x32x16_bf16 a[152:167], v[12:15], a[20:23], a[152:167]
 s_add_u32 s85, s49, s98
 buffer_load_dwordx4 a[232:235], v6, s[24:27], s85 offen offset:0 sc1
 s_waitcnt lgkmcnt(1)
 v_add_f32 v88, v88, v96
 v_add_f32 v89, v89, v97
 v_add_f32 v90, v90, v98
 v_add_f32 v91, v91, v99
 v_mfma_f32_32x32x16_bf16 a[152:167], v[16:19], a[64:67], a[152:167]
 v_add_f32 v92, v92, v100
 v_add_f32 v93, v93, v101
 v_add_f32 v94, v94, v102
 v_add_f32 v95, v95, v103
 v_mfma_f32_32x32x16_bf16 a[152:167], v[20:23], a[68:71], a[152:167]
 ds_write_b128 v248, a[168:171] offset:4096
 v_mfma_f32_32x32x16_bf16 a[152:167], v[24:27], a[112:115], a[152:167]
 buffer_load_dwordx4 a[236:239], v6, s[24:27], s85 offen offset:1024 sc1
 v_lshlrev_b32_e64 v96, 16, v240
 v_and_b32 v97, 0xffff0000, v240
 v_lshlrev_b32_e64 v98, 16, v241
 v_and_b32 v99, 0xffff0000, v241
 v_mfma_f32_32x32x16_bf16 a[152:167], v[28:31], a[116:119], a[152:167]
 ds_write_b128 v249, a[172:175] offset:4096
 v_mfma_f32_32x32x16_bf16 a[152:167], v[32:35], v[112:115], a[152:167]
 v_lshlrev_b32_e64 v100, 16, v242
 v_and_b32 v101, 0xffff0000, v242
 v_lshlrev_b32_e64 v102, 16, v243
 v_and_b32 v103, 0xffff0000, v243
 v_mfma_f32_32x32x16_bf16 a[152:167], v[36:39], v[116:119], a[152:167]
 ds_write_b128 v250, a[176:179] offset:4096
 s_add_u32 s85, s49, s99
 buffer_load_dwordx4 a[240:243], v6, s[24:27], s85 offen offset:0 sc1
 v_mfma_f32_32x32x16_bf16 a[152:167], v[40:43], v[160:163], a[152:167]
 v_add_f32 v88, v88, v96
 v_add_f32 v89, v89, v97
 v_add_f32 v90, v90, v98
 v_add_f32_e64 v91, v91, v99
 v_mfma_f32_32x32x16_bf16 a[152:167], v[44:47], v[164:167], a[152:167]
 ds_write_b128 v251, a[180:183] offset:4096
 v_mfma_f32_32x32x16_bf16 a[152:167], v[48:51], v[208:211], a[152:167]
 buffer_load_dwordx4 a[244:247], v6, s[24:27], s85 offen offset:1024 sc1
 v_add_f32 v92, v92, v100
 v_add_f32 v93, v93, v101
 v_add_f32 v94, v94, v102
 v_add_f32 v95, v95, v103
 v_mfma_f32_32x32x16_bf16 a[152:167], v[52:55], v[212:215], a[152:167]
 v_cvt_pk_bf16_f32 v240, v88, v89
 v_cvt_pk_bf16_f32 v241, v90, v91
 v_cvt_pk_bf16_f32 v242, v92, v93
 v_cvt_pk_bf16_f32 v243, v94, v95
 v_mfma_f32_32x32x16_bf16 a[168:183], v[8:11], a[24:27], a[184:199]
 s_waitcnt lgkmcnt(0)
 s_barrier
 ds_read_b128 v[88:91], v252 offset:0
 ds_read_b128 v[92:95], v253 offset:0
 ds_read_b128 v[96:99], v252 offset:8192
 ds_read_b128 v[100:103], v253 offset:8192
 v_mfma_f32_32x32x16_bf16 a[168:183], v[12:15], a[28:31], a[168:183]
 s_lshl_b32 s6, s57, 6
 buffer_store_dwordx4 v[240:243], v246, s[20:23], s6 offen sc1 nt
 v_mfma_f32_32x32x16_bf16 a[168:183], v[16:19], a[72:75], a[168:183]
 ds_write_b128 v248, a[152:155] offset:32768
 v_mfma_f32_32x32x16_bf16 a[168:183], v[20:23], a[76:79], a[168:183]
 s_waitcnt lgkmcnt(1)
 v_add_f32 v88, v88, v96
 v_add_f32 v89, v89, v97
 v_add_f32 v90, v90, v98
 v_add_f32 v91, v91, v99
 v_mfma_f32_32x32x16_bf16 a[168:183], v[24:27], a[120:123], a[168:183]
 v_add_f32 v92, v92, v100
 v_add_f32 v93, v93, v101
 v_add_f32 v94, v94, v102
 v_add_f32 v95, v95, v103
 v_mfma_f32_32x32x16_bf16 a[168:183], v[28:31], a[124:127], a[168:183]
 ds_read_b128 v[96:99], v252 offset:16384
 ds_read_b128 v[100:103], v253 offset:16384
 v_mfma_f32_32x32x16_bf16 a[168:183], v[32:35], v[120:123], a[168:183]
 ds_write_b128 v249, a[156:159] offset:32768
 v_mfma_f32_32x32x16_bf16 a[168:183], v[36:39], v[124:127], a[168:183]
 ds_write_b128 v250, a[160:163] offset:32768
 v_mfma_f32_32x32x16_bf16 a[168:183], v[40:43], v[168:171], a[168:183]
 s_waitcnt lgkmcnt(2)
 v_add_f32 v88, v88, v96
 v_add_f32 v89, v89, v97
 v_add_f32 v90, v90, v98
 v_add_f32_e64 v91, v91, v99
 v_mfma_f32_32x32x16_bf16 a[168:183], v[44:47], v[172:175], a[168:183]
 v_add_f32 v92, v92, v100
 v_add_f32 v93, v93, v101
 v_add_f32 v94, v94, v102
 v_add_f32 v95, v95, v103
 v_mfma_f32_32x32x16_bf16 a[168:183], v[48:51], v[216:219], a[168:183]
 ds_read_b128 v[96:99], v252 offset:24576
 ds_read_b128 v[100:103], v253 offset:24576
 ds_read_b128 v[240:243], v0 offset:24576
 v_mfma_f32_32x32x16_bf16 a[168:183], v[52:55], v[220:223], a[168:183]
 ds_write_b128 v251, a[164:167] offset:32768
 v_mfma_f32_32x32x16_bf16 a[152:167], v[8:11], a[32:35], a[184:199]
 v_mfma_f32_32x32x16_bf16 a[152:167], v[12:15], a[36:39], a[152:167]
 s_waitcnt lgkmcnt(1)
 v_add_f32 v88, v88, v96
 v_add_f32 v89, v89, v97
 v_add_f32 v90, v90, v98
 v_add_f32_e64 v91, v91, v99
 v_mfma_f32_32x32x16_bf16 a[152:167], v[16:19], a[80:83], a[152:167]
 v_add_f32 v92, v92, v100
 v_add_f32 v93, v93, v101
 v_add_f32 v94, v94, v102
 v_add_f32 v95, v95, v103
 v_mfma_f32_32x32x16_bf16 a[152:167], v[20:23], a[84:87], a[152:167]
 ds_write_b128 v248, a[168:171] offset:36864
 v_mfma_f32_32x32x16_bf16 a[152:167], v[24:27], a[128:131], a[152:167]
 v_lshlrev_b32_e64 v96, 16, v240
 v_and_b32 v97, 0xffff0000, v240
 v_lshlrev_b32_e64 v98, 16, v241
 v_and_b32 v99, 0xffff0000, v241
 v_mfma_f32_32x32x16_bf16 a[152:167], v[28:31], a[132:135], a[152:167]
 ds_write_b128 v249, a[172:175] offset:36864
 v_mfma_f32_32x32x16_bf16 a[152:167], v[32:35], v[128:131], a[152:167]
 v_lshlrev_b32_e64 v100, 16, v242
 v_and_b32 v101, 0xffff0000, v242
 v_lshlrev_b32_e64 v102, 16, v243
 v_and_b32 v103, 0xffff0000, v243
 v_mfma_f32_32x32x16_bf16 a[152:167], v[36:39], v[132:135], a[152:167]
 ds_write_b128 v250, a[176:179] offset:36864
 ds_read_b128 a[248:251], v3 offset:0
 v_mfma_f32_32x32x16_bf16 a[152:167], v[40:43], v[176:179], a[152:167]
 v_add_f32 v88, v88, v96
 v_add_f32 v89, v89, v97
 v_add_f32 v90, v90, v98
 v_add_f32 v91, v91, v99
 v_mfma_f32_32x32x16_bf16 a[152:167], v[44:47], v[180:183], a[152:167]
 ds_write_b128 v251, a[180:183] offset:36864
 ds_read_b128 a[252:255], v4 offset:0
 v_mfma_f32_32x32x16_bf16 a[152:167], v[48:51], v[224:227], a[152:167]
 v_add_f32 v92, v92, v100
 v_add_f32 v93, v93, v101
 v_add_f32 v94, v94, v102
 v_add_f32 v95, v95, v103
 v_mfma_f32_32x32x16_bf16 a[152:167], v[52:55], v[228:231], a[152:167]
 v_cvt_pk_bf16_f32 v240, v88, v89
 v_cvt_pk_bf16_f32 v241, v90, v91
 v_cvt_pk_bf16_f32 v242, v92, v93
 v_cvt_pk_bf16_f32 v243, v94, v95
 v_mfma_f32_32x32x16_bf16 a[168:183], v[8:11], a[40:43], a[184:199]
 s_waitcnt lgkmcnt(1)
 s_barrier
 ds_read_b128 v[88:91], v252 offset:32768
 ds_read_b128 v[92:95], v253 offset:32768
 ds_read_b128 v[96:99], v252 offset:40960
 ds_read_b128 v[100:103], v253 offset:40960
 s_waitcnt vmcnt(13)
 v_mfma_f32_32x32x16_bf16 v[56:71], a[248:251], a[200:203], 0
 s_lshl_b32 s6, s58, 6
 buffer_store_dwordx4 v[240:243], v244, s[20:23], s6 offen sc1 nt
 ds_read_b128 a[248:251], v3 offset:544
 v_mfma_f32_32x32x16_bf16 a[168:183], v[12:15], a[44:47], a[168:183]
 s_lshl_b32 s6, s59, 7
 v_add_u32 v7, s6, v5
 ds_read_b128 a[184:187], v7 offset:0
 ds_read_b128 a[188:191], v7 offset:32
 ds_read_b128 a[192:195], v7 offset:64
 ds_read_b128 a[196:199], v7 offset:96
 s_waitcnt vmcnt(13) lgkmcnt(9)
 v_mfma_f32_32x32x16_bf16 v[56:71], a[252:255], a[204:207], v[56:71]
 ds_read_b128 a[252:255], v4 offset:544
 v_mfma_f32_32x32x16_bf16 a[168:183], v[16:19], a[88:91], a[168:183]
 ds_write_b128 v248, a[152:155] offset:0
 s_waitcnt vmcnt(12) lgkmcnt(6)
 v_mfma_f32_32x32x16_bf16 v[72:87], a[248:251], a[208:211], 0
 ds_read_b128 a[248:251], v3 offset:1088
 v_mfma_f32_32x32x16_bf16 a[168:183], v[20:23], a[92:95], a[168:183]
 v_add_f32 v88, v88, v96
 v_add_f32 v89, v89, v97
 v_add_f32 v90, v90, v98
 v_add_f32 v91, v91, v99
 s_nop 0
 v_cvt_pk_bf16_f32 v8, v56, v57
 v_cvt_pk_bf16_f32 v9, v58, v59
 s_waitcnt vmcnt(11) lgkmcnt(2)
 v_mfma_f32_32x32x16_bf16 v[72:87], a[252:255], a[212:215], v[72:87]
 ds_read_b128 a[252:255], v4 offset:1088
 v_cvt_pk_bf16_f32 v10, v60, v61
 v_cvt_pk_bf16_f32 v11, v62, v63
 v_cvt_pk_bf16_f32 v12, v64, v65
 v_cvt_pk_bf16_f32 v13, v66, v67
 v_mfma_f32_32x32x16_bf16 a[168:183], v[24:27], a[136:139], a[168:183]
 v_add_f32 v92, v92, v100
 v_add_f32 v93, v93, v101
 v_add_f32 v94, v94, v102
 v_add_f32 v95, v95, v103
 v_cvt_pk_bf16_f32 v14, v68, v69
 v_cvt_pk_bf16_f32 v15, v70, v71
 s_waitcnt vmcnt(9) lgkmcnt(1)
 v_mfma_f32_32x32x16_bf16 v[56:71], a[248:251], a[216:219], 0
 ds_read_b128 a[248:251], v3 offset:1632
 v_mfma_f32_32x32x16_bf16 a[168:183], v[28:31], a[140:143], a[168:183]
 ds_read_b128 v[96:99], v252 offset:49152
 ds_read_b128 v[100:103], v253 offset:49152
 v_cvt_pk_bf16_f32 v16, v72, v73
 v_cvt_pk_bf16_f32 v17, v74, v75
 s_waitcnt vmcnt(8) lgkmcnt(3)
 v_mfma_f32_32x32x16_bf16 v[56:71], a[252:255], a[220:223], v[56:71]
 ds_read_b128 a[252:255], v4 offset:1632
 v_cvt_pk_bf16_f32 v18, v76, v77
 v_cvt_pk_bf16_f32 v19, v78, v79
 v_cvt_pk_bf16_f32 v20, v80, v81
 v_cvt_pk_bf16_f32 v21, v82, v83
 v_mfma_f32_32x32x16_bf16 a[168:183], v[32:35], v[136:139], a[168:183]
 ds_write_b128 v249, a[156:159] offset:0
 v_cvt_pk_bf16_f32 v22, v84, v85
 v_cvt_pk_bf16_f32 v23, v86, v87
 s_waitcnt vmcnt(7) lgkmcnt(4)
 v_mfma_f32_32x32x16_bf16 v[72:87], a[248:251], a[224:227], 0
 ds_read_b128 a[248:251], v3 offset:2176
 v_mfma_f32_32x32x16_bf16 a[168:183], v[36:39], v[140:143], a[168:183]
 ds_write_b128 v250, a[160:163] offset:0
 v_cvt_pk_bf16_f32 v24, v56, v57
 v_cvt_pk_bf16_f32 v25, v58, v59
 s_waitcnt vmcnt(6) lgkmcnt(3)
 v_mfma_f32_32x32x16_bf16 v[72:87], a[252:255], a[228:231], v[72:87]
 ds_read_b128 a[252:255], v4 offset:2176
 v_cvt_pk_bf16_f32 v26, v60, v61
 v_cvt_pk_bf16_f32 v27, v62, v63
 v_cvt_pk_bf16_f32 v28, v64, v65
 v_cvt_pk_bf16_f32 v29, v66, v67
 v_mfma_f32_32x32x16_bf16 a[168:183], v[40:43], v[184:187], a[168:183]
 v_add_f32 v88, v88, v96
 v_add_f32 v89, v89, v97
 v_add_f32_e64 v90, v90, v98
 v_add_f32 v91, v91, v99
 v_cvt_pk_bf16_f32 v30, v68, v69
 v_cvt_pk_bf16_f32 v31, v70, v71
 s_waitcnt vmcnt(5) lgkmcnt(2)
 v_mfma_f32_32x32x16_bf16 v[56:71], a[248:251], a[232:235], 0
 ds_read_b128 a[248:251], v3 offset:2720
 v_mfma_f32_32x32x16_bf16 a[168:183], v[44:47], v[188:191], a[168:183]
 v_add_f32 v92, v92, v100
 v_add_f32 v93, v93, v101
 v_add_f32_e64 v94, v94, v102
 v_add_f32 v95, v95, v103
 v_cvt_pk_bf16_f32 v32, v72, v73
 v_cvt_pk_bf16_f32 v33, v74, v75
 s_waitcnt vmcnt(4) lgkmcnt(1)
 v_mfma_f32_32x32x16_bf16 v[56:71], a[252:255], a[236:239], v[56:71]
 ds_read_b128 a[252:255], v4 offset:2720
 v_cvt_pk_bf16_f32 v34, v76, v77
 v_cvt_pk_bf16_f32 v35, v78, v79
 v_cvt_pk_bf16_f32 v36, v80, v81
 v_cvt_pk_bf16_f32 v37, v82, v83
 v_mfma_f32_32x32x16_bf16 a[168:183], v[48:51], v[232:235], a[168:183]
 ds_read_b128 v[96:99], v252 offset:57344
 ds_read_b128 v[100:103], v253 offset:57344
 ds_read_b128 v[240:243], v0 offset:28672
 v_cvt_pk_bf16_f32 v38, v84, v85
 v_cvt_pk_bf16_f32 v39, v86, v87
 s_waitcnt vmcnt(3) lgkmcnt(4)
 v_mfma_f32_32x32x16_bf16 v[72:87], a[248:251], a[240:243], 0
 v_mfma_f32_32x32x16_bf16 a[168:183], v[52:55], v[236:239], a[168:183]
 ds_write_b128 v251, a[164:167] offset:0
 v_cvt_pk_bf16_f32 v40, v56, v57
 v_cvt_pk_bf16_f32 v41, v58, v59
 s_waitcnt vmcnt(2) lgkmcnt(4)
 v_mfma_f32_32x32x16_bf16 v[72:87], a[252:255], a[244:247], v[72:87]
 v_cvt_pk_bf16_f32 v42, v60, v61
 v_cvt_pk_bf16_f32 v43, v62, v63
 v_cvt_pk_bf16_f32 v44, v64, v65
 v_cvt_pk_bf16_f32 v45, v66, v67
 v_mfma_f32_32x32x16_bf16 a[152:167], v[8:11], a[0:3], a[184:199]
 v_cvt_pk_bf16_f32 v46, v68, v69
 v_cvt_pk_bf16_f32 v47, v70, v71
 v_mfma_f32_32x32x16_bf16 a[152:167], v[12:15], a[4:7], a[152:167]
 s_mul_i32 s49, s60, 49152
 s_add_u32 s49, s49, 0x380000
 s_add_u32 s85, s49, s94
 buffer_load_dwordx4 a[200:203], v6, s[24:27], s85 offen offset:0 sc1
 s_waitcnt lgkmcnt(1)
 v_add_f32 v88, v88, v96
 v_add_f32 v89, v89, v97
 v_add_f32 v90, v90, v98
 v_add_f32 v91, v91, v99
 v_mfma_f32_32x32x16_bf16 a[152:167], v[16:19], a[48:51], a[152:167]
 v_add_f32 v92, v92, v100
 v_add_f32 v93, v93, v101
 v_add_f32 v94, v94, v102
 v_add_f32 v95, v95, v103
 v_cvt_pk_bf16_f32 v48, v72, v73
 v_cvt_pk_bf16_f32 v49, v74, v75
 v_mfma_f32_32x32x16_bf16 a[152:167], v[20:23], a[52:55], a[152:167]
 ds_write_b128 v248, a[168:171] offset:4096
 v_cvt_pk_bf16_f32 v50, v76, v77
 v_cvt_pk_bf16_f32 v51, v78, v79
 v_cvt_pk_bf16_f32 v52, v80, v81
 v_cvt_pk_bf16_f32 v53, v82, v83
 v_mfma_f32_32x32x16_bf16 a[152:167], v[24:27], a[96:99], a[152:167]
 buffer_load_dwordx4 a[204:207], v6, s[24:27], s85 offen offset:1024 sc1
 v_lshlrev_b32_e64 v96, 16, v240
 v_and_b32 v97, 0xffff0000, v240
 v_lshlrev_b32_e64 v98, 16, v241
 v_and_b32 v99, 0xffff0000, v241
 v_cvt_pk_bf16_f32 v54, v84, v85
 v_cvt_pk_bf16_f32 v55, v86, v87
 v_mfma_f32_32x32x16_bf16 a[152:167], v[28:31], a[100:103], a[152:167]
 ds_write_b128 v249, a[172:175] offset:4096
 v_mfma_f32_32x32x16_bf16 a[152:167], v[32:35], a[144:147], a[152:167]
 v_lshlrev_b32_e64 v100, 16, v242
 v_and_b32 v101, 0xffff0000, v242
 v_lshlrev_b32_e64 v102, 16, v243
 v_and_b32 v103, 0xffff0000, v243
 v_mfma_f32_32x32x16_bf16 a[152:167], v[36:39], a[148:151], a[152:167]
 ds_write_b128 v250, a[176:179] offset:4096
 s_add_u32 s85, s49, s95
 buffer_load_dwordx4 a[208:211], v6, s[24:27], s85 offen offset:0 sc1
 v_mfma_f32_32x32x16_bf16 a[152:167], v[40:43], v[144:147], a[152:167]
 v_add_f32 v88, v88, v96
 v_add_f32 v89, v89, v97
 v_add_f32 v90, v90, v98
 v_add_f32_e64 v91, v91, v99
 v_mfma_f32_32x32x16_bf16 a[152:167], v[44:47], v[148:151], a[152:167]
 ds_write_b128 v251, a[180:183] offset:4096
 v_mfma_f32_32x32x16_bf16 a[152:167], v[48:51], v[192:195], a[152:167]
 buffer_load_dwordx4 a[212:215], v6, s[24:27], s85 offen offset:1024 sc1
 v_add_f32 v92, v92, v100
 v_add_f32 v93, v93, v101
 v_add_f32 v94, v94, v102
 v_add_f32 v95, v95, v103
 v_mfma_f32_32x32x16_bf16 a[152:167], v[52:55], v[196:199], a[152:167]
 v_cvt_pk_bf16_f32 v240, v88, v89
 v_cvt_pk_bf16_f32 v241, v90, v91
 v_cvt_pk_bf16_f32 v242, v92, v93
 v_cvt_pk_bf16_f32 v243, v94, v95
 v_mfma_f32_32x32x16_bf16 a[168:183], v[8:11], a[8:11], a[184:199]
 s_waitcnt lgkmcnt(0)
 s_barrier
 ds_read_b128 v[88:91], v252 offset:0
 ds_read_b128 v[92:95], v253 offset:0
 ds_read_b128 v[96:99], v252 offset:8192
 ds_read_b128 v[100:103], v253 offset:8192
 v_mfma_f32_32x32x16_bf16 a[168:183], v[12:15], a[12:15], a[168:183]
 s_lshl_b32 s6, s58, 6
 buffer_store_dwordx4 v[240:243], v245, s[20:23], s6 offen sc1 nt
 s_add_u32 s85, s49, s96
 buffer_load_dwordx4 a[216:219], v6, s[24:27], s85 offen offset:0 sc1
 v_mfma_f32_32x32x16_bf16 a[168:183], v[16:19], a[56:59], a[168:183]
 ds_write_b128 v248, a[152:155] offset:32768
 v_mfma_f32_32x32x16_bf16 a[168:183], v[20:23], a[60:63], a[168:183]
 s_waitcnt lgkmcnt(1)
 v_add_f32 v88, v88, v96
 v_add_f32 v89, v89, v97
 v_add_f32 v90, v90, v98
 v_add_f32_e64 v91, v91, v99
 v_mfma_f32_32x32x16_bf16 a[168:183], v[24:27], a[104:107], a[168:183]
 buffer_load_dwordx4 a[220:223], v6, s[24:27], s85 offen offset:1024 sc1
 v_add_f32 v92, v92, v100
 v_add_f32 v93, v93, v101
 v_add_f32 v94, v94, v102
 v_add_f32 v95, v95, v103
 v_mfma_f32_32x32x16_bf16 a[168:183], v[28:31], a[108:111], a[168:183]
 ds_read_b128 v[96:99], v252 offset:16384
 ds_read_b128 v[100:103], v253 offset:16384
 v_mfma_f32_32x32x16_bf16 a[168:183], v[32:35], v[104:107], a[168:183]
 ds_write_b128 v249, a[156:159] offset:32768
 v_mfma_f32_32x32x16_bf16 a[168:183], v[36:39], v[108:111], a[168:183]
 ds_write_b128 v250, a[160:163] offset:32768
 s_add_u32 s85, s49, s97
 buffer_load_dwordx4 a[224:227], v6, s[24:27], s85 offen offset:0 sc1
 v_mfma_f32_32x32x16_bf16 a[168:183], v[40:43], v[152:155], a[168:183]
 s_waitcnt lgkmcnt(2)
 v_add_f32 v88, v88, v96
 v_add_f32 v89, v89, v97
 v_add_f32 v90, v90, v98
 v_add_f32 v91, v91, v99
 v_mfma_f32_32x32x16_bf16 a[168:183], v[44:47], v[156:159], a[168:183]
 v_add_f32 v92, v92, v100
 v_add_f32 v93, v93, v101
 v_add_f32 v94, v94, v102
 v_add_f32 v95, v95, v103
 v_mfma_f32_32x32x16_bf16 a[168:183], v[48:51], v[200:203], a[168:183]
 ds_read_b128 v[96:99], v252 offset:24576
 ds_read_b128 v[100:103], v253 offset:24576
 ds_read_b128 v[240:243], v0 offset:32768
 buffer_load_dwordx4 a[228:231], v6, s[24:27], s85 offen offset:1024 sc1
 v_mfma_f32_32x32x16_bf16 a[168:183], v[52:55], v[204:207], a[168:183]
 ds_write_b128 v251, a[164:167] offset:32768
 v_mfma_f32_32x32x16_bf16 a[152:167], v[8:11], a[16:19], a[184:199]
 v_mfma_f32_32x32x16_bf16 a[152:167], v[12:15], a[20:23], a[152:167]
 s_add_u32 s85, s49, s98
 buffer_load_dwordx4 a[232:235], v6, s[24:27], s85 offen offset:0 sc1
 s_waitcnt lgkmcnt(1)
 v_add_f32 v88, v88, v96
 v_add_f32 v89, v89, v97
 v_add_f32 v90, v90, v98
 v_add_f32 v91, v91, v99
 v_mfma_f32_32x32x16_bf16 a[152:167], v[16:19], a[64:67], a[152:167]
 v_add_f32 v92, v92, v100
 v_add_f32 v93, v93, v101
 v_add_f32 v94, v94, v102
 v_add_f32 v95, v95, v103
 v_mfma_f32_32x32x16_bf16 a[152:167], v[20:23], a[68:71], a[152:167]
 ds_write_b128 v248, a[168:171] offset:36864
 v_mfma_f32_32x32x16_bf16 a[152:167], v[24:27], a[112:115], a[152:167]
 buffer_load_dwordx4 a[236:239], v6, s[24:27], s85 offen offset:1024 sc1
 v_lshlrev_b32_e64 v96, 16, v240
 v_and_b32 v97, 0xffff0000, v240
 v_lshlrev_b32_e64 v98, 16, v241
 v_and_b32 v99, 0xffff0000, v241
 v_mfma_f32_32x32x16_bf16 a[152:167], v[28:31], a[116:119], a[152:167]
 ds_write_b128 v249, a[172:175] offset:36864
 v_mfma_f32_32x32x16_bf16 a[152:167], v[32:35], v[112:115], a[152:167]
 v_lshlrev_b32_e64 v100, 16, v242
 v_and_b32 v101, 0xffff0000, v242
 v_lshlrev_b32_e64 v102, 16, v243
 v_and_b32 v103, 0xffff0000, v243
 v_mfma_f32_32x32x16_bf16 a[152:167], v[36:39], v[116:119], a[152:167]
 ds_write_b128 v250, a[176:179] offset:36864
 s_add_u32 s85, s49, s99
 buffer_load_dwordx4 a[240:243], v6, s[24:27], s85 offen offset:0 sc1
 v_mfma_f32_32x32x16_bf16 a[152:167], v[40:43], v[160:163], a[152:167]
 v_add_f32 v88, v88, v96
 v_add_f32 v89, v89, v97
 v_add_f32 v90, v90, v98
 v_add_f32_e64 v91, v91, v99
 v_mfma_f32_32x32x16_bf16 a[152:167], v[44:47], v[164:167], a[152:167]
 ds_write_b128 v251, a[180:183] offset:36864
 v_mfma_f32_32x32x16_bf16 a[152:167], v[48:51], v[208:211], a[152:167]
 buffer_load_dwordx4 a[244:247], v6, s[24:27], s85 offen offset:1024 sc1
 v_add_f32 v92, v92, v100
 v_add_f32 v93, v93, v101
 v_add_f32 v94, v94, v102
 v_add_f32 v95, v95, v103
 v_mfma_f32_32x32x16_bf16 a[152:167], v[52:55], v[212:215], a[152:167]
 v_cvt_pk_bf16_f32 v240, v88, v89
 v_cvt_pk_bf16_f32 v241, v90, v91
 v_cvt_pk_bf16_f32 v242, v92, v93
 v_cvt_pk_bf16_f32 v243, v94, v95
 v_mfma_f32_32x32x16_bf16 a[168:183], v[8:11], a[24:27], a[184:199]
 s_waitcnt lgkmcnt(0)
 s_barrier
 ds_read_b128 v[88:91], v252 offset:32768
 ds_read_b128 v[92:95], v253 offset:32768
 ds_read_b128 v[96:99], v252 offset:40960
 ds_read_b128 v[100:103], v253 offset:40960
 v_mfma_f32_32x32x16_bf16 a[168:183], v[12:15], a[28:31], a[168:183]
 s_lshl_b32 s6, s58, 6
 buffer_store_dwordx4 v[240:243], v246, s[20:23], s6 offen sc1 nt
 v_mfma_f32_32x32x16_bf16 a[168:183], v[16:19], a[72:75], a[168:183]
 ds_write_b128 v248, a[152:155] offset:0
 v_mfma_f32_32x32x16_bf16 a[168:183], v[20:23], a[76:79], a[168:183]
 s_waitcnt lgkmcnt(1)
 v_add_f32 v88, v88, v96
 v_add_f32 v89, v89, v97
 v_add_f32 v90, v90, v98
 v_add_f32 v91, v91, v99
 v_mfma_f32_32x32x16_bf16 a[168:183], v[24:27], a[120:123], a[168:183]
 v_add_f32 v92, v92, v100
 v_add_f32 v93, v93, v101
 v_add_f32 v94, v94, v102
 v_add_f32 v95, v95, v103
 v_mfma_f32_32x32x16_bf16 a[168:183], v[28:31], a[124:127], a[168:183]
 ds_read_b128 v[96:99], v252 offset:49152
 ds_read_b128 v[100:103], v253 offset:49152
 v_mfma_f32_32x32x16_bf16 a[168:183], v[32:35], v[120:123], a[168:183]
 ds_write_b128 v249, a[156:159] offset:0
 v_mfma_f32_32x32x16_bf16 a[168:183], v[36:39], v[124:127], a[168:183]
 ds_write_b128 v250, a[160:163] offset:0
 v_mfma_f32_32x32x16_bf16 a[168:183], v[40:43], v[168:171], a[168:183]
 s_waitcnt lgkmcnt(2)
 v_add_f32 v88, v88, v96
 v_add_f32 v89, v89, v97
 v_add_f32 v90, v90, v98
 v_add_f32_e64 v91, v91, v99
 v_mfma_f32_32x32x16_bf16 a[168:183], v[44:47], v[172:175], a[168:183]
 v_add_f32 v92, v92, v100
 v_add_f32 v93, v93, v101
 v_add_f32 v94, v94, v102
 v_add_f32 v95, v95, v103
 v_mfma_f32_32x32x16_bf16 a[168:183], v[48:51], v[216:219], a[168:183]
 ds_read_b128 v[96:99], v252 offset:57344
 ds_read_b128 v[100:103], v253 offset:57344
 ds_read_b128 v[240:243], v0 offset:36864
 v_mfma_f32_32x32x16_bf16 a[168:183], v[52:55], v[220:223], a[168:183]
 ds_write_b128 v251, a[164:167] offset:0
 v_mfma_f32_32x32x16_bf16 a[152:167], v[8:11], a[32:35], a[184:199]
 v_mfma_f32_32x32x16_bf16 a[152:167], v[12:15], a[36:39], a[152:167]
 s_waitcnt lgkmcnt(1)
 v_add_f32 v88, v88, v96
 v_add_f32 v89, v89, v97
 v_add_f32 v90, v90, v98
 v_add_f32_e64 v91, v91, v99
 v_mfma_f32_32x32x16_bf16 a[152:167], v[16:19], a[80:83], a[152:167]
 v_add_f32 v92, v92, v100
 v_add_f32 v93, v93, v101
 v_add_f32 v94, v94, v102
 v_add_f32 v95, v95, v103
 v_mfma_f32_32x32x16_bf16 a[152:167], v[20:23], a[84:87], a[152:167]
 ds_write_b128 v248, a[168:171] offset:4096
 v_mfma_f32_32x32x16_bf16 a[152:167], v[24:27], a[128:131], a[152:167]
 v_lshlrev_b32_e64 v96, 16, v240
 v_and_b32 v97, 0xffff0000, v240
 v_lshlrev_b32_e64 v98, 16, v241
 v_and_b32 v99, 0xffff0000, v241
 v_mfma_f32_32x32x16_bf16 a[152:167], v[28:31], a[132:135], a[152:167]
 ds_write_b128 v249, a[172:175] offset:4096
 v_mfma_f32_32x32x16_bf16 a[152:167], v[32:35], v[128:131], a[152:167]
 v_lshlrev_b32_e64 v100, 16, v242
 v_and_b32 v101, 0xffff0000, v242
 v_lshlrev_b32_e64 v102, 16, v243
 v_and_b32 v103, 0xffff0000, v243
 v_mfma_f32_32x32x16_bf16 a[152:167], v[36:39], v[132:135], a[152:167]
 ds_write_b128 v250, a[176:179] offset:4096
 ds_read_b128 a[248:251], v3 offset:0
 v_mfma_f32_32x32x16_bf16 a[152:167], v[40:43], v[176:179], a[152:167]
 v_add_f32 v88, v88, v96
 v_add_f32 v89, v89, v97
 v_add_f32 v90, v90, v98
 v_add_f32 v91, v91, v99
 v_mfma_f32_32x32x16_bf16 a[152:167], v[44:47], v[180:183], a[152:167]
 ds_write_b128 v251, a[180:183] offset:4096
 ds_read_b128 a[252:255], v4 offset:0
 v_mfma_f32_32x32x16_bf16 a[152:167], v[48:51], v[224:227], a[152:167]
 v_add_f32 v92, v92, v100
 v_add_f32 v93, v93, v101
 v_add_f32 v94, v94, v102
 v_add_f32 v95, v95, v103
 v_mfma_f32_32x32x16_bf16 a[152:167], v[52:55], v[228:231], a[152:167]
 v_cvt_pk_bf16_f32 v240, v88, v89
 v_cvt_pk_bf16_f32 v241, v90, v91
 v_cvt_pk_bf16_f32 v242, v92, v93
 v_cvt_pk_bf16_f32 v243, v94, v95
 v_mfma_f32_32x32x16_bf16 a[168:183], v[8:11], a[40:43], a[184:199]
 s_waitcnt lgkmcnt(1)
 s_barrier
 ds_read_b128 v[88:91], v252 offset:0
 ds_read_b128 v[92:95], v253 offset:0
 ds_read_b128 v[96:99], v252 offset:8192
 ds_read_b128 v[100:103], v253 offset:8192
 s_waitcnt vmcnt(13)
 v_mfma_f32_32x32x16_bf16 v[56:71], a[248:251], a[200:203], 0
 s_lshl_b32 s6, s59, 6
 buffer_store_dwordx4 v[240:243], v244, s[20:23], s6 offen sc1 nt
 ds_read_b128 a[248:251], v3 offset:544
 v_mfma_f32_32x32x16_bf16 a[168:183], v[12:15], a[44:47], a[168:183]
 s_lshl_b32 s6, s60, 7
 v_add_u32 v7, s6, v5
 ds_read_b128 a[184:187], v7 offset:0
 ds_read_b128 a[188:191], v7 offset:32
 ds_read_b128 a[192:195], v7 offset:64
 ds_read_b128 a[196:199], v7 offset:96
 s_waitcnt vmcnt(13) lgkmcnt(9)
 v_mfma_f32_32x32x16_bf16 v[56:71], a[252:255], a[204:207], v[56:71]
 ds_read_b128 a[252:255], v4 offset:544
 v_mfma_f32_32x32x16_bf16 a[168:183], v[16:19], a[88:91], a[168:183]
 ds_write_b128 v248, a[152:155] offset:32768
 s_waitcnt vmcnt(12) lgkmcnt(6)
 v_mfma_f32_32x32x16_bf16 v[72:87], a[248:251], a[208:211], 0
 ds_read_b128 a[248:251], v3 offset:1088
 v_mfma_f32_32x32x16_bf16 a[168:183], v[20:23], a[92:95], a[168:183]
 v_add_f32 v88, v88, v96
 v_add_f32 v89, v89, v97
 v_add_f32 v90, v90, v98
 v_add_f32 v91, v91, v99
 s_nop 0
 v_cvt_pk_bf16_f32 v8, v56, v57
 v_cvt_pk_bf16_f32 v9, v58, v59
 s_waitcnt vmcnt(11) lgkmcnt(2)
 v_mfma_f32_32x32x16_bf16 v[72:87], a[252:255], a[212:215], v[72:87]
 ds_read_b128 a[252:255], v4 offset:1088
 v_cvt_pk_bf16_f32 v10, v60, v61
 v_cvt_pk_bf16_f32 v11, v62, v63
 v_cvt_pk_bf16_f32 v12, v64, v65
 v_cvt_pk_bf16_f32 v13, v66, v67
 v_mfma_f32_32x32x16_bf16 a[168:183], v[24:27], a[136:139], a[168:183]
 v_add_f32 v92, v92, v100
 v_add_f32 v93, v93, v101
 v_add_f32 v94, v94, v102
 v_add_f32 v95, v95, v103
 v_cvt_pk_bf16_f32 v14, v68, v69
 v_cvt_pk_bf16_f32 v15, v70, v71
 s_waitcnt vmcnt(9) lgkmcnt(1)
 v_mfma_f32_32x32x16_bf16 v[56:71], a[248:251], a[216:219], 0
 ds_read_b128 a[248:251], v3 offset:1632
 v_mfma_f32_32x32x16_bf16 a[168:183], v[28:31], a[140:143], a[168:183]
 ds_read_b128 v[96:99], v252 offset:16384
 ds_read_b128 v[100:103], v253 offset:16384
 v_cvt_pk_bf16_f32 v16, v72, v73
 v_cvt_pk_bf16_f32 v17, v74, v75
 s_waitcnt vmcnt(8) lgkmcnt(3)
 v_mfma_f32_32x32x16_bf16 v[56:71], a[252:255], a[220:223], v[56:71]
 ds_read_b128 a[252:255], v4 offset:1632
 v_cvt_pk_bf16_f32 v18, v76, v77
 v_cvt_pk_bf16_f32 v19, v78, v79
 v_cvt_pk_bf16_f32 v20, v80, v81
 v_cvt_pk_bf16_f32 v21, v82, v83
 v_mfma_f32_32x32x16_bf16 a[168:183], v[32:35], v[136:139], a[168:183]
 ds_write_b128 v249, a[156:159] offset:32768
 v_cvt_pk_bf16_f32 v22, v84, v85
 v_cvt_pk_bf16_f32 v23, v86, v87
 s_waitcnt vmcnt(7) lgkmcnt(4)
 v_mfma_f32_32x32x16_bf16 v[72:87], a[248:251], a[224:227], 0
 ds_read_b128 a[248:251], v3 offset:2176
 v_mfma_f32_32x32x16_bf16 a[168:183], v[36:39], v[140:143], a[168:183]
 ds_write_b128 v250, a[160:163] offset:32768
 v_cvt_pk_bf16_f32 v24, v56, v57
 v_cvt_pk_bf16_f32 v25, v58, v59
 s_waitcnt vmcnt(6) lgkmcnt(3)
 v_mfma_f32_32x32x16_bf16 v[72:87], a[252:255], a[228:231], v[72:87]
 ds_read_b128 a[252:255], v4 offset:2176
 v_cvt_pk_bf16_f32 v26, v60, v61
 v_cvt_pk_bf16_f32 v27, v62, v63
 v_cvt_pk_bf16_f32 v28, v64, v65
 v_cvt_pk_bf16_f32 v29, v66, v67
 v_mfma_f32_32x32x16_bf16 a[168:183], v[40:43], v[184:187], a[168:183]
 v_add_f32 v88, v88, v96
 v_add_f32 v89, v89, v97
 v_add_f32_e64 v90, v90, v98
 v_add_f32 v91, v91, v99
 v_cvt_pk_bf16_f32 v30, v68, v69
 v_cvt_pk_bf16_f32 v31, v70, v71
 s_waitcnt vmcnt(5) lgkmcnt(2)
 v_mfma_f32_32x32x16_bf16 v[56:71], a[248:251], a[232:235], 0
 ds_read_b128 a[248:251], v3 offset:2720
 v_mfma_f32_32x32x16_bf16 a[168:183], v[44:47], v[188:191], a[168:183]
 v_add_f32 v92, v92, v100
 v_add_f32 v93, v93, v101
 v_add_f32_e64 v94, v94, v102
 v_add_f32 v95, v95, v103
 v_cvt_pk_bf16_f32 v32, v72, v73
 v_cvt_pk_bf16_f32 v33, v74, v75
 s_waitcnt vmcnt(4) lgkmcnt(1)
 v_mfma_f32_32x32x16_bf16 v[56:71], a[252:255], a[236:239], v[56:71]
 ds_read_b128 a[252:255], v4 offset:2720
 v_cvt_pk_bf16_f32 v34, v76, v77
 v_cvt_pk_bf16_f32 v35, v78, v79
 v_cvt_pk_bf16_f32 v36, v80, v81
 v_cvt_pk_bf16_f32 v37, v82, v83
 v_mfma_f32_32x32x16_bf16 a[168:183], v[48:51], v[232:235], a[168:183]
 ds_read_b128 v[96:99], v252 offset:24576
 ds_read_b128 v[100:103], v253 offset:24576
 ds_read_b128 v[240:243], v0 offset:40960
 v_cvt_pk_bf16_f32 v38, v84, v85
 v_cvt_pk_bf16_f32 v39, v86, v87
 s_waitcnt vmcnt(3) lgkmcnt(4)
 v_mfma_f32_32x32x16_bf16 v[72:87], a[248:251], a[240:243], 0
 v_mfma_f32_32x32x16_bf16 a[168:183], v[52:55], v[236:239], a[168:183]
 ds_write_b128 v251, a[164:167] offset:32768
 v_cvt_pk_bf16_f32 v40, v56, v57
 v_cvt_pk_bf16_f32 v41, v58, v59
 s_waitcnt vmcnt(2) lgkmcnt(4)
 v_mfma_f32_32x32x16_bf16 v[72:87], a[252:255], a[244:247], v[72:87]
 v_cvt_pk_bf16_f32 v42, v60, v61
 v_cvt_pk_bf16_f32 v43, v62, v63
 v_cvt_pk_bf16_f32 v44, v64, v65
 v_cvt_pk_bf16_f32 v45, v66, v67
 v_mfma_f32_32x32x16_bf16 a[152:167], v[8:11], a[0:3], a[184:199]
 v_cvt_pk_bf16_f32 v46, v68, v69
 v_cvt_pk_bf16_f32 v47, v70, v71
 v_mfma_f32_32x32x16_bf16 a[152:167], v[12:15], a[4:7], a[152:167]
 s_mul_i32 s49, s61, 49152
 s_add_u32 s49, s49, 0x380000
 s_add_u32 s85, s49, s94
 buffer_load_dwordx4 a[200:203], v6, s[24:27], s85 offen offset:0 sc1
 s_waitcnt lgkmcnt(1)
 v_add_f32 v88, v88, v96
 v_add_f32 v89, v89, v97
 v_add_f32 v90, v90, v98
 v_add_f32 v91, v91, v99
 v_mfma_f32_32x32x16_bf16 a[152:167], v[16:19], a[48:51], a[152:167]
 v_add_f32 v92, v92, v100
 v_add_f32 v93, v93, v101
 v_add_f32 v94, v94, v102
 v_add_f32 v95, v95, v103
 v_cvt_pk_bf16_f32 v48, v72, v73
 v_cvt_pk_bf16_f32 v49, v74, v75
 v_mfma_f32_32x32x16_bf16 a[152:167], v[20:23], a[52:55], a[152:167]
 ds_write_b128 v248, a[168:171] offset:36864
 v_cvt_pk_bf16_f32 v50, v76, v77
 v_cvt_pk_bf16_f32 v51, v78, v79
 v_cvt_pk_bf16_f32 v52, v80, v81
 v_cvt_pk_bf16_f32 v53, v82, v83
 v_mfma_f32_32x32x16_bf16 a[152:167], v[24:27], a[96:99], a[152:167]
 buffer_load_dwordx4 a[204:207], v6, s[24:27], s85 offen offset:1024 sc1
 v_lshlrev_b32_e64 v96, 16, v240
 v_and_b32 v97, 0xffff0000, v240
 v_lshlrev_b32_e64 v98, 16, v241
 v_and_b32 v99, 0xffff0000, v241
 v_cvt_pk_bf16_f32 v54, v84, v85
 v_cvt_pk_bf16_f32 v55, v86, v87
 v_mfma_f32_32x32x16_bf16 a[152:167], v[28:31], a[100:103], a[152:167]
 ds_write_b128 v249, a[172:175] offset:36864
 v_mfma_f32_32x32x16_bf16 a[152:167], v[32:35], a[144:147], a[152:167]
 v_lshlrev_b32_e64 v100, 16, v242
 v_and_b32 v101, 0xffff0000, v242
 v_lshlrev_b32_e64 v102, 16, v243
 v_and_b32 v103, 0xffff0000, v243
 v_mfma_f32_32x32x16_bf16 a[152:167], v[36:39], a[148:151], a[152:167]
 ds_write_b128 v250, a[176:179] offset:36864
 s_add_u32 s85, s49, s95
 buffer_load_dwordx4 a[208:211], v6, s[24:27], s85 offen offset:0 sc1
 v_mfma_f32_32x32x16_bf16 a[152:167], v[40:43], v[144:147], a[152:167]
 v_add_f32 v88, v88, v96
 v_add_f32 v89, v89, v97
 v_add_f32 v90, v90, v98
 v_add_f32_e64 v91, v91, v99
 v_mfma_f32_32x32x16_bf16 a[152:167], v[44:47], v[148:151], a[152:167]
 ds_write_b128 v251, a[180:183] offset:36864
 v_mfma_f32_32x32x16_bf16 a[152:167], v[48:51], v[192:195], a[152:167]
 buffer_load_dwordx4 a[212:215], v6, s[24:27], s85 offen offset:1024 sc1
 v_add_f32 v92, v92, v100
 v_add_f32 v93, v93, v101
 v_add_f32 v94, v94, v102
 v_add_f32 v95, v95, v103
 v_mfma_f32_32x32x16_bf16 a[152:167], v[52:55], v[196:199], a[152:167]
 v_cvt_pk_bf16_f32 v240, v88, v89
 v_cvt_pk_bf16_f32 v241, v90, v91
 v_cvt_pk_bf16_f32 v242, v92, v93
 v_cvt_pk_bf16_f32 v243, v94, v95
 v_mfma_f32_32x32x16_bf16 a[168:183], v[8:11], a[8:11], a[184:199]
 s_waitcnt lgkmcnt(0)
 s_barrier
 ds_read_b128 v[88:91], v252 offset:32768
 ds_read_b128 v[92:95], v253 offset:32768
 ds_read_b128 v[96:99], v252 offset:40960
 ds_read_b128 v[100:103], v253 offset:40960
 v_mfma_f32_32x32x16_bf16 a[168:183], v[12:15], a[12:15], a[168:183]
 s_lshl_b32 s6, s59, 6
 buffer_store_dwordx4 v[240:243], v245, s[20:23], s6 offen sc1 nt
 s_add_u32 s85, s49, s96
 buffer_load_dwordx4 a[216:219], v6, s[24:27], s85 offen offset:0 sc1
 v_mfma_f32_32x32x16_bf16 a[168:183], v[16:19], a[56:59], a[168:183]
 ds_write_b128 v248, a[152:155] offset:0
 v_mfma_f32_32x32x16_bf16 a[168:183], v[20:23], a[60:63], a[168:183]
 s_waitcnt lgkmcnt(1)
 v_add_f32 v88, v88, v96
 v_add_f32 v89, v89, v97
 v_add_f32 v90, v90, v98
 v_add_f32_e64 v91, v91, v99
 v_mfma_f32_32x32x16_bf16 a[168:183], v[24:27], a[104:107], a[168:183]
 buffer_load_dwordx4 a[220:223], v6, s[24:27], s85 offen offset:1024 sc1
 v_add_f32 v92, v92, v100
 v_add_f32 v93, v93, v101
 v_add_f32 v94, v94, v102
 v_add_f32 v95, v95, v103
 v_mfma_f32_32x32x16_bf16 a[168:183], v[28:31], a[108:111], a[168:183]
 ds_read_b128 v[96:99], v252 offset:49152
 ds_read_b128 v[100:103], v253 offset:49152
 v_mfma_f32_32x32x16_bf16 a[168:183], v[32:35], v[104:107], a[168:183]
 ds_write_b128 v249, a[156:159] offset:0
 v_mfma_f32_32x32x16_bf16 a[168:183], v[36:39], v[108:111], a[168:183]
 ds_write_b128 v250, a[160:163] offset:0
 s_add_u32 s85, s49, s97
 buffer_load_dwordx4 a[224:227], v6, s[24:27], s85 offen offset:0 sc1
 v_mfma_f32_32x32x16_bf16 a[168:183], v[40:43], v[152:155], a[168:183]
 s_waitcnt lgkmcnt(2)
 v_add_f32 v88, v88, v96
 v_add_f32 v89, v89, v97
 v_add_f32 v90, v90, v98
 v_add_f32 v91, v91, v99
 v_mfma_f32_32x32x16_bf16 a[168:183], v[44:47], v[156:159], a[168:183]
 v_add_f32 v92, v92, v100
 v_add_f32 v93, v93, v101
 v_add_f32 v94, v94, v102
 v_add_f32 v95, v95, v103
 v_mfma_f32_32x32x16_bf16 a[168:183], v[48:51], v[200:203], a[168:183]
 ds_read_b128 v[96:99], v252 offset:57344
 ds_read_b128 v[100:103], v253 offset:57344
 ds_read_b128 v[240:243], v0 offset:45056
 buffer_load_dwordx4 a[228:231], v6, s[24:27], s85 offen offset:1024 sc1
 v_mfma_f32_32x32x16_bf16 a[168:183], v[52:55], v[204:207], a[168:183]
 ds_write_b128 v251, a[164:167] offset:0
 v_mfma_f32_32x32x16_bf16 a[152:167], v[8:11], a[16:19], a[184:199]
 v_mfma_f32_32x32x16_bf16 a[152:167], v[12:15], a[20:23], a[152:167]
 s_add_u32 s85, s49, s98
 buffer_load_dwordx4 a[232:235], v6, s[24:27], s85 offen offset:0 sc1
 s_waitcnt lgkmcnt(1)
 v_add_f32 v88, v88, v96
 v_add_f32 v89, v89, v97
 v_add_f32 v90, v90, v98
 v_add_f32 v91, v91, v99
 v_mfma_f32_32x32x16_bf16 a[152:167], v[16:19], a[64:67], a[152:167]
 v_add_f32 v92, v92, v100
 v_add_f32 v93, v93, v101
 v_add_f32 v94, v94, v102
 v_add_f32 v95, v95, v103
 v_mfma_f32_32x32x16_bf16 a[152:167], v[20:23], a[68:71], a[152:167]
 ds_write_b128 v248, a[168:171] offset:4096
 v_mfma_f32_32x32x16_bf16 a[152:167], v[24:27], a[112:115], a[152:167]
 buffer_load_dwordx4 a[236:239], v6, s[24:27], s85 offen offset:1024 sc1
 v_lshlrev_b32_e64 v96, 16, v240
 v_and_b32 v97, 0xffff0000, v240
 v_lshlrev_b32_e64 v98, 16, v241
 v_and_b32 v99, 0xffff0000, v241
 v_mfma_f32_32x32x16_bf16 a[152:167], v[28:31], a[116:119], a[152:167]
 ds_write_b128 v249, a[172:175] offset:4096
 v_mfma_f32_32x32x16_bf16 a[152:167], v[32:35], v[112:115], a[152:167]
 v_lshlrev_b32_e64 v100, 16, v242
 v_and_b32 v101, 0xffff0000, v242
 v_lshlrev_b32_e64 v102, 16, v243
 v_and_b32 v103, 0xffff0000, v243
 v_mfma_f32_32x32x16_bf16 a[152:167], v[36:39], v[116:119], a[152:167]
 ds_write_b128 v250, a[176:179] offset:4096
 s_add_u32 s85, s49, s99
 buffer_load_dwordx4 a[240:243], v6, s[24:27], s85 offen offset:0 sc1
 v_mfma_f32_32x32x16_bf16 a[152:167], v[40:43], v[160:163], a[152:167]
 v_add_f32 v88, v88, v96
 v_add_f32 v89, v89, v97
 v_add_f32 v90, v90, v98
 v_add_f32_e64 v91, v91, v99
 v_mfma_f32_32x32x16_bf16 a[152:167], v[44:47], v[164:167], a[152:167]
 ds_write_b128 v251, a[180:183] offset:4096
 v_mfma_f32_32x32x16_bf16 a[152:167], v[48:51], v[208:211], a[152:167]
 buffer_load_dwordx4 a[244:247], v6, s[24:27], s85 offen offset:1024 sc1
 v_add_f32 v92, v92, v100
 v_add_f32 v93, v93, v101
 v_add_f32 v94, v94, v102
 v_add_f32 v95, v95, v103
 v_mfma_f32_32x32x16_bf16 a[152:167], v[52:55], v[212:215], a[152:167]
 v_cvt_pk_bf16_f32 v240, v88, v89
 v_cvt_pk_bf16_f32 v241, v90, v91
 v_cvt_pk_bf16_f32 v242, v92, v93
 v_cvt_pk_bf16_f32 v243, v94, v95
 v_mfma_f32_32x32x16_bf16 a[168:183], v[8:11], a[24:27], a[184:199]
 s_waitcnt lgkmcnt(0)
 s_barrier
 ds_read_b128 v[88:91], v252 offset:0
 ds_read_b128 v[92:95], v253 offset:0
 ds_read_b128 v[96:99], v252 offset:8192
 ds_read_b128 v[100:103], v253 offset:8192
 v_mfma_f32_32x32x16_bf16 a[168:183], v[12:15], a[28:31], a[168:183]
 s_lshl_b32 s6, s59, 6
 buffer_store_dwordx4 v[240:243], v246, s[20:23], s6 offen sc1 nt
 v_mfma_f32_32x32x16_bf16 a[168:183], v[16:19], a[72:75], a[168:183]
 ds_write_b128 v248, a[152:155] offset:32768
 v_mfma_f32_32x32x16_bf16 a[168:183], v[20:23], a[76:79], a[168:183]
 s_waitcnt lgkmcnt(1)
 v_add_f32 v88, v88, v96
 v_add_f32 v89, v89, v97
 v_add_f32 v90, v90, v98
 v_add_f32 v91, v91, v99
 v_mfma_f32_32x32x16_bf16 a[168:183], v[24:27], a[120:123], a[168:183]
 v_add_f32 v92, v92, v100
 v_add_f32 v93, v93, v101
 v_add_f32 v94, v94, v102
 v_add_f32 v95, v95, v103
 v_mfma_f32_32x32x16_bf16 a[168:183], v[28:31], a[124:127], a[168:183]
 ds_read_b128 v[96:99], v252 offset:16384
 ds_read_b128 v[100:103], v253 offset:16384
 v_mfma_f32_32x32x16_bf16 a[168:183], v[32:35], v[120:123], a[168:183]
 ds_write_b128 v249, a[156:159] offset:32768
 v_mfma_f32_32x32x16_bf16 a[168:183], v[36:39], v[124:127], a[168:183]
 ds_write_b128 v250, a[160:163] offset:32768
 v_mfma_f32_32x32x16_bf16 a[168:183], v[40:43], v[168:171], a[168:183]
 s_waitcnt lgkmcnt(2)
 v_add_f32 v88, v88, v96
 v_add_f32 v89, v89, v97
 v_add_f32 v90, v90, v98
 v_add_f32_e64 v91, v91, v99
 v_mfma_f32_32x32x16_bf16 a[168:183], v[44:47], v[172:175], a[168:183]
 v_add_f32 v92, v92, v100
 v_add_f32 v93, v93, v101
 v_add_f32 v94, v94, v102
 v_add_f32 v95, v95, v103
 v_mfma_f32_32x32x16_bf16 a[168:183], v[48:51], v[216:219], a[168:183]
 ds_read_b128 v[96:99], v252 offset:24576
 ds_read_b128 v[100:103], v253 offset:24576
 ds_read_b128 v[240:243], v0 offset:49152
 v_mfma_f32_32x32x16_bf16 a[168:183], v[52:55], v[220:223], a[168:183]
 ds_write_b128 v251, a[164:167] offset:32768
 v_mfma_f32_32x32x16_bf16 a[152:167], v[8:11], a[32:35], a[184:199]
 v_mfma_f32_32x32x16_bf16 a[152:167], v[12:15], a[36:39], a[152:167]
 s_waitcnt lgkmcnt(1)
 v_add_f32 v88, v88, v96
 v_add_f32 v89, v89, v97
 v_add_f32 v90, v90, v98
 v_add_f32_e64 v91, v91, v99
 v_mfma_f32_32x32x16_bf16 a[152:167], v[16:19], a[80:83], a[152:167]
 v_add_f32 v92, v92, v100
 v_add_f32 v93, v93, v101
 v_add_f32 v94, v94, v102
 v_add_f32 v95, v95, v103
 v_mfma_f32_32x32x16_bf16 a[152:167], v[20:23], a[84:87], a[152:167]
 ds_write_b128 v248, a[168:171] offset:36864
 v_mfma_f32_32x32x16_bf16 a[152:167], v[24:27], a[128:131], a[152:167]
 v_lshlrev_b32_e64 v96, 16, v240
 v_and_b32 v97, 0xffff0000, v240
 v_lshlrev_b32_e64 v98, 16, v241
 v_and_b32 v99, 0xffff0000, v241
 v_mfma_f32_32x32x16_bf16 a[152:167], v[28:31], a[132:135], a[152:167]
 ds_write_b128 v249, a[172:175] offset:36864
 v_mfma_f32_32x32x16_bf16 a[152:167], v[32:35], v[128:131], a[152:167]
 v_lshlrev_b32_e64 v100, 16, v242
 v_and_b32 v101, 0xffff0000, v242
 v_lshlrev_b32_e64 v102, 16, v243
 v_and_b32 v103, 0xffff0000, v243
 v_mfma_f32_32x32x16_bf16 a[152:167], v[36:39], v[132:135], a[152:167]
 ds_write_b128 v250, a[176:179] offset:36864
 ds_read_b128 a[248:251], v3 offset:0
 v_mfma_f32_32x32x16_bf16 a[152:167], v[40:43], v[176:179], a[152:167]
 v_add_f32 v88, v88, v96
 v_add_f32 v89, v89, v97
 v_add_f32 v90, v90, v98
 v_add_f32 v91, v91, v99
 v_mfma_f32_32x32x16_bf16 a[152:167], v[44:47], v[180:183], a[152:167]
 ds_write_b128 v251, a[180:183] offset:36864
 ds_read_b128 a[252:255], v4 offset:0
 v_mfma_f32_32x32x16_bf16 a[152:167], v[48:51], v[224:227], a[152:167]
 v_add_f32 v92, v92, v100
 v_add_f32 v93, v93, v101
 v_add_f32 v94, v94, v102
 v_add_f32 v95, v95, v103
 v_mfma_f32_32x32x16_bf16 a[152:167], v[52:55], v[228:231], a[152:167]
 v_cvt_pk_bf16_f32 v240, v88, v89
 v_cvt_pk_bf16_f32 v241, v90, v91
 v_cvt_pk_bf16_f32 v242, v92, v93
 v_cvt_pk_bf16_f32 v243, v94, v95
 v_mfma_f32_32x32x16_bf16 a[168:183], v[8:11], a[40:43], a[184:199]
 s_waitcnt lgkmcnt(1)
 s_barrier
 ds_read_b128 v[88:91], v252 offset:32768
 ds_read_b128 v[92:95], v253 offset:32768
 ds_read_b128 v[96:99], v252 offset:40960
 ds_read_b128 v[100:103], v253 offset:40960
 s_waitcnt vmcnt(13)
 v_mfma_f32_32x32x16_bf16 v[56:71], a[248:251], a[200:203], 0
 s_lshl_b32 s6, s60, 6
 buffer_store_dwordx4 v[240:243], v244, s[20:23], s6 offen sc1 nt
 ds_read_b128 a[248:251], v3 offset:544
 v_mfma_f32_32x32x16_bf16 a[168:183], v[12:15], a[44:47], a[168:183]
 s_lshl_b32 s6, s61, 7
 v_add_u32 v7, s6, v5
 ds_read_b128 a[184:187], v7 offset:0
 ds_read_b128 a[188:191], v7 offset:32
 ds_read_b128 a[192:195], v7 offset:64
 ds_read_b128 a[196:199], v7 offset:96
 s_waitcnt vmcnt(13) lgkmcnt(9)
 v_mfma_f32_32x32x16_bf16 v[56:71], a[252:255], a[204:207], v[56:71]
 ds_read_b128 a[252:255], v4 offset:544
 v_mfma_f32_32x32x16_bf16 a[168:183], v[16:19], a[88:91], a[168:183]
 ds_write_b128 v248, a[152:155] offset:0
 s_waitcnt vmcnt(12) lgkmcnt(6)
 v_mfma_f32_32x32x16_bf16 v[72:87], a[248:251], a[208:211], 0
 ds_read_b128 a[248:251], v3 offset:1088
 v_mfma_f32_32x32x16_bf16 a[168:183], v[20:23], a[92:95], a[168:183]
 v_add_f32 v88, v88, v96
 v_add_f32 v89, v89, v97
 v_add_f32 v90, v90, v98
 v_add_f32 v91, v91, v99
 s_nop 0
 v_cvt_pk_bf16_f32 v8, v56, v57
 v_cvt_pk_bf16_f32 v9, v58, v59
 s_waitcnt vmcnt(11) lgkmcnt(2)
 v_mfma_f32_32x32x16_bf16 v[72:87], a[252:255], a[212:215], v[72:87]
 ds_read_b128 a[252:255], v4 offset:1088
 v_cvt_pk_bf16_f32 v10, v60, v61
 v_cvt_pk_bf16_f32 v11, v62, v63
 v_cvt_pk_bf16_f32 v12, v64, v65
 v_cvt_pk_bf16_f32 v13, v66, v67
 v_mfma_f32_32x32x16_bf16 a[168:183], v[24:27], a[136:139], a[168:183]
 v_add_f32 v92, v92, v100
 v_add_f32 v93, v93, v101
 v_add_f32 v94, v94, v102
 v_add_f32 v95, v95, v103
 v_cvt_pk_bf16_f32 v14, v68, v69
 v_cvt_pk_bf16_f32 v15, v70, v71
 s_waitcnt vmcnt(9) lgkmcnt(1)
 v_mfma_f32_32x32x16_bf16 v[56:71], a[248:251], a[216:219], 0
 ds_read_b128 a[248:251], v3 offset:1632
 v_mfma_f32_32x32x16_bf16 a[168:183], v[28:31], a[140:143], a[168:183]
 ds_read_b128 v[96:99], v252 offset:49152
 ds_read_b128 v[100:103], v253 offset:49152
 v_cvt_pk_bf16_f32 v16, v72, v73
 v_cvt_pk_bf16_f32 v17, v74, v75
 s_waitcnt vmcnt(8) lgkmcnt(3)
 v_mfma_f32_32x32x16_bf16 v[56:71], a[252:255], a[220:223], v[56:71]
 ds_read_b128 a[252:255], v4 offset:1632
 v_cvt_pk_bf16_f32 v18, v76, v77
 v_cvt_pk_bf16_f32 v19, v78, v79
 v_cvt_pk_bf16_f32 v20, v80, v81
 v_cvt_pk_bf16_f32 v21, v82, v83
 v_mfma_f32_32x32x16_bf16 a[168:183], v[32:35], v[136:139], a[168:183]
 ds_write_b128 v249, a[156:159] offset:0
 v_cvt_pk_bf16_f32 v22, v84, v85
 v_cvt_pk_bf16_f32 v23, v86, v87
 s_waitcnt vmcnt(7) lgkmcnt(4)
 v_mfma_f32_32x32x16_bf16 v[72:87], a[248:251], a[224:227], 0
 ds_read_b128 a[248:251], v3 offset:2176
 v_mfma_f32_32x32x16_bf16 a[168:183], v[36:39], v[140:143], a[168:183]
 ds_write_b128 v250, a[160:163] offset:0
 v_cvt_pk_bf16_f32 v24, v56, v57
 v_cvt_pk_bf16_f32 v25, v58, v59
 s_waitcnt vmcnt(6) lgkmcnt(3)
 v_mfma_f32_32x32x16_bf16 v[72:87], a[252:255], a[228:231], v[72:87]
 ds_read_b128 a[252:255], v4 offset:2176
 v_cvt_pk_bf16_f32 v26, v60, v61
 v_cvt_pk_bf16_f32 v27, v62, v63
 v_cvt_pk_bf16_f32 v28, v64, v65
 v_cvt_pk_bf16_f32 v29, v66, v67
 v_mfma_f32_32x32x16_bf16 a[168:183], v[40:43], v[184:187], a[168:183]
 v_add_f32 v88, v88, v96
 v_add_f32 v89, v89, v97
 v_add_f32_e64 v90, v90, v98
 v_add_f32 v91, v91, v99
 v_cvt_pk_bf16_f32 v30, v68, v69
 v_cvt_pk_bf16_f32 v31, v70, v71
 s_waitcnt vmcnt(5) lgkmcnt(2)
 v_mfma_f32_32x32x16_bf16 v[56:71], a[248:251], a[232:235], 0
 ds_read_b128 a[248:251], v3 offset:2720
 v_mfma_f32_32x32x16_bf16 a[168:183], v[44:47], v[188:191], a[168:183]
 v_add_f32 v92, v92, v100
 v_add_f32 v93, v93, v101
 v_add_f32_e64 v94, v94, v102
 v_add_f32 v95, v95, v103
 v_cvt_pk_bf16_f32 v32, v72, v73
 v_cvt_pk_bf16_f32 v33, v74, v75
 s_waitcnt vmcnt(4) lgkmcnt(1)
 v_mfma_f32_32x32x16_bf16 v[56:71], a[252:255], a[236:239], v[56:71]
 ds_read_b128 a[252:255], v4 offset:2720
 v_cvt_pk_bf16_f32 v34, v76, v77
 v_cvt_pk_bf16_f32 v35, v78, v79
 v_cvt_pk_bf16_f32 v36, v80, v81
 v_cvt_pk_bf16_f32 v37, v82, v83
 v_mfma_f32_32x32x16_bf16 a[168:183], v[48:51], v[232:235], a[168:183]
 ds_read_b128 v[96:99], v252 offset:57344
 ds_read_b128 v[100:103], v253 offset:57344
 ds_read_b128 v[240:243], v0 offset:53248
 v_cvt_pk_bf16_f32 v38, v84, v85
 v_cvt_pk_bf16_f32 v39, v86, v87
 s_waitcnt vmcnt(3) lgkmcnt(4)
 v_mfma_f32_32x32x16_bf16 v[72:87], a[248:251], a[240:243], 0
 v_mfma_f32_32x32x16_bf16 a[168:183], v[52:55], v[236:239], a[168:183]
 ds_write_b128 v251, a[164:167] offset:0
 v_cvt_pk_bf16_f32 v40, v56, v57
 v_cvt_pk_bf16_f32 v41, v58, v59
 s_waitcnt vmcnt(2) lgkmcnt(4)
 v_mfma_f32_32x32x16_bf16 v[72:87], a[252:255], a[244:247], v[72:87]
 v_cvt_pk_bf16_f32 v42, v60, v61
 v_cvt_pk_bf16_f32 v43, v62, v63
 v_cvt_pk_bf16_f32 v44, v64, v65
 v_cvt_pk_bf16_f32 v45, v66, v67
 v_mfma_f32_32x32x16_bf16 a[152:167], v[8:11], a[0:3], a[184:199]
 v_cvt_pk_bf16_f32 v46, v68, v69
 v_cvt_pk_bf16_f32 v47, v70, v71
 v_mfma_f32_32x32x16_bf16 a[152:167], v[12:15], a[4:7], a[152:167]
 s_waitcnt lgkmcnt(1)
 v_add_f32 v88, v88, v96
 v_add_f32 v89, v89, v97
 v_add_f32 v90, v90, v98
 v_add_f32_e64 v91, v91, v99
 v_mfma_f32_32x32x16_bf16 a[152:167], v[16:19], a[48:51], a[152:167]
 v_add_f32 v92, v92, v100
 v_add_f32 v93, v93, v101
 v_add_f32 v94, v94, v102
 v_add_f32 v95, v95, v103
 v_cvt_pk_bf16_f32 v48, v72, v73
 v_cvt_pk_bf16_f32 v49, v74, v75
 v_mfma_f32_32x32x16_bf16 a[152:167], v[20:23], a[52:55], a[152:167]
 ds_write_b128 v248, a[168:171] offset:4096
 v_cvt_pk_bf16_f32 v50, v76, v77
 v_cvt_pk_bf16_f32 v51, v78, v79
 v_cvt_pk_bf16_f32 v52, v80, v81
 v_cvt_pk_bf16_f32 v53, v82, v83
 v_mfma_f32_32x32x16_bf16 a[152:167], v[24:27], a[96:99], a[152:167]
 v_lshlrev_b32_e64 v96, 16, v240
 v_and_b32 v97, 0xffff0000, v240
 v_lshlrev_b32_e64 v98, 16, v241
 v_and_b32 v99, 0xffff0000, v241
 v_cvt_pk_bf16_f32 v54, v84, v85
 v_cvt_pk_bf16_f32 v55, v86, v87
 v_mfma_f32_32x32x16_bf16 a[152:167], v[28:31], a[100:103], a[152:167]
 ds_write_b128 v249, a[172:175] offset:4096
 v_mfma_f32_32x32x16_bf16 a[152:167], v[32:35], a[144:147], a[152:167]
 v_lshlrev_b32_e64 v100, 16, v242
 v_and_b32 v101, 0xffff0000, v242
 v_lshlrev_b32_e64 v102, 16, v243
 v_and_b32 v103, 0xffff0000, v243
 v_mfma_f32_32x32x16_bf16 a[152:167], v[36:39], a[148:151], a[152:167]
 ds_write_b128 v250, a[176:179] offset:4096
 v_mfma_f32_32x32x16_bf16 a[152:167], v[40:43], v[144:147], a[152:167]
 v_add_f32 v88, v88, v96
 v_add_f32 v89, v89, v97
 v_add_f32 v90, v90, v98
 v_add_f32 v91, v91, v99
 v_mfma_f32_32x32x16_bf16 a[152:167], v[44:47], v[148:151], a[152:167]
 ds_write_b128 v251, a[180:183] offset:4096
 v_mfma_f32_32x32x16_bf16 a[152:167], v[48:51], v[192:195], a[152:167]
 v_add_f32 v92, v92, v100
 v_add_f32 v93, v93, v101
 v_add_f32 v94, v94, v102
 v_add_f32 v95, v95, v103
 v_mfma_f32_32x32x16_bf16 a[152:167], v[52:55], v[196:199], a[152:167]
 v_cvt_pk_bf16_f32 v240, v88, v89
 v_cvt_pk_bf16_f32 v241, v90, v91
 v_cvt_pk_bf16_f32 v242, v92, v93
 v_cvt_pk_bf16_f32 v243, v94, v95
 v_mfma_f32_32x32x16_bf16 a[168:183], v[8:11], a[8:11], a[184:199]
 s_waitcnt lgkmcnt(0)
 s_barrier
 ds_read_b128 v[88:91], v252 offset:0
 ds_read_b128 v[92:95], v253 offset:0
 ds_read_b128 v[96:99], v252 offset:8192
 ds_read_b128 v[100:103], v253 offset:8192
 s_mul_i32 s49, s5, 49152
 s_mul_i32 s6, s3, 12288
 s_add_u32 s49, s49, s6
 s_add_u32 s49, s49, 0x180000
 s_cmp_lt_u32 s4, 6
 s_cselect_b32 s49, s49, 0x40000000
 s_lshl_b32 s6, s56, 11
 s_add_u32 s6, s6, s49
 buffer_load_dwordx4 a[0:3], v6, s[24:27], s6 offen offset:0 sc1
 v_mfma_f32_32x32x16_bf16 a[168:183], v[12:15], a[12:15], a[168:183]
 s_lshl_b32 s6, s60, 6
 buffer_store_dwordx4 v[240:243], v245, s[20:23], s6 offen sc1 nt
 v_mfma_f32_32x32x16_bf16 a[168:183], v[16:19], a[56:59], a[168:183]
 ds_write_b128 v248, a[152:155] offset:32768
 s_lshl_b32 s6, s56, 11
 s_add_u32 s6, s6, s49
 buffer_load_dwordx4 a[4:7], v6, s[24:27], s6 offen offset:1024 sc1
 v_mfma_f32_32x32x16_bf16 a[168:183], v[20:23], a[60:63], a[168:183]
 s_waitcnt lgkmcnt(1)
 v_add_f32 v88, v88, v96
 v_add_f32 v89, v89, v97
 v_add_f32 v90, v90, v98
 v_add_f32_e64 v91, v91, v99
 v_mfma_f32_32x32x16_bf16 a[168:183], v[24:27], a[104:107], a[168:183]
 s_lshl_b32 s6, s57, 11
 s_add_u32 s6, s6, s49
 buffer_load_dwordx4 a[48:51], v6, s[24:27], s6 offen offset:0 sc1
 v_add_f32 v92, v92, v100
 v_add_f32 v93, v93, v101
 v_add_f32 v94, v94, v102
 v_add_f32 v95, v95, v103
 v_mfma_f32_32x32x16_bf16 a[168:183], v[28:31], a[108:111], a[168:183]
 ds_read_b128 v[96:99], v252 offset:16384
 ds_read_b128 v[100:103], v253 offset:16384
 v_mfma_f32_32x32x16_bf16 a[168:183], v[32:35], v[104:107], a[168:183]
 ds_write_b128 v249, a[156:159] offset:32768
 s_lshl_b32 s6, s57, 11
 s_add_u32 s6, s6, s49
 buffer_load_dwordx4 a[52:55], v6, s[24:27], s6 offen offset:1024 sc1
 v_mfma_f32_32x32x16_bf16 a[168:183], v[36:39], v[108:111], a[168:183]
 ds_write_b128 v250, a[160:163] offset:32768
 v_mfma_f32_32x32x16_bf16 a[168:183], v[40:43], v[152:155], a[168:183]
 s_lshl_b32 s6, s58, 11
 s_add_u32 s6, s6, s49
 buffer_load_dwordx4 a[96:99], v6, s[24:27], s6 offen offset:0 sc1
 s_waitcnt lgkmcnt(2)
 v_add_f32 v88, v88, v96
 v_add_f32 v89, v89, v97
 v_add_f32 v90, v90, v98
 v_add_f32_e64 v91, v91, v99
 v_mfma_f32_32x32x16_bf16 a[168:183], v[44:47], v[156:159], a[168:183]
 v_add_f32 v92, v92, v100
 v_add_f32 v93, v93, v101
 v_add_f32 v94, v94, v102
 v_add_f32 v95, v95, v103
 v_mfma_f32_32x32x16_bf16 a[168:183], v[48:51], v[200:203], a[168:183]
 ds_read_b128 v[96:99], v252 offset:24576
 ds_read_b128 v[100:103], v253 offset:24576
 ds_read_b128 v[240:243], v0 offset:57344
 s_lshl_b32 s6, s58, 11
 s_add_u32 s6, s6, s49
 buffer_load_dwordx4 a[100:103], v6, s[24:27], s6 offen offset:1024 sc1
 v_mfma_f32_32x32x16_bf16 a[168:183], v[52:55], v[204:207], a[168:183]
 ds_write_b128 v251, a[164:167] offset:32768
 v_mfma_f32_32x32x16_bf16 a[152:167], v[8:11], a[16:19], a[184:199]
 s_lshl_b32 s6, s59, 11
 s_add_u32 s6, s6, s49
 buffer_load_dwordx4 a[144:147], v6, s[24:27], s6 offen offset:0 sc1
 v_mfma_f32_32x32x16_bf16 a[152:167], v[12:15], a[20:23], a[152:167]
 s_waitcnt lgkmcnt(1)
 v_add_f32 v88, v88, v96
 v_add_f32 v89, v89, v97
 v_add_f32 v90, v90, v98
 v_add_f32_e64 v91, v91, v99
 v_mfma_f32_32x32x16_bf16 a[152:167], v[16:19], a[64:67], a[152:167]
 s_lshl_b32 s6, s59, 11
 s_add_u32 s6, s6, s49
 buffer_load_dwordx4 a[148:151], v6, s[24:27], s6 offen offset:1024 sc1
 v_add_f32 v92, v92, v100
 v_add_f32 v93, v93, v101
 v_add_f32 v94, v94, v102
 v_add_f32 v95, v95, v103
 v_mfma_f32_32x32x16_bf16 a[152:167], v[20:23], a[68:71], a[152:167]
 ds_write_b128 v248, a[168:171] offset:36864
 v_mfma_f32_32x32x16_bf16 a[152:167], v[24:27], a[112:115], a[152:167]
 s_lshl_b32 s6, s60, 11
 s_add_u32 s6, s6, s49
 buffer_load_dwordx4 v[144:147], v6, s[24:27], s6 offen offset:0 sc1
 v_lshlrev_b32_e64 v96, 16, v240
 v_and_b32 v97, 0xffff0000, v240
 v_lshlrev_b32_e64 v98, 16, v241
 v_and_b32 v99, 0xffff0000, v241
 v_mfma_f32_32x32x16_bf16 a[152:167], v[28:31], a[116:119], a[152:167]
 ds_write_b128 v249, a[172:175] offset:36864
 v_mfma_f32_32x32x16_bf16 a[152:167], v[32:35], v[112:115], a[152:167]
 s_lshl_b32 s6, s60, 11
 s_add_u32 s6, s6, s49
 buffer_load_dwordx4 v[148:151], v6, s[24:27], s6 offen offset:1024 sc1
 v_lshlrev_b32_e64 v100, 16, v242
 v_and_b32 v101, 0xffff0000, v242
 v_lshlrev_b32_e64 v102, 16, v243
 v_and_b32 v103, 0xffff0000, v243
 v_add_u32 v0, 12288, v0
 v_mfma_f32_32x32x16_bf16 a[152:167], v[36:39], v[116:119], a[152:167]
 ds_write_b128 v250, a[176:179] offset:36864
 v_mfma_f32_32x32x16_bf16 a[152:167], v[40:43], v[160:163], a[152:167]
 s_lshl_b32 s6, s61, 11
 s_add_u32 s6, s6, s49
 buffer_load_dwordx4 v[192:195], v6, s[24:27], s6 offen offset:0 sc1
 v_add_f32 v88, v88, v96
 v_add_f32 v89, v89, v97
 v_add_f32 v90, v90, v98
 v_add_f32 v91, v91, v99
 v_mfma_f32_32x32x16_bf16 a[152:167], v[44:47], v[164:167], a[152:167]
 ds_write_b128 v251, a[180:183] offset:36864
 v_mfma_f32_32x32x16_bf16 a[152:167], v[48:51], v[208:211], a[152:167]
 s_lshl_b32 s6, s61, 11
 s_add_u32 s6, s6, s49
 buffer_load_dwordx4 v[196:199], v6, s[24:27], s6 offen offset:1024 sc1
 v_add_f32 v92, v92, v100
 v_add_f32 v93, v93, v101
 v_add_f32 v94, v94, v102
 v_add_f32 v95, v95, v103
 v_mfma_f32_32x32x16_bf16 a[152:167], v[52:55], v[212:215], a[152:167]
 v_cvt_pk_bf16_f32 v240, v88, v89
 v_cvt_pk_bf16_f32 v241, v90, v91
 v_cvt_pk_bf16_f32 v242, v92, v93
 v_cvt_pk_bf16_f32 v243, v94, v95
 v_mfma_f32_32x32x16_bf16 a[168:183], v[8:11], a[24:27], a[184:199]
 s_waitcnt lgkmcnt(0)
 s_barrier
 ds_read_b128 v[88:91], v252 offset:32768
 ds_read_b128 v[92:95], v253 offset:32768
 ds_read_b128 v[96:99], v252 offset:40960
 ds_read_b128 v[100:103], v253 offset:40960
 v_lshrrev_b32 v58, 4, v6
 v_lshrrev_b32 v59, 2, v58
 v_and_b32 v59, 7, v59
 s_lshl_b32 s84, s3, 3
 v_mfma_f32_32x32x16_bf16 a[168:183], v[12:15], a[28:31], a[168:183]
 s_lshl_b32 s6, s60, 6
 buffer_store_dwordx4 v[240:243], v246, s[20:23], s6 offen sc1 nt
 v_add_u32 v59, s84, v59
 v_and_b32 v60, 3, v58
 v_and_b32 v61, 7, v59
 v_xor_b32_e64 v61, v60, v61
 v_mfma_f32_32x32x16_bf16 a[168:183], v[16:19], a[72:75], a[168:183]
 ds_write_b128 v248, a[152:155] offset:0
 v_lshlrev_b32_e64 v61, 4, v61
 v_lshl_add_u32 v61, v59, 7, v61
 v_add_u32 v56, 98304, v61
 v_xor_b32_e64 v57, 64, v56
 v_mfma_f32_32x32x16_bf16 a[168:183], v[20:23], a[76:79], a[168:183]
 s_waitcnt lgkmcnt(1)
 v_add_f32 v88, v88, v96
 v_add_f32 v89, v89, v97
 v_add_f32 v90, v90, v98
 v_add_f32 v91, v91, v99
 v_lshrrev_b32 v61, 2, v59
 v_lshrrev_b32_e64 v62, 1, v61
 v_lshlrev_b32 v62, 2, v62
 s_lshr_b32 s84, s5, 3
 v_mfma_f32_32x32x16_bf16 a[168:183], v[24:27], a[120:123], a[168:183]
 v_add_f32 v92, v92, v100
 v_add_f32 v93, v93, v101
 v_add_f32 v94, v94, v102
 v_add_f32 v95, v95, v103
 v_add_u32 v62, s84, v62
 v_and_b32 v61, 1, v61
 v_lshlrev_b32 v61, 3, v61
 s_and_b32 s84, s5, 7
 v_mfma_f32_32x32x16_bf16 a[168:183], v[28:31], a[124:127], a[168:183]
 ds_read_b128 v[96:99], v252 offset:49152
 ds_read_b128 v[100:103], v253 offset:49152
 v_add_u32 v61, s84, v61
 v_mul_u32_u24 v62, 14, v62
 v_add_u32_e64 v62, 13, v62
 v_mul_u32_u24 v62, 224, v62
 v_mfma_f32_32x32x16_bf16 a[168:183], v[32:35], v[120:123], a[168:183]
 ds_write_b128 v249, a[156:159] offset:0
 v_mul_u32_u24 v61, 14, v61
 v_and_b32 v63, 3, v59
 v_add3_u32 v61, v61, v63, 10
 v_add_u32_e64 v62, v62, v61
 v_mfma_f32_32x32x16_bf16 a[168:183], v[36:39], v[124:127], a[168:183]
 ds_write_b128 v250, a[160:163] offset:0
 v_mul_u32_u24 v62, 384, v62
 v_lshl_add_u32 v62, v60, 4, v62
 v_mov_b32 v63, 0x40000000
 v_cmp_gt_u32 vcc, 32, v58
 v_mfma_f32_32x32x16_bf16 a[168:183], v[40:43], v[168:171], a[168:183]
 s_waitcnt lgkmcnt(2)
 v_add_f32 v88, v88, v96
 v_add_f32 v89, v89, v97
 v_add_f32 v90, v90, v98
 v_add_f32 v91, v91, v99
 v_cndmask_b32 v62, v63, v62, vcc
 s_cmp_lt_u32 s4, 6
 s_cselect_b32 s84, 0, 0x40000000
 v_add_u32_e64 v247, s84, v62
 v_mfma_f32_32x32x16_bf16 a[168:183], v[44:47], v[172:175], a[168:183]
 v_add_f32 v92, v92, v100
 v_add_f32 v93, v93, v101
 v_add_f32 v94, v94, v102
 v_add_f32 v95, v95, v103
 v_mfma_f32_32x32x16_bf16 a[168:183], v[48:51], v[216:219], a[168:183]
 ds_read_b128 v[96:99], v252 offset:57344
 ds_read_b128 v[100:103], v253 offset:57344
 ds_read_b128 v[240:243], v0 offset:49152
 v_mfma_f32_32x32x16_bf16 a[168:183], v[52:55], v[220:223], a[168:183]
 ds_write_b128 v251, a[164:167] offset:0
 v_mfma_f32_32x32x16_bf16 a[152:167], v[8:11], a[32:35], a[184:199]
 v_mfma_f32_32x32x16_bf16 a[152:167], v[12:15], a[36:39], a[152:167]
 s_lshl_b32 s87, s61, 6
 buffer_load_dwordx4 v[200:203], v247, s[8:11], s87 offen
 s_waitcnt lgkmcnt(1)
 v_add_f32 v88, v88, v96
 v_add_f32 v89, v89, v97
 v_add_f32 v90, v90, v98
 v_add_f32 v91, v91, v99
 v_mfma_f32_32x32x16_bf16 a[152:167], v[16:19], a[80:83], a[152:167]
 v_add_f32 v92, v92, v100
 v_add_f32 v93, v93, v101
 v_add_f32 v94, v94, v102
 v_add_f32 v95, v95, v103
 v_mfma_f32_32x32x16_bf16 a[152:167], v[20:23], a[84:87], a[152:167]
 ds_write_b128 v248, a[168:171] offset:4096
 v_mfma_f32_32x32x16_bf16 a[152:167], v[24:27], a[128:131], a[152:167]
 v_lshlrev_b32_e64 v96, 16, v240
 v_and_b32 v97, 0xffff0000, v240
 v_lshlrev_b32_e64 v98, 16, v241
 v_and_b32 v99, 0xffff0000, v241
 v_mfma_f32_32x32x16_bf16 a[152:167], v[28:31], a[132:135], a[152:167]
 ds_write_b128 v249, a[172:175] offset:4096
 v_mfma_f32_32x32x16_bf16 a[152:167], v[32:35], v[128:131], a[152:167]
 v_lshlrev_b32_e64 v100, 16, v242
 v_and_b32 v101, 0xffff0000, v242
 v_lshlrev_b32_e64 v102, 16, v243
 v_and_b32 v103, 0xffff0000, v243
 v_mfma_f32_32x32x16_bf16 a[152:167], v[36:39], v[132:135], a[152:167]
 ds_write_b128 v250, a[176:179] offset:4096
 v_mfma_f32_32x32x16_bf16 a[152:167], v[40:43], v[176:179], a[152:167]
 v_add_f32 v88, v88, v96
 v_add_f32 v89, v89, v97
 v_add_f32 v90, v90, v98
 v_add_f32 v91, v91, v99
 v_mfma_f32_32x32x16_bf16 a[152:167], v[44:47], v[180:183], a[152:167]
 ds_write_b128 v251, a[180:183] offset:4096
 v_mfma_f32_32x32x16_bf16 a[152:167], v[48:51], v[224:227], a[152:167]
 v_add_f32 v92, v92, v100
 v_add_f32 v93, v93, v101
 v_add_f32 v94, v94, v102
 v_add_f32 v95, v95, v103
 v_mfma_f32_32x32x16_bf16 a[152:167], v[52:55], v[228:231], a[152:167]
 v_cvt_pk_bf16_f32 v240, v88, v89
 v_cvt_pk_bf16_f32 v241, v90, v91
 v_cvt_pk_bf16_f32 v242, v92, v93
 v_cvt_pk_bf16_f32 v243, v94, v95
 v_mfma_f32_32x32x16_bf16 a[168:183], v[8:11], a[40:43], a[184:199]
 s_waitcnt lgkmcnt(0)
 s_barrier
 ds_read_b128 v[88:91], v252 offset:0
 ds_read_b128 v[92:95], v253 offset:0
 ds_read_b128 v[96:99], v252 offset:8192
 ds_read_b128 v[100:103], v253 offset:8192
 v_mfma_f32_32x32x16_bf16 a[168:183], v[12:15], a[44:47], a[168:183]
 s_lshl_b32 s6, s61, 6
 buffer_store_dwordx4 v[240:243], v244, s[20:23], s6 offen sc1 nt
 v_mfma_f32_32x32x16_bf16 a[168:183], v[16:19], a[88:91], a[168:183]
 ds_write_b128 v248, a[152:155] offset:32768
 v_mfma_f32_32x32x16_bf16 a[168:183], v[20:23], a[92:95], a[168:183]
 s_waitcnt lgkmcnt(1)
 v_add_f32 v88, v88, v96
 v_add_f32 v89, v89, v97
 v_add_f32 v90, v90, v98
 v_add_f32 v91, v91, v99
 v_mfma_f32_32x32x16_bf16 a[168:183], v[24:27], a[136:139], a[168:183]
 v_add_f32 v92, v92, v100
 v_add_f32 v93, v93, v101
 v_add_f32 v94, v94, v102
 v_add_f32 v95, v95, v103
 v_mfma_f32_32x32x16_bf16 a[168:183], v[28:31], a[140:143], a[168:183]
 ds_read_b128 v[96:99], v252 offset:16384
 ds_read_b128 v[100:103], v253 offset:16384
 v_mfma_f32_32x32x16_bf16 a[168:183], v[32:35], v[136:139], a[168:183]
 ds_write_b128 v249, a[156:159] offset:32768
 v_mfma_f32_32x32x16_bf16 a[168:183], v[36:39], v[140:143], a[168:183]
 ds_write_b128 v250, a[160:163] offset:32768
 v_mfma_f32_32x32x16_bf16 a[168:183], v[40:43], v[184:187], a[168:183]
 s_waitcnt lgkmcnt(2)
 v_add_f32 v88, v88, v96
 v_add_f32 v89, v89, v97
 v_add_f32 v90, v90, v98
 v_add_f32_e64 v91, v91, v99
 v_mfma_f32_32x32x16_bf16 a[168:183], v[44:47], v[188:191], a[168:183]
 v_add_f32 v92, v92, v100
 v_add_f32 v93, v93, v101
 v_add_f32 v94, v94, v102
 v_add_f32 v95, v95, v103
 v_mfma_f32_32x32x16_bf16 a[168:183], v[48:51], v[232:235], a[168:183]
 ds_read_b128 v[96:99], v252 offset:24576
 ds_read_b128 v[100:103], v253 offset:24576
 ds_read_b128 v[240:243], v0 offset:53248
 v_mfma_f32_32x32x16_bf16 a[168:183], v[52:55], v[236:239], a[168:183]
 ds_write_b128 v251, a[164:167] offset:32768
 s_waitcnt vmcnt(15)
 v_mfma_f32_32x32x16_bf16 a[152:167], v[8:11], a[0:3], a[184:199]
 s_waitcnt vmcnt(13)
 v_mfma_f32_32x32x16_bf16 a[152:167], v[12:15], a[4:7], a[152:167]
 s_waitcnt lgkmcnt(1)
 v_add_f32 v88, v88, v96
 v_add_f32 v89, v89, v97
 v_add_f32 v90, v90, v98
 v_add_f32 v91, v91, v99
 s_waitcnt vmcnt(12)
 v_mfma_f32_32x32x16_bf16 a[152:167], v[16:19], a[48:51], a[152:167]
 v_add_f32 v92, v92, v100
 v_add_f32 v93, v93, v101
 v_add_f32_e64 v94, v94, v102
 v_add_f32 v95, v95, v103
 s_waitcnt vmcnt(11)
 v_mfma_f32_32x32x16_bf16 a[152:167], v[20:23], a[52:55], a[152:167]
 ds_write_b128 v248, a[168:171] offset:36864
 s_waitcnt vmcnt(10)
 v_mfma_f32_32x32x16_bf16 a[152:167], v[24:27], a[96:99], a[152:167]
 v_lshlrev_b32 v96, 16, v240
 v_and_b32 v97, 0xffff0000, v240
 v_lshlrev_b32 v98, 16, v241
 v_and_b32 v99, 0xffff0000, v241
 s_waitcnt vmcnt(9)
 v_mfma_f32_32x32x16_bf16 a[152:167], v[28:31], a[100:103], a[152:167]
 ds_write_b128 v249, a[172:175] offset:36864
 s_waitcnt vmcnt(8)
 v_mfma_f32_32x32x16_bf16 a[152:167], v[32:35], a[144:147], a[152:167]
 v_lshlrev_b32 v100, 16, v242
 v_and_b32 v101, 0xffff0000, v242
 v_lshlrev_b32 v102, 16, v243
 v_and_b32 v103, 0xffff0000, v243
 s_waitcnt vmcnt(7)
 v_mfma_f32_32x32x16_bf16 a[152:167], v[36:39], a[148:151], a[152:167]
 ds_write_b128 v250, a[176:179] offset:36864
 s_waitcnt vmcnt(6)
 v_mfma_f32_32x32x16_bf16 a[152:167], v[40:43], v[144:147], a[152:167]
 v_add_f32 v88, v88, v96
 v_add_f32 v89, v89, v97
 v_add_f32 v90, v90, v98
 v_add_f32 v91, v91, v99
 s_waitcnt vmcnt(5)
 v_mfma_f32_32x32x16_bf16 a[152:167], v[44:47], v[148:151], a[152:167]
 ds_write_b128 v251, a[180:183] offset:36864
 s_waitcnt vmcnt(4)
 v_mfma_f32_32x32x16_bf16 a[152:167], v[48:51], v[192:195], a[152:167]
 v_add_f32 v92, v92, v100
 v_add_f32 v93, v93, v101
 v_add_f32 v94, v94, v102
 v_add_f32 v95, v95, v103
 s_waitcnt vmcnt(3)
 v_mfma_f32_32x32x16_bf16 a[152:167], v[52:55], v[196:199], a[152:167]
 v_cvt_pk_bf16_f32 v240, v88, v89
 v_cvt_pk_bf16_f32 v241, v90, v91
 v_cvt_pk_bf16_f32 v242, v92, v93
 v_cvt_pk_bf16_f32 v243, v94, v95
 s_lshl_b32 s6, s61, 6
 buffer_store_dwordx4 v[240:243], v245, s[20:23], s6 offen sc1 nt
 s_waitcnt lgkmcnt(0)
 s_barrier
 s_nop 3
 ds_write_b128 v248, a[152:155] offset:0
 ds_write_b128 v249, a[156:159] offset:0
 ds_write_b128 v250, a[160:163] offset:0
 ds_write_b128 v251, a[164:167] offset:0
 s_waitcnt lgkmcnt(0)
 s_barrier
 ds_read_b128 v[104:107], v252 offset:32768
 ds_read_b128 v[108:111], v253 offset:32768
 ds_read_b128 v[112:115], v252 offset:40960
 ds_read_b128 v[116:119], v253 offset:40960
 ds_read_b128 v[120:123], v252 offset:49152
 ds_read_b128 v[124:127], v253 offset:49152
 ds_read_b128 v[128:131], v252 offset:57344
 ds_read_b128 v[132:135], v253 offset:57344
 ds_read_b128 v[136:139], v0 offset:57344
 ds_read_b128 v[152:155], v56 offset:0
 ds_read_b128 v[156:159], v57 offset:0
 ds_read_b128 v[160:163], v56 offset:8192
 ds_read_b128 v[164:167], v57 offset:8192
 ds_read_b128 v[168:171], v56 offset:16384
 ds_read_b128 v[172:175], v57 offset:16384
 ds_read_b128 v[176:179], v56 offset:24576
 ds_read_b128 v[180:183], v57 offset:24576
 s_waitcnt lgkmcnt(14)
 v_add_f32 v104, v104, v112
 v_add_f32 v105, v105, v113
 v_add_f32 v106, v106, v114
 v_add_f32 v107, v107, v115
 s_waitcnt lgkmcnt(13)
 v_add_f32 v108, v108, v116
 v_add_f32 v109, v109, v117
 v_add_f32 v110, v110, v118
 v_add_f32 v111, v111, v119
 s_waitcnt lgkmcnt(10)
 v_add_f32 v120, v120, v128
 v_add_f32 v121, v121, v129
 v_add_f32 v122, v122, v130
 v_add_f32 v123, v123, v131
 s_waitcnt lgkmcnt(9)
 v_add_f32 v124, v124, v132
 v_add_f32 v125, v125, v133
 v_add_f32 v126, v126, v134
 v_add_f32 v127, v127, v135
 s_waitcnt lgkmcnt(8)
 v_lshlrev_b32 v112, 16, v136
 v_and_b32 v113, 0xffff0000, v136
 v_lshlrev_b32_e64 v114, 16, v137
 v_and_b32 v115, 0xffff0000, v137
 v_lshlrev_b32_e64 v116, 16, v138
 v_and_b32 v117, 0xffff0000, v138
 v_lshlrev_b32_e64 v118, 16, v139
 v_and_b32 v119, 0xffff0000, v139
 v_add_f32 v104, v104, v120
 v_add_f32 v105, v105, v121
 v_add_f32 v106, v106, v122
 v_add_f32 v107, v107, v123
 v_add_f32 v108, v108, v124
 v_add_f32 v109, v109, v125
 v_add_f32 v110, v110, v126
 v_add_f32 v111, v111, v127
 v_add_f32 v104, v104, v112
 v_add_f32 v105, v105, v113
 v_add_f32 v106, v106, v114
 v_add_f32 v107, v107, v115
 v_add_f32 v108, v108, v116
 v_add_f32 v109, v109, v117
 v_add_f32 v110, v110, v118
 v_add_f32 v111, v111, v119
 v_cvt_pk_bf16_f32 v140, v104, v105
 v_cvt_pk_bf16_f32 v141, v106, v107
 v_cvt_pk_bf16_f32 v142, v108, v109
 v_cvt_pk_bf16_f32 v143, v110, v111
 s_lshl_b32 s6, s61, 6
 buffer_store_dwordx4 v[140:143], v246, s[20:23], s6 offen sc1 nt
 s_waitcnt lgkmcnt(5)
 v_add_f32 v152, v152, v160
 v_add_f32 v153, v153, v161
 v_add_f32 v154, v154, v162
 v_add_f32 v155, v155, v163
 s_waitcnt lgkmcnt(4)
 v_add_f32 v156, v156, v164
 v_add_f32 v157, v157, v165
 v_add_f32 v158, v158, v166
 v_add_f32 v159, v159, v167
 s_waitcnt lgkmcnt(1)
 v_add_f32 v168, v168, v176
 v_add_f32 v169, v169, v177
 v_add_f32 v170, v170, v178
 v_add_f32 v171, v171, v179
 s_waitcnt lgkmcnt(0)
 v_add_f32 v172, v172, v180
 v_add_f32 v173, v173, v181
 v_add_f32 v174, v174, v182
 v_add_f32 v175, v175, v183
 s_waitcnt vmcnt(3)
 v_lshlrev_b32_e64 v160, 16, v200
 v_and_b32 v161, 0xffff0000, v200
 v_lshlrev_b32_e64 v162, 16, v201
 v_and_b32 v163, 0xffff0000, v201
 v_lshlrev_b32_e64 v164, 16, v202
 v_and_b32 v165, 0xffff0000, v202
 v_lshlrev_b32_e64 v166, 16, v203
 v_and_b32 v167, 0xffff0000, v203
 v_add_f32 v152, v152, v168
 v_add_f32 v153, v153, v169
 v_add_f32 v154, v154, v170
 v_add_f32 v155, v155, v171
 v_add_f32 v156, v156, v172
 v_add_f32 v157, v157, v173
 v_add_f32 v158, v158, v174
 v_add_f32 v159, v159, v175
 v_add_f32 v152, v152, v160
 v_add_f32 v153, v153, v161
 v_add_f32 v154, v154, v162
 v_add_f32 v155, v155, v163
 v_add_f32 v156, v156, v164
 v_add_f32 v157, v157, v165
 v_add_f32 v158, v158, v166
 v_add_f32 v159, v159, v167
 v_cvt_pk_bf16_f32 v188, v152, v153
 v_cvt_pk_bf16_f32 v189, v154, v155
 v_cvt_pk_bf16_f32 v190, v156, v157
 v_cvt_pk_bf16_f32 v191, v158, v159
 s_lshl_b32 s6, s61, 6
 buffer_store_dwordx4 v[188:191], v247, s[20:23], s6 offen sc1 nt
 s_waitcnt vmcnt(0) lgkmcnt(0)
L_end:
 s_endpgm
.section .rodata,"a"
.p2align 6
.amdhsa_kernel standalone__modern_conv_block_slak__vision_kernel
  .amdhsa_next_free_vgpr 512
  .amdhsa_next_free_sgpr 102
  .amdhsa_accum_offset 256
  .amdhsa_group_segment_fixed_size 0
  .amdhsa_kernarg_size 72
  .amdhsa_user_sgpr_count 2
  .amdhsa_user_sgpr_kernarg_segment_ptr 1
  .amdhsa_system_sgpr_workgroup_id_x 1
  .amdhsa_float_denorm_mode_32 3
.end_amdhsa_kernel
```
